```python
import torch

def _softmax(x, axis=-1):
    return torch.softmax(x, dim=axis)
def _gelu(x):
    return torch.nn.functional.gelu(x, approximate="tanh")
def _silu(x):
    return torch.nn.functional.silu(x)
def _sigmoid(x):
    return torch.sigmoid(x)
def _layernorm(x, axis=-1, eps=1e-5):
    m = x.mean(dim=axis, keepdim=True)
    v = x.var(dim=axis, keepdim=True, unbiased=False)
    return (x - m) / torch.sqrt(v + eps)
def _scatter_add(tgt, idx, src, axis=0):
    return tgt.clone().index_add_(axis, idx, src)
def _segment_sum(src, seg, n):
    out = torch.zeros((n,) + src.shape[1:], dtype=src.dtype)
    return out.index_add_(0, seg, src)
def _pad(x, pw):
    flat = tuple(v for pair in reversed(pw) for v in pair)
    return torch.nn.functional.pad(x, flat)

kernel_name = 'gated_mix__linear_attn_block__dense_activation_mish__prompt'

def setup_inputs():

    _w = (lambda a: (lambda t: t.to(torch.bfloat16) if t.is_floating_point() else t)(torch.as_tensor(a)))
    def _A_setup():
        B, S, D = 1, 2048, 1024
        return {
            "x": _w((lambda *s: torch.randn(*s, dtype=torch.bfloat16) * 0.05)(B, S, D)),
            "wqkv": _w((lambda *s: torch.randn(*s, dtype=torch.bfloat16) * 0.8)(D, 3 * D)),
            "wo": _w((lambda *s: torch.randn(*s, dtype=torch.bfloat16) * 0.05)(D, D)),
        }
    _A_in = _A_setup()

    def _B_setup():
        B, S, D, F = 1, 2048, 1024, 3584
        return {
            "x": _w((lambda *s: torch.randn(*s, dtype=torch.bfloat16) * 0.05)(B, S, D)),
            "w1": _w((lambda *s: torch.randn(*s, dtype=torch.bfloat16) * 12.8)(D, F) * (D ** -0.5)),
            "b1": _w((lambda *s: torch.randn(*s, dtype=torch.bfloat16) * 0.4)(F)),
            "w2": _w((lambda *s: torch.randn(*s, dtype=torch.bfloat16) * 0.05)(F, D) * (F ** -0.5)),
        }
    _B_in = _B_setup()

    return {
        "A_x": _A_in["x"],
        "A_wqkv": _A_in["wqkv"],
        "A_wo": _A_in["wo"],
        "B_x": _B_in["x"],
        "B_w1": _B_in["w1"],
        "B_b1": _B_in["b1"],
        "B_w2": _B_in["w2"],
        "gate_w": _w((lambda *s: torch.randn(*s, dtype=torch.bfloat16) * 0.05)(1024) * 16.0),
    }

def reference(A_x, A_wqkv, A_wo, B_x, B_w1, B_b1, B_w2, gate_w):
    def _A_ref(x, wqkv, wo):
        B, S, D = x.shape
        H = 32; Dh = D // H
        qkv = (lambda x, *d: x.permute(*d))((x @ wqkv).reshape(B, S, 3, H, Dh), 2, 0, 3, 1, 4)
        q, k, v = qkv[0], qkv[1], qkv[2]
        phi = lambda t: torch.where(t > 0, t + 1, torch.exp(t)) + 1e-6
        pq, pk = phi(q), phi(k)
        kv = torch.einsum("bhsd,bhse->bhde", pk, v)
        z = torch.einsum("bhsd->bhd", pk)
        num = torch.einsum("bhqd,bhde->bhqe", pq, kv)
        den = torch.einsum("bhqd,bhd->bhq", pq, z)[..., None] + 1e-6
        o = num / den
        return (lambda x, *d: x.permute(*d))(o, 0, 2, 1, 3).reshape(B, S, D) @ wo

    def _B_ref(x, w1, b1, w2):
        h = torch.einsum("bsd,df->bsf", x, w1) + b1
        sp = torch.log1p(torch.exp(-torch.abs(h))) + torch.where(h > 0, h, torch.zeros_like(h))
        act = h * torch.tanh(sp)
        return torch.einsum("bsf,fd->bsd", act, w2)

    x = A_x
    g = _sigmoid((x * gate_w).sum(-1, keepdims=True))
    a = _A_ref(x, A_wqkv, A_wo)
    b = _B_ref(x, B_w1, B_b1, B_w2)
    return g * a + (1 - g) * b
```

```asm
; @launch grid=(256,1,1) block=(512,1,1) lds=163840
.amdgcn_target "amdgcn-amd-amdhsa--gfx950"
.text
.globl gated_mix__linear_attn_block__dense_activation_mish__prompt_kernel
.p2align 8
.type gated_mix__linear_attn_block__dense_activation_mish__prompt_kernel,@function
.set CODE_LAST, K_code_end - gated_mix__linear_attn_block__dense_activation_mish__prompt_kernel - 64
gated_mix__linear_attn_block__dense_activation_mish__prompt_kernel:
    s_cmp_ge_u32 s2, 256
    s_cbranch_scc1 K_end
    s_load_dwordx16 s[4:19], s[0:1], 0
    s_load_dwordx4 s[20:23], s[0:1], 64
    s_load_dwordx2 s[24:25], s[0:1], 80
    s_getpc_b64 s[26:27]
    s_lshr_b32 s3, s2, 3
    s_and_b32 s3, s3, 7
    s_lshl_b32 s3, s3, 13
    v_lshlrev_b32 v5, 7, v0
    v_add_u32 v5, s3, v5
    v_min_u32 v5, CODE_LAST, v5
    v_cmp_gt_u32 vcc, 64, v0
    s_nop 1
    s_and_saveexec_b64 s[30:31], vcc
    s_cbranch_execz CP_skip
    global_load_dword v3, v5, s[26:27]
CP_skip:
    s_mov_b64 exec, -1
    v_and_b32 v1, 63, v0
    v_lshrrev_b32 v2, 6, v0
    s_nop 0
    v_readfirstlane_b32 s59, v2
    s_and_b32 s73, s2, 7
    s_lshr_b32 s74, s2, 3
    s_and_b32 s56, s74, 7
    s_lshl_b32 s79, s73, 2
    s_lshr_b32 s75, s74, 3
    s_add_u32 s79, s79, s75
    s_lshr_b32 s57, s79, 1
    s_and_b32 s58, s79, 1
    s_and_b32 s60, s59, 3
    s_lshr_b32 s61, s59, 2
    s_cmp_eq_u32 s58, 0
    s_mov_b32 s75, 0x286085C6
    s_cselect_b32 s75, 0x09CA0420, s75
    s_and_b32 s76, s57, 1
    s_lshl_b32 s76, s76, 4
    s_lshr_b32 s75, s75, s76
    s_and_b32 s62, s75, 15
    s_bfe_u32 s63, s75, 0x40004
    s_bfe_u32 s64, s75, 0x40008
    s_bfe_u32 s65, s75, 0x4000c
    v_lshrrev_b32 v2, 4, v1
    v_lshrrev_b32 v6, 3, v1
    v_and_b32 v7, 7, v1
    s_lshl_b32 s75, s59, 15
    v_xor_b32 v5, 0, v2
    v_xor_b32 v5, v5, v7
    v_lshlrev_b32 v5, 4, v5
    v_lshl_add_u32 v5, v6, 11, v5
    s_add_u32 s76, s75, 0
    v_add_u32 v105, s76, v5
    v_xor_b32 v5, 4, v2
    v_xor_b32 v5, v5, v7
    v_lshlrev_b32 v5, 4, v5
    v_lshl_add_u32 v5, v6, 11, v5
    s_add_u32 s76, s75, 15360
    v_add_u32 v106, s76, v5
    s_lshl_b32 s77, s59, 11
    s_add_u32 s78, s77, 65536
    s_lshl_b32 s69, s56, 19
    s_sub_u32 s69, s69, 128
    s_mov_b32 s70, 65536
    s_mov_b32 s67, 0
    s_mul_i32 s92, s57, 448
    s_cmp_ge_u32 s59, 4
    s_cbranch_scc1 K1_setup_z3
    s_lshr_b32 s73, s59, 1
    s_lshl_b32 s75, s57, 7
    s_add_u32 s76, s73, 1
    s_lshl_b32 s76, s76, 11
    s_cmp_eq_u32 s58, 0
    s_cselect_b32 s76, s76, 0
    s_add_u32 s75, s75, s76
    s_lshl_b32 s76, s65, 5
    s_add_u32 s76, s76, s92
    s_and_b32 s73, s58, s73
    s_cselect_b32 s75, s76, s75
    s_movk_i32 s66, 6144
    s_cselect_b32 s66, 7168, s66
    v_lshrrev_b32 v5, 1, v7
    v_and_b32 v7, 1, v2
    v_xor_b32 v5, v5, v7
    v_and_b32 v7, 1, v1
    v_mul_lo_u32 v6, v6, s66
    v_lshl_add_u32 v6, v7, 4, v6
    s_and_b32 s76, s59, 1
    s_lshl_b32 s76, s76, 4
    s_mul_i32 s76, s76, s66
    s_add_u32 s75, s75, s76
    v_xor_b32 v7, 0, v5
    v_lshl_add_u32 v7, v7, 5, v6
    v_add_u32 v107, s75, v7
    v_xor_b32 v7, 2, v5
    v_lshl_add_u32 v7, v7, 5, v6
    s_lshl_b32 s76, s66, 3
    s_add_u32 s75, s75, s76
    s_sub_u32 s75, s75, 1024
    v_add_u32 v108, s75, v7
    s_branch K1_setup_w_done
K1_setup_z3:
    s_mov_b32 s66, 7168
    s_mov_b32 s73, 1
    v_bfe_u32 v5, v1, 1, 3
    v_xor_b32 v5, v5, v2
    s_and_b32 s76, s59, 1
    s_lshl_b32 s76, s76, 2
    v_xor_b32 v5, s76, v5
    v_and_b32 v6, 1, v1
    v_mul_u32_u24 v7, 7168, v2
    v_lshl_add_u32 v7, v6, 4, v7
    s_mul_i32 s76, s60, 57344
    s_add_u32 s75, s92, s76
    s_sub_u32 s76, s63, 2
    s_sub_u32 s74, s64, 4
    v_mov_b32 v117, s62
    v_mov_b32 v118, s76
    v_cmp_lt_u32 vcc, 1, v5
    s_nop 1
    v_cndmask_b32 v117, v117, v118, vcc
    v_mov_b32 v118, s74
    v_cmp_lt_u32 vcc, 3, v5
    s_nop 1
    v_cndmask_b32 v117, v117, v118, vcc
    v_add_u32 v117, v117, v5
    v_lshl_add_u32 v117, v117, 5, v7
    v_add_u32 v117, s75, v117
    v_mov_b32 v118, 0x40000000
    v_cmp_lt_u32 vcc, 4, v5
    s_nop 1
    v_cndmask_b32 v107, v117, v118, vcc
    v_add_u32 v108, 27648, v107
K1_setup_w_done:
    s_lshl_b32 s68, s66, 5
    v_lshlrev_b32 v5, 3, v2
    s_waitcnt lgkmcnt(0)
    s_mov_b32 s28, s4
    s_and_b32 s29, s5, 0xffff
    s_mov_b32 s30, 4194304
    s_mov_b32 s31, 0x00020000
    s_mov_b32 s32, s6
    s_and_b32 s33, s7, 0xffff
    s_mov_b32 s34, 6291456
    s_mov_b32 s35, 0x00020000
    s_cmp_eq_u32 s73, 1
    s_cselect_b32 s32, s12, s32
    s_cselect_b32 s33, s13, s33
    s_cselect_b32 s34, 7340032, s34
    s_and_b32 s33, s33, 0xffff
    s_add_u32 m0, s77, 0
    s_nop 0
    buffer_load_dwordx4 v107, s[32:35], s67 offen offset:0 lds
    buffer_load_dwordx4 v108, s[32:35], s67 offen offset:1024 lds
    s_add_u32 s67, s67, s68
    s_add_u32 s69, s69, 128
    s_add_u32 s70, s70, 32768
    s_cmp_eq_u32 s70, 98304
    s_cselect_b32 s70, 0, s70
    s_add_u32 m0, s70, s78
    s_nop 0
    buffer_load_dwordx4 v105, s[28:31], s69 offen offset:0 lds
    buffer_load_dwordx4 v106, s[28:31], s69 offen offset:1024 lds
    s_add_u32 s73, s69, 262144
    s_add_u32 s74, s70, s78
    s_add_u32 m0, s74, 16384
    s_nop 0
    buffer_load_dwordx4 v105, s[28:31], s73 offen offset:0 lds
    buffer_load_dwordx4 v106, s[28:31], s73 offen offset:1024 lds
    s_mov_b32 s44, s14
    s_and_b32 s45, s15, 0xffff
    s_mov_b32 s46, 7168
    s_mov_b32 s47, 0x00020000
    s_mov_b32 s48, s14
    s_and_b32 s49, s15, 0xffff
    s_mov_b32 s50, 7168
    s_mov_b32 s51, 0x00020000
    s_cmp_eq_u32 s58, 0
    s_cselect_b32 s50, 0, s50
    s_lshl_b32 s76, s61, 1
    s_add_u32 s76, s76, s65
    s_lshl_b32 s76, s76, 5
    s_add_u32 s76, s76, s92
    buffer_load_dwordx2 v[36:37], v5, s[48:51], s76 offen
    buffer_load_dwordx2 v[38:39], v5, s[48:51], s76 offen offset:32
    s_cmp_eq_u32 s61, 0
    s_cselect_b32 s76, s62, s63
    s_lshl_b32 s76, s76, 5
    s_add_u32 s76, s76, s92
    buffer_load_dwordx2 v[40:41], v5, s[44:47], s76 offen
    buffer_load_dwordx2 v[42:43], v5, s[44:47], s76 offen offset:32
    s_lshl_b32 s76, s64, 5
    s_add_u32 s76, s76, s92
    buffer_load_dwordx2 v[44:45], v5, s[44:47], s76 offen
    s_mov_b32 s36, s24
    s_and_b32 s37, s25, 0xffff
    s_mov_b32 s38, 268435456
    s_mov_b32 s39, 0x00020000
    s_mov_b32 s40, s22
    s_and_b32 s41, s23, 0xffff
    s_mov_b32 s42, 256
    s_mov_b32 s43, 0x00020000
    s_lshl_b32 s76, s2, 3
    s_add_u32 s76, s76, s59
    s_cmp_lg_u32 s76, 7
    s_cbranch_scc1 K1_noep
    s_mov_b32 s76, 20049920
    buffer_load_dword v110, off, s[36:39], s76 sc1
K1_noep:
    s_mov_b32 s52, s18
    s_and_b32 s53, s19, 0xffff
    s_mov_b32 s54, 2048
    s_mov_b32 s55, 0x00020000
    v_lshlrev_b32 v113, 4, v1
    s_lshl_b32 s93, s56, 5
    s_add_u32 s93, s93, s79
    s_lshl_b32 s100, s93, 7
    s_add_u32 s100, s100, 19996672
    s_lshl_b32 s75, s93, 3
    s_add_u32 s75, s75, s59
    s_bfe_u32 s95, s2, 0x20001
    s_bfe_u32 s94, s2, 0x10007
    s_lshl_b32 s94, s94, 1
    s_bfe_u32 s73, s2, 0x10005
    s_or_b32 s94, s94, s73
    s_lshl_b32 s94, s94, 1
    s_bfe_u32 s73, s2, 0x10006
    s_or_b32 s94, s94, s73
    s_and_b32 s93, s2, 1
    s_lshl_b32 s93, s93, 2
    s_bfe_u32 s73, s2, 0x20003
    s_or_b32 s93, s93, s73
    s_lshl_b32 s93, s93, 2
    s_or_b32 s93, s93, s95
    s_lshl_b32 s93, s93, 3
    s_or_b32 s93, s93, s94
    s_lshl_b32 s87, s75, 2
    s_add_u32 s87, s87, 19922944
    s_lshl_b32 s98, s75, 11
    s_lshl_b32 s82, s57, 1
    s_add_u32 s82, s82, s61
    s_mov_b32 s80, 1069066811
    s_mov_b32 s85, 0x42700000
    s_mov_b32 s86, 0x358637bd
    s_lshl_b32 s92, s56, 2
    s_add_u32 s92, s92, s60
    s_mul_i32 s92, s92, 576
    s_mul_i32 s75, s57, 7
    s_add_u32 s92, s92, s75
    s_add_u32 s92, s92, 32
    s_lshl_b32 s92, s92, 10
    v_bfe_u32 v119, v1, 2, 2
    v_and_b32 v120, 3, v1
    v_lshl_add_u32 v5, v2, 3, v119
    v_lshrrev_b32 v6, 1, v119
    v_and_b32 v7, 1, v2
    v_lshl_or_b32 v6, v7, 1, v6
    s_lshl_b32 s75, s61, 1
    s_add_u32 s76, s75, 0
    v_xor_b32 v116, s76, v6
    v_lshlrev_b32 v116, 5, v116
    v_lshl_add_u32 v116, v5, 7, v116
    v_lshl_add_u32 v100, v120, 3, v116
    s_add_u32 s76, s75, 1
    v_xor_b32 v116, s76, v6
    v_lshlrev_b32 v116, 5, v116
    v_lshl_add_u32 v116, v5, 7, v116
    v_lshl_add_u32 v101, v120, 3, v116
    v_lshl_or_b32 v6, v7, 2, v119
    s_add_u32 s76, s75, 0
    v_xor_b32 v116, s76, v6
    v_lshlrev_b32 v116, 5, v116
    v_lshl_add_u32 v116, v5, 8, v116
    v_lshl_add_u32 v116, v120, 3, v116
    v_add_u32 v102, 8192, v116
    s_add_u32 s76, s75, 1
    v_xor_b32 v116, s76, v6
    v_lshlrev_b32 v116, 5, v116
    v_lshl_add_u32 v116, v5, 8, v116
    v_lshl_add_u32 v116, v120, 3, v116
    v_add_u32 v103, 8192, v116
    s_mov_b32 s76, 4
    v_xor_b32 v116, s76, v6
    v_lshlrev_b32 v116, 5, v116
    v_lshl_add_u32 v116, v5, 8, v116
    v_lshl_add_u32 v116, v120, 3, v116
    v_add_u32 v104, 8192, v116
    v_and_b32 v5, 15, v1
    v_bfe_u32 v6, v1, 1, 3
    v_xor_b32 v6, v6, v2
    s_lshl_b32 s76, s60, 13
    s_add_u32 s76, s76, 65536
    v_lshlrev_b32 v5, 7, v5
    v_lshl_add_u32 v5, v6, 4, v5
    v_add_u32 v96, s76, v5
    v_xor_b32 v97, 64, v96
    v_mov_b32 v98, v96
    v_mov_b32 v99, v97
    s_mov_b32 s71, 0
    s_and_b32 s9, s9, 0xffff
    s_mov_b32 s88, s16
    s_and_b32 s89, s17, 0xffff
    s_mov_b32 s90, 7340032
    s_mov_b32 s91, 0x00020000
    s_mov_b32 s73, 114688
    v_mul_lo_u32 v109, v1, s73
    s_lshl_b32 s75, s59, 8
    s_add_u32 s75, s75, s2
    s_lshl_b32 s84, s75, 7
    s_lshr_b32 s73, s2, 3
    s_mul_i32 s73, s73, 5
    s_mul_i32 s74, s59, 9
    s_add_u32 s73, s73, s74
    s_and_b32 s74, s2, 7
    s_mul_i32 s74, s74, 3
    s_add_u32 s73, s73, s74
    s_mul_i32 s74, s73, 2979
    s_lshr_b32 s74, s74, 16
    s_mul_i32 s74, s74, 22
    s_sub_u32 s11, s73, s74
    s_cmp_lt_u32 s75, 896
    s_cselect_b32 s10, s11, 1000
    s_cmp_lg_u32 s59, 4
    s_cbranch_scc1 PF_done
    s_mov_b32 s88, s8
    s_and_b32 s89, s9, 0xffff
    s_mov_b32 s90, 2097152
    s_mov_b32 s91, 0x00020000
    s_mov_b32 s10, s11
    s_mov_b32 s84, 0
    v_mul_u32_u24 v5, 5, v1
    v_add_u32 v5, s2, v5
    v_and_b32 v5, 255, v5
    v_lshl_add_u32 v5, v1, 8, v5
    v_lshlrev_b32 v109, 7, v5
PF_done:
    s_mov_b32 s3, 1000
    v_and_b32 v5, 1, v1
    v_lshlrev_b32 v5, 4, v5
    v_lshl_add_u32 v5, v2, 11, v5
    s_lshl_b32 s76, s59, 13
    s_lshl_b32 s73, s94, 8
    s_add_u32 s76, s76, s73
    s_and_b32 s73, s59, 1
    s_lshl_b32 s73, s73, 2
    v_xor_b32 v7, s73, v6
    v_lshl_add_u32 v7, v7, 5, v5
    v_add_u32 v114, s76, v7
    s_lshl_b32 s101, s59, 10
    v_pk_mov_b32 v[128:129], 0, 0
    v_pk_mov_b32 v[130:131], 0, 0
    v_pk_mov_b32 v[132:133], 0, 0
    v_pk_mov_b32 v[134:135], 0, 0
    v_pk_mov_b32 v[136:137], 0, 0
    v_pk_mov_b32 v[138:139], 0, 0
    v_pk_mov_b32 v[140:141], 0, 0
    v_pk_mov_b32 v[142:143], 0, 0
    v_pk_mov_b32 v[144:145], 0, 0
    v_pk_mov_b32 v[146:147], 0, 0
    v_pk_mov_b32 v[148:149], 0, 0
    v_pk_mov_b32 v[150:151], 0, 0
    v_pk_mov_b32 v[152:153], 0, 0
    v_pk_mov_b32 v[154:155], 0, 0
    v_pk_mov_b32 v[156:157], 0, 0
    v_pk_mov_b32 v[158:159], 0, 0
    s_add_u32 m0, s77, 16384
    s_nop 0
    buffer_load_dwordx4 v107, s[32:35], s67 offen offset:0 lds
    buffer_load_dwordx4 v108, s[32:35], s67 offen offset:1024 lds
    s_add_u32 s67, s67, s68
    s_add_u32 m0, s77, 32768
    s_nop 0
    buffer_load_dwordx4 v107, s[32:35], s67 offen offset:0 lds
    buffer_load_dwordx4 v108, s[32:35], s67 offen offset:1024 lds
    s_add_u32 s67, s67, s68
    s_add_u32 s69, s69, 128
    s_add_u32 s70, s70, 32768
    s_cmp_eq_u32 s70, 98304
    s_cselect_b32 s70, 0, s70
    s_add_u32 m0, s70, s78
    s_nop 0
    buffer_load_dwordx4 v105, s[28:31], s69 offen offset:0 lds
    buffer_load_dwordx4 v106, s[28:31], s69 offen offset:1024 lds
    s_add_u32 s73, s69, 262144
    s_add_u32 s74, s70, s78
    s_add_u32 m0, s74, 16384
    s_nop 0
    buffer_load_dwordx4 v105, s[28:31], s73 offen offset:0 lds
    buffer_load_dwordx4 v106, s[28:31], s73 offen offset:1024 lds
    s_waitcnt vmcnt(8)
    v_lshlrev_b32 v160, 16, v36
    v_and_b32 v161, 0xffff0000, v36
    v_lshlrev_b32 v162, 16, v37
    v_and_b32 v163, 0xffff0000, v37
    v_pk_mov_b32 v[164:165], v[160:161], v[160:161] op_sel:[0,1]
    v_pk_mov_b32 v[166:167], v[162:163], v[162:163] op_sel:[0,1]
    v_pk_mov_b32 v[168:169], v[160:161], v[160:161] op_sel:[0,1]
    v_pk_mov_b32 v[170:171], v[162:163], v[162:163] op_sel:[0,1]
    v_pk_mov_b32 v[172:173], v[160:161], v[160:161] op_sel:[0,1]
    v_pk_mov_b32 v[174:175], v[162:163], v[162:163] op_sel:[0,1]
    v_lshlrev_b32 v176, 16, v38
    v_and_b32 v177, 0xffff0000, v38
    v_lshlrev_b32 v178, 16, v39
    v_and_b32 v179, 0xffff0000, v39
    v_pk_mov_b32 v[180:181], v[176:177], v[176:177] op_sel:[0,1]
    v_pk_mov_b32 v[182:183], v[178:179], v[178:179] op_sel:[0,1]
    v_pk_mov_b32 v[184:185], v[176:177], v[176:177] op_sel:[0,1]
    v_pk_mov_b32 v[186:187], v[178:179], v[178:179] op_sel:[0,1]
    v_pk_mov_b32 v[188:189], v[176:177], v[176:177] op_sel:[0,1]
    v_pk_mov_b32 v[190:191], v[178:179], v[178:179] op_sel:[0,1]
    v_lshlrev_b32 v192, 16, v40
    v_and_b32 v193, 0xffff0000, v40
    v_lshlrev_b32 v194, 16, v41
    v_and_b32 v195, 0xffff0000, v41
    v_pk_mov_b32 v[196:197], v[192:193], v[192:193] op_sel:[0,1]
    v_pk_mov_b32 v[198:199], v[194:195], v[194:195] op_sel:[0,1]
    v_pk_mov_b32 v[200:201], v[192:193], v[192:193] op_sel:[0,1]
    v_pk_mov_b32 v[202:203], v[194:195], v[194:195] op_sel:[0,1]
    v_pk_mov_b32 v[204:205], v[192:193], v[192:193] op_sel:[0,1]
    v_pk_mov_b32 v[206:207], v[194:195], v[194:195] op_sel:[0,1]
    v_lshlrev_b32 v208, 16, v42
    v_and_b32 v209, 0xffff0000, v42
    v_lshlrev_b32 v210, 16, v43
    v_and_b32 v211, 0xffff0000, v43
    v_pk_mov_b32 v[212:213], v[208:209], v[208:209] op_sel:[0,1]
    v_pk_mov_b32 v[214:215], v[210:211], v[210:211] op_sel:[0,1]
    v_pk_mov_b32 v[216:217], v[208:209], v[208:209] op_sel:[0,1]
    v_pk_mov_b32 v[218:219], v[210:211], v[210:211] op_sel:[0,1]
    v_pk_mov_b32 v[220:221], v[208:209], v[208:209] op_sel:[0,1]
    v_pk_mov_b32 v[222:223], v[210:211], v[210:211] op_sel:[0,1]
    v_lshlrev_b32 v224, 16, v44
    v_and_b32 v225, 0xffff0000, v44
    v_lshlrev_b32 v226, 16, v45
    v_and_b32 v227, 0xffff0000, v45
    v_pk_mov_b32 v[228:229], v[224:225], v[224:225] op_sel:[0,1]
    v_pk_mov_b32 v[230:231], v[226:227], v[226:227] op_sel:[0,1]
    v_pk_mov_b32 v[232:233], v[224:225], v[224:225] op_sel:[0,1]
    v_pk_mov_b32 v[234:235], v[226:227], v[226:227] op_sel:[0,1]
    v_pk_mov_b32 v[236:237], v[224:225], v[224:225] op_sel:[0,1]
    v_pk_mov_b32 v[238:239], v[226:227], v[226:227] op_sel:[0,1]
    s_lshl_b32 s75, s2, 3
    s_add_u32 s75, s75, s59
    s_cmp_lg_u32 s75, 7
    s_cbranch_scc1 K1_nopub
    v_add_u32 v110, 1, v110
    v_or_b32 v110, 0x80000000, v110
    s_mov_b32 s76, 20049920
    buffer_store_dword v110, off, s[40:43], 0 sc1
    buffer_store_dword v110, off, s[36:39], s76 sc1
    s_waitcnt vmcnt(0)
K1_nopub:
    s_mov_b32 s44, s16
    s_and_b32 s45, s17, 0xffff
    s_mov_b32 s46, 7340032
    s_mov_b32 s47, 0x00020000
    s_mul_i32 s97, s95, 1835008
    s_mul_i32 s19, s95, 524288
    s_lshl_b32 s75, s58, 1
    s_add_u32 s75, s75, s61
    s_cmp_eq_u32 s75, 1
    s_cbranch_scc1 K1_v01
    s_cmp_eq_u32 s75, 2
    s_cbranch_scc1 K1_v10
    s_cmp_eq_u32 s75, 3
    s_cbranch_scc1 K1_v11
K1_v00:
    s_barrier
    ds_read_b64_tr_b16 v[8:9], v100 offset:0
    ds_read_b64_tr_b16 v[10:11], v100 offset:512
    ds_read_b128 v[64:67], v98 offset:0
    ds_read_b128 v[68:71], v98 offset:2048
    ds_read_b128 v[72:75], v98 offset:4096
    ds_read_b128 v[76:79], v98 offset:6144
    ds_read_b64_tr_b16 v[12:13], v101 offset:0
    ds_read_b64_tr_b16 v[14:15], v101 offset:512
    ds_read_b64_tr_b16 v[16:17], v100 offset:4096
    ds_read_b64_tr_b16 v[18:19], v100 offset:4608
    ds_read_b64_tr_b16 v[20:21], v101 offset:4096
    ds_read_b64_tr_b16 v[22:23], v101 offset:4608
    ds_read_b64_tr_b16 v[24:25], v102 offset:0
    ds_read_b64_tr_b16 v[26:27], v102 offset:1024
    ds_read_b64_tr_b16 v[28:29], v103 offset:0
    ds_read_b64_tr_b16 v[30:31], v103 offset:1024
    ds_read_b64_tr_b16 v[32:33], v104 offset:0
    ds_read_b64_tr_b16 v[34:35], v104 offset:1024
    s_mov_b32 s72, 1
    s_waitcnt vmcnt(6) lgkmcnt(0)
    s_barrier
    v_mfma_f32_16x16x32_bf16 v[128:131], v[64:67], v[8:11], v[128:131]
    ds_read_b64_tr_b16 v[36:37], v100 offset:16384
    s_add_u32 m0, s77, 49152
    s_nop 0
    buffer_load_dwordx4 v107, s[32:35], s67 offen offset:0 lds
    v_mfma_f32_16x16x32_bf16 v[132:135], v[68:71], v[8:11], v[132:135]
    ds_read_b64_tr_b16 v[38:39], v100 offset:16896
    v_mfma_f32_16x16x32_bf16 v[136:139], v[72:75], v[8:11], v[136:139]
    ds_read_b128 v[80:83], v99 offset:0
    v_mfma_f32_16x16x32_bf16 v[140:143], v[76:79], v[8:11], v[140:143]
    ds_read_b128 v[84:87], v99 offset:2048
    buffer_load_dwordx4 v108, s[32:35], s67 offen offset:1024 lds
    v_mfma_f32_16x16x32_bf16 v[156:159], v[76:79], v[12:15], v[156:159]
    ds_read_b128 v[88:91], v99 offset:4096
    v_mfma_f32_16x16x32_bf16 v[152:155], v[72:75], v[12:15], v[152:155]
    ds_read_b128 v[92:95], v99 offset:6144
    v_mfma_f32_16x16x32_bf16 v[148:151], v[68:71], v[12:15], v[148:151]
    ds_read_b64_tr_b16 v[40:41], v101 offset:16384
    s_add_u32 s67, s67, s68
    s_add_u32 s69, s69, 128
    s_add_u32 s70, s70, 32768
    s_cmp_eq_u32 s70, 98304
    s_cselect_b32 s70, 0, s70
    s_add_u32 m0, s70, s78
    s_nop 0
    buffer_load_dwordx4 v105, s[28:31], s69 offen offset:0 lds
    v_mfma_f32_16x16x32_bf16 v[144:147], v[64:67], v[12:15], v[144:147]
    ds_read_b64_tr_b16 v[42:43], v101 offset:16896
    v_mfma_f32_16x16x32_bf16 v[160:163], v[64:67], v[16:19], v[160:163]
    ds_read_b64_tr_b16 v[44:45], v100 offset:20480
    v_mfma_f32_16x16x32_bf16 v[164:167], v[68:71], v[16:19], v[164:167]
    ds_read_b64_tr_b16 v[46:47], v100 offset:20992
    buffer_load_dwordx4 v106, s[28:31], s69 offen offset:1024 lds
    v_mfma_f32_16x16x32_bf16 v[168:171], v[72:75], v[16:19], v[168:171]
    ds_read_b64_tr_b16 v[48:49], v101 offset:20480
    v_mfma_f32_16x16x32_bf16 v[172:175], v[76:79], v[16:19], v[172:175]
    ds_read_b64_tr_b16 v[50:51], v101 offset:20992
    v_mfma_f32_16x16x32_bf16 v[188:191], v[76:79], v[20:23], v[188:191]
    ds_read_b64_tr_b16 v[52:53], v102 offset:16384
    s_add_u32 m0, s77, 0
    s_nop 0
    buffer_load_dwordx4 v107, s[32:35], s67 offen offset:0 lds
    v_mfma_f32_16x16x32_bf16 v[184:187], v[72:75], v[20:23], v[184:187]
    ds_read_b64_tr_b16 v[54:55], v102 offset:17408
    v_mfma_f32_16x16x32_bf16 v[180:183], v[68:71], v[20:23], v[180:183]
    ds_read_b64_tr_b16 v[56:57], v103 offset:16384
    v_mfma_f32_16x16x32_bf16 v[176:179], v[64:67], v[20:23], v[176:179]
    ds_read_b64_tr_b16 v[58:59], v103 offset:17408
    buffer_load_dwordx4 v108, s[32:35], s67 offen offset:1024 lds
    v_mfma_f32_16x16x32_bf16 v[192:195], v[24:27], v[64:67], v[192:195]
    ds_read_b64_tr_b16 v[60:61], v104 offset:16384
    v_mfma_f32_16x16x32_bf16 v[196:199], v[24:27], v[68:71], v[196:199]
    ds_read_b64_tr_b16 v[62:63], v104 offset:17408
    v_mfma_f32_16x16x32_bf16 v[200:203], v[24:27], v[72:75], v[200:203]
    s_add_u32 s67, s67, s68
    s_add_u32 s73, s69, 262144
    s_add_u32 s74, s70, s78
    s_add_u32 m0, s74, 16384
    s_nop 0
    buffer_load_dwordx4 v105, s[28:31], s73 offen offset:0 lds
    v_mfma_f32_16x16x32_bf16 v[204:207], v[24:27], v[76:79], v[204:207]
    v_mfma_f32_16x16x32_bf16 v[220:223], v[28:31], v[76:79], v[220:223]
    v_mfma_f32_16x16x32_bf16 v[216:219], v[28:31], v[72:75], v[216:219]
    buffer_load_dwordx4 v106, s[28:31], s73 offen offset:1024 lds
    v_mfma_f32_16x16x32_bf16 v[212:215], v[28:31], v[68:71], v[212:215]
    v_mfma_f32_16x16x32_bf16 v[208:211], v[28:31], v[64:67], v[208:211]
    v_mfma_f32_16x16x32_bf16 v[224:227], v[32:35], v[64:67], v[224:227]
    v_mfma_f32_16x16x32_bf16 v[228:231], v[32:35], v[68:71], v[228:231]
    v_mfma_f32_16x16x32_bf16 v[232:235], v[32:35], v[72:75], v[232:235]
    v_mfma_f32_16x16x32_bf16 v[236:239], v[32:35], v[76:79], v[236:239]
    s_waitcnt vmcnt(8) lgkmcnt(0)
    s_barrier
    s_add_u32 s71, s71, 32768
    s_cmp_eq_u32 s71, 98304
    s_cselect_b32 s71, 0, s71
    v_add_u32 v98, s71, v96
    v_add_u32 v99, s71, v97
    v_mfma_f32_16x16x32_bf16 v[128:131], v[80:83], v[36:39], v[128:131]
    ds_read_b64_tr_b16 v[8:9], v100 offset:32768
    s_add_u32 m0, s77, 16384
    s_nop 0
    buffer_load_dwordx4 v107, s[32:35], s67 offen offset:0 lds
    v_mfma_f32_16x16x32_bf16 v[132:135], v[84:87], v[36:39], v[132:135]
    ds_read_b64_tr_b16 v[10:11], v100 offset:33280
    v_mfma_f32_16x16x32_bf16 v[136:139], v[88:91], v[36:39], v[136:139]
    ds_read_b128 v[64:67], v98 offset:0
    v_mfma_f32_16x16x32_bf16 v[140:143], v[92:95], v[36:39], v[140:143]
    ds_read_b128 v[68:71], v98 offset:2048
    buffer_load_dwordx4 v108, s[32:35], s67 offen offset:1024 lds
    v_mfma_f32_16x16x32_bf16 v[156:159], v[92:95], v[40:43], v[156:159]
    ds_read_b128 v[72:75], v98 offset:4096
    v_mfma_f32_16x16x32_bf16 v[152:155], v[88:91], v[40:43], v[152:155]
    ds_read_b128 v[76:79], v98 offset:6144
    v_mfma_f32_16x16x32_bf16 v[148:151], v[84:87], v[40:43], v[148:151]
    ds_read_b64_tr_b16 v[12:13], v101 offset:32768
    s_add_u32 s67, s67, s68
    s_add_u32 s69, s69, 128
    s_add_u32 s70, s70, 32768
    s_cmp_eq_u32 s70, 98304
    s_cselect_b32 s70, 0, s70
    s_add_u32 m0, s70, s78
    s_nop 0
    buffer_load_dwordx4 v105, s[28:31], s69 offen offset:0 lds
    v_mfma_f32_16x16x32_bf16 v[144:147], v[80:83], v[40:43], v[144:147]
    ds_read_b64_tr_b16 v[14:15], v101 offset:33280
    v_mfma_f32_16x16x32_bf16 v[160:163], v[80:83], v[44:47], v[160:163]
    ds_read_b64_tr_b16 v[16:17], v100 offset:36864
    v_mfma_f32_16x16x32_bf16 v[164:167], v[84:87], v[44:47], v[164:167]
    ds_read_b64_tr_b16 v[18:19], v100 offset:37376
    buffer_load_dwordx4 v106, s[28:31], s69 offen offset:1024 lds
    v_mfma_f32_16x16x32_bf16 v[168:171], v[88:91], v[44:47], v[168:171]
    ds_read_b64_tr_b16 v[20:21], v101 offset:36864
    v_mfma_f32_16x16x32_bf16 v[172:175], v[92:95], v[44:47], v[172:175]
    ds_read_b64_tr_b16 v[22:23], v101 offset:37376
    v_mfma_f32_16x16x32_bf16 v[188:191], v[92:95], v[48:51], v[188:191]
    ds_read_b64_tr_b16 v[24:25], v102 offset:32768
    v_mfma_f32_16x16x32_bf16 v[184:187], v[88:91], v[48:51], v[184:187]
    ds_read_b64_tr_b16 v[26:27], v102 offset:33792
    v_mfma_f32_16x16x32_bf16 v[180:183], v[84:87], v[48:51], v[180:183]
    ds_read_b64_tr_b16 v[28:29], v103 offset:32768
    v_mfma_f32_16x16x32_bf16 v[176:179], v[80:83], v[48:51], v[176:179]
    ds_read_b64_tr_b16 v[30:31], v103 offset:33792
    v_mfma_f32_16x16x32_bf16 v[192:195], v[52:55], v[80:83], v[192:195]
    ds_read_b64_tr_b16 v[32:33], v104 offset:32768
    v_mfma_f32_16x16x32_bf16 v[196:199], v[52:55], v[84:87], v[196:199]
    ds_read_b64_tr_b16 v[34:35], v104 offset:33792
    v_mfma_f32_16x16x32_bf16 v[200:203], v[52:55], v[88:91], v[200:203]
    v_mfma_f32_16x16x32_bf16 v[204:207], v[52:55], v[92:95], v[204:207]
    v_mfma_f32_16x16x32_bf16 v[220:223], v[56:59], v[92:95], v[220:223]
    v_mfma_f32_16x16x32_bf16 v[216:219], v[56:59], v[88:91], v[216:219]
    v_mfma_f32_16x16x32_bf16 v[212:215], v[56:59], v[84:87], v[212:215]
    v_mfma_f32_16x16x32_bf16 v[208:211], v[56:59], v[80:83], v[208:211]
    v_mfma_f32_16x16x32_bf16 v[224:227], v[60:63], v[80:83], v[224:227]
    v_mfma_f32_16x16x32_bf16 v[228:231], v[60:63], v[84:87], v[228:231]
    v_mfma_f32_16x16x32_bf16 v[232:235], v[60:63], v[88:91], v[232:235]
    v_mfma_f32_16x16x32_bf16 v[236:239], v[60:63], v[92:95], v[236:239]
    s_waitcnt vmcnt(8) lgkmcnt(0)
    s_barrier
    v_mfma_f32_16x16x32_bf16 v[128:131], v[64:67], v[8:11], v[128:131]
    ds_read_b64_tr_b16 v[36:37], v100 offset:49152
    s_add_u32 m0, s77, 32768
    s_nop 0
    buffer_load_dwordx4 v107, s[32:35], s67 offen offset:0 lds
    v_mfma_f32_16x16x32_bf16 v[132:135], v[68:71], v[8:11], v[132:135]
    ds_read_b64_tr_b16 v[38:39], v100 offset:49664
    v_mfma_f32_16x16x32_bf16 v[136:139], v[72:75], v[8:11], v[136:139]
    ds_read_b128 v[80:83], v99 offset:0
    v_mfma_f32_16x16x32_bf16 v[140:143], v[76:79], v[8:11], v[140:143]
    ds_read_b128 v[84:87], v99 offset:2048
    buffer_load_dwordx4 v108, s[32:35], s67 offen offset:1024 lds
    v_mfma_f32_16x16x32_bf16 v[156:159], v[76:79], v[12:15], v[156:159]
    ds_read_b128 v[88:91], v99 offset:4096
    v_mfma_f32_16x16x32_bf16 v[152:155], v[72:75], v[12:15], v[152:155]
    ds_read_b128 v[92:95], v99 offset:6144
    v_mfma_f32_16x16x32_bf16 v[148:151], v[68:71], v[12:15], v[148:151]
    ds_read_b64_tr_b16 v[40:41], v101 offset:49152
    s_add_u32 s67, s67, s68
    s_add_u32 s73, s69, 262144
    s_add_u32 s74, s70, s78
    s_add_u32 m0, s74, 16384
    s_nop 0
    buffer_load_dwordx4 v105, s[28:31], s73 offen offset:0 lds
    v_mfma_f32_16x16x32_bf16 v[144:147], v[64:67], v[12:15], v[144:147]
    ds_read_b64_tr_b16 v[42:43], v101 offset:49664
    v_mfma_f32_16x16x32_bf16 v[160:163], v[64:67], v[16:19], v[160:163]
    ds_read_b64_tr_b16 v[44:45], v100 offset:53248
    v_mfma_f32_16x16x32_bf16 v[164:167], v[68:71], v[16:19], v[164:167]
    ds_read_b64_tr_b16 v[46:47], v100 offset:53760
    buffer_load_dwordx4 v106, s[28:31], s73 offen offset:1024 lds
    v_mfma_f32_16x16x32_bf16 v[168:171], v[72:75], v[16:19], v[168:171]
    ds_read_b64_tr_b16 v[48:49], v101 offset:53248
    v_mfma_f32_16x16x32_bf16 v[172:175], v[76:79], v[16:19], v[172:175]
    ds_read_b64_tr_b16 v[50:51], v101 offset:53760
    v_mfma_f32_16x16x32_bf16 v[188:191], v[76:79], v[20:23], v[188:191]
    ds_read_b64_tr_b16 v[52:53], v102 offset:49152
    v_mfma_f32_16x16x32_bf16 v[184:187], v[72:75], v[20:23], v[184:187]
    ds_read_b64_tr_b16 v[54:55], v102 offset:50176
    v_mfma_f32_16x16x32_bf16 v[180:183], v[68:71], v[20:23], v[180:183]
    ds_read_b64_tr_b16 v[56:57], v103 offset:49152
    v_mfma_f32_16x16x32_bf16 v[176:179], v[64:67], v[20:23], v[176:179]
    ds_read_b64_tr_b16 v[58:59], v103 offset:50176
    v_mfma_f32_16x16x32_bf16 v[192:195], v[24:27], v[64:67], v[192:195]
    ds_read_b64_tr_b16 v[60:61], v104 offset:49152
    v_mfma_f32_16x16x32_bf16 v[196:199], v[24:27], v[68:71], v[196:199]
    ds_read_b64_tr_b16 v[62:63], v104 offset:50176
    v_mfma_f32_16x16x32_bf16 v[200:203], v[24:27], v[72:75], v[200:203]
    v_mfma_f32_16x16x32_bf16 v[204:207], v[24:27], v[76:79], v[204:207]
    v_mfma_f32_16x16x32_bf16 v[220:223], v[28:31], v[76:79], v[220:223]
    v_mfma_f32_16x16x32_bf16 v[216:219], v[28:31], v[72:75], v[216:219]
    v_mfma_f32_16x16x32_bf16 v[212:215], v[28:31], v[68:71], v[212:215]
    v_mfma_f32_16x16x32_bf16 v[208:211], v[28:31], v[64:67], v[208:211]
    v_mfma_f32_16x16x32_bf16 v[224:227], v[32:35], v[64:67], v[224:227]
    v_mfma_f32_16x16x32_bf16 v[228:231], v[32:35], v[68:71], v[228:231]
    v_mfma_f32_16x16x32_bf16 v[232:235], v[32:35], v[72:75], v[232:235]
    v_mfma_f32_16x16x32_bf16 v[236:239], v[32:35], v[76:79], v[236:239]
    s_waitcnt vmcnt(8) lgkmcnt(0)
    s_barrier
    s_add_u32 s71, s71, 32768
    s_cmp_eq_u32 s71, 98304
    s_cselect_b32 s71, 0, s71
    v_add_u32 v98, s71, v96
    v_add_u32 v99, s71, v97
    v_mfma_f32_16x16x32_bf16 v[128:131], v[80:83], v[36:39], v[128:131]
    ds_read_b64_tr_b16 v[8:9], v100 offset:0
    s_add_u32 m0, s77, 49152
    s_nop 0
    buffer_load_dwordx4 v107, s[32:35], s67 offen offset:0 lds
    v_mfma_f32_16x16x32_bf16 v[132:135], v[84:87], v[36:39], v[132:135]
    ds_read_b64_tr_b16 v[10:11], v100 offset:512
    v_mfma_f32_16x16x32_bf16 v[136:139], v[88:91], v[36:39], v[136:139]
    ds_read_b128 v[64:67], v98 offset:0
    v_mfma_f32_16x16x32_bf16 v[140:143], v[92:95], v[36:39], v[140:143]
    ds_read_b128 v[68:71], v98 offset:2048
    buffer_load_dwordx4 v108, s[32:35], s67 offen offset:1024 lds
    v_mfma_f32_16x16x32_bf16 v[156:159], v[92:95], v[40:43], v[156:159]
    ds_read_b128 v[72:75], v98 offset:4096
    v_mfma_f32_16x16x32_bf16 v[152:155], v[88:91], v[40:43], v[152:155]
    ds_read_b128 v[76:79], v98 offset:6144
    v_mfma_f32_16x16x32_bf16 v[148:151], v[84:87], v[40:43], v[148:151]
    ds_read_b64_tr_b16 v[12:13], v101 offset:0
    s_add_u32 s67, s67, s68
    s_add_u32 s69, s69, 128
    s_add_u32 s70, s70, 32768
    s_cmp_eq_u32 s70, 98304
    s_cselect_b32 s70, 0, s70
    s_add_u32 m0, s70, s78
    s_nop 0
    buffer_load_dwordx4 v105, s[28:31], s69 offen offset:0 lds
    v_mfma_f32_16x16x32_bf16 v[144:147], v[80:83], v[40:43], v[144:147]
    ds_read_b64_tr_b16 v[14:15], v101 offset:512
    v_mfma_f32_16x16x32_bf16 v[160:163], v[80:83], v[44:47], v[160:163]
    ds_read_b64_tr_b16 v[16:17], v100 offset:4096
    v_mfma_f32_16x16x32_bf16 v[164:167], v[84:87], v[44:47], v[164:167]
    ds_read_b64_tr_b16 v[18:19], v100 offset:4608
    buffer_load_dwordx4 v106, s[28:31], s69 offen offset:1024 lds
    v_mfma_f32_16x16x32_bf16 v[168:171], v[88:91], v[44:47], v[168:171]
    ds_read_b64_tr_b16 v[20:21], v101 offset:4096
    v_mfma_f32_16x16x32_bf16 v[172:175], v[92:95], v[44:47], v[172:175]
    ds_read_b64_tr_b16 v[22:23], v101 offset:4608
    v_mfma_f32_16x16x32_bf16 v[188:191], v[92:95], v[48:51], v[188:191]
    ds_read_b64_tr_b16 v[24:25], v102 offset:0
    v_mfma_f32_16x16x32_bf16 v[184:187], v[88:91], v[48:51], v[184:187]
    ds_read_b64_tr_b16 v[26:27], v102 offset:1024
    v_mfma_f32_16x16x32_bf16 v[180:183], v[84:87], v[48:51], v[180:183]
    ds_read_b64_tr_b16 v[28:29], v103 offset:0
    v_mfma_f32_16x16x32_bf16 v[176:179], v[80:83], v[48:51], v[176:179]
    ds_read_b64_tr_b16 v[30:31], v103 offset:1024
    v_mfma_f32_16x16x32_bf16 v[192:195], v[52:55], v[80:83], v[192:195]
    ds_read_b64_tr_b16 v[32:33], v104 offset:0
    v_mfma_f32_16x16x32_bf16 v[196:199], v[52:55], v[84:87], v[196:199]
    ds_read_b64_tr_b16 v[34:35], v104 offset:1024
    v_mfma_f32_16x16x32_bf16 v[200:203], v[52:55], v[88:91], v[200:203]
    v_mfma_f32_16x16x32_bf16 v[204:207], v[52:55], v[92:95], v[204:207]
    v_mfma_f32_16x16x32_bf16 v[220:223], v[56:59], v[92:95], v[220:223]
    v_mfma_f32_16x16x32_bf16 v[216:219], v[56:59], v[88:91], v[216:219]
    v_mfma_f32_16x16x32_bf16 v[212:215], v[56:59], v[84:87], v[212:215]
    v_mfma_f32_16x16x32_bf16 v[208:211], v[56:59], v[80:83], v[208:211]
    v_mfma_f32_16x16x32_bf16 v[224:227], v[60:63], v[80:83], v[224:227]
    v_mfma_f32_16x16x32_bf16 v[228:231], v[60:63], v[84:87], v[228:231]
    v_mfma_f32_16x16x32_bf16 v[232:235], v[60:63], v[88:91], v[232:235]
    v_mfma_f32_16x16x32_bf16 v[236:239], v[60:63], v[92:95], v[236:239]
    s_waitcnt vmcnt(8) lgkmcnt(0)
    s_barrier
K1_v00_loop:
    v_mfma_f32_16x16x32_bf16 v[128:131], v[64:67], v[8:11], v[128:131]
    ds_read_b64_tr_b16 v[36:37], v100 offset:16384
    s_add_u32 m0, s77, 0
    s_nop 0
    buffer_load_dwordx4 v107, s[32:35], s67 offen offset:0 lds
    v_mfma_f32_16x16x32_bf16 v[132:135], v[68:71], v[8:11], v[132:135]
    ds_read_b64_tr_b16 v[38:39], v100 offset:16896
    v_mfma_f32_16x16x32_bf16 v[136:139], v[72:75], v[8:11], v[136:139]
    ds_read_b128 v[80:83], v99 offset:0
    v_mfma_f32_16x16x32_bf16 v[140:143], v[76:79], v[8:11], v[140:143]
    ds_read_b128 v[84:87], v99 offset:2048
    buffer_load_dwordx4 v108, s[32:35], s67 offen offset:1024 lds
    v_mfma_f32_16x16x32_bf16 v[156:159], v[76:79], v[12:15], v[156:159]
    ds_read_b128 v[88:91], v99 offset:4096
    v_mfma_f32_16x16x32_bf16 v[152:155], v[72:75], v[12:15], v[152:155]
    ds_read_b128 v[92:95], v99 offset:6144
    v_mfma_f32_16x16x32_bf16 v[148:151], v[68:71], v[12:15], v[148:151]
    ds_read_b64_tr_b16 v[40:41], v101 offset:16384
    s_add_u32 s67, s67, s68
    s_add_u32 s73, s69, 262144
    s_add_u32 s74, s70, s78
    s_add_u32 m0, s74, 16384
    s_nop 0
    buffer_load_dwordx4 v105, s[28:31], s73 offen offset:0 lds
    v_mfma_f32_16x16x32_bf16 v[144:147], v[64:67], v[12:15], v[144:147]
    ds_read_b64_tr_b16 v[42:43], v101 offset:16896
    v_mfma_f32_16x16x32_bf16 v[160:163], v[64:67], v[16:19], v[160:163]
    ds_read_b64_tr_b16 v[44:45], v100 offset:20480
    v_mfma_f32_16x16x32_bf16 v[164:167], v[68:71], v[16:19], v[164:167]
    ds_read_b64_tr_b16 v[46:47], v100 offset:20992
    buffer_load_dwordx4 v106, s[28:31], s73 offen offset:1024 lds
    v_mfma_f32_16x16x32_bf16 v[168:171], v[72:75], v[16:19], v[168:171]
    ds_read_b64_tr_b16 v[48:49], v101 offset:20480
    v_mfma_f32_16x16x32_bf16 v[172:175], v[76:79], v[16:19], v[172:175]
    ds_read_b64_tr_b16 v[50:51], v101 offset:20992
    v_mfma_f32_16x16x32_bf16 v[188:191], v[76:79], v[20:23], v[188:191]
    ds_read_b64_tr_b16 v[52:53], v102 offset:16384
    s_sub_u32 s10, s10, 1
    s_cbranch_scc0 PFs1
    buffer_load_dword v3, v109, s[88:91], s84 offen
    s_mov_b32 s10, s3
    s_add_u32 s84, s84, 8192
    s_mov_b32 s3, 1000
PFs1:
    v_mfma_f32_16x16x32_bf16 v[184:187], v[72:75], v[20:23], v[184:187]
    ds_read_b64_tr_b16 v[54:55], v102 offset:17408
    v_mfma_f32_16x16x32_bf16 v[180:183], v[68:71], v[20:23], v[180:183]
    ds_read_b64_tr_b16 v[56:57], v103 offset:16384
    v_mfma_f32_16x16x32_bf16 v[176:179], v[64:67], v[20:23], v[176:179]
    ds_read_b64_tr_b16 v[58:59], v103 offset:17408
    v_mfma_f32_16x16x32_bf16 v[192:195], v[24:27], v[64:67], v[192:195]
    ds_read_b64_tr_b16 v[60:61], v104 offset:16384
    v_mfma_f32_16x16x32_bf16 v[196:199], v[24:27], v[68:71], v[196:199]
    ds_read_b64_tr_b16 v[62:63], v104 offset:17408
    v_mfma_f32_16x16x32_bf16 v[200:203], v[24:27], v[72:75], v[200:203]
    v_mfma_f32_16x16x32_bf16 v[204:207], v[24:27], v[76:79], v[204:207]
    v_mfma_f32_16x16x32_bf16 v[220:223], v[28:31], v[76:79], v[220:223]
    v_mfma_f32_16x16x32_bf16 v[216:219], v[28:31], v[72:75], v[216:219]
    v_mfma_f32_16x16x32_bf16 v[212:215], v[28:31], v[68:71], v[212:215]
    v_mfma_f32_16x16x32_bf16 v[208:211], v[28:31], v[64:67], v[208:211]
    v_mfma_f32_16x16x32_bf16 v[224:227], v[32:35], v[64:67], v[224:227]
    v_mfma_f32_16x16x32_bf16 v[228:231], v[32:35], v[68:71], v[228:231]
    v_mfma_f32_16x16x32_bf16 v[232:235], v[32:35], v[72:75], v[232:235]
    v_mfma_f32_16x16x32_bf16 v[236:239], v[32:35], v[76:79], v[236:239]
    s_waitcnt vmcnt(8) lgkmcnt(0)
    s_barrier
    s_add_u32 s71, s71, 32768
    s_cmp_eq_u32 s71, 98304
    s_cselect_b32 s71, 0, s71
    v_add_u32 v98, s71, v96
    v_add_u32 v99, s71, v97
    v_mfma_f32_16x16x32_bf16 v[128:131], v[80:83], v[36:39], v[128:131]
    ds_read_b64_tr_b16 v[8:9], v100 offset:32768
    s_add_u32 m0, s77, 16384
    s_nop 0
    buffer_load_dwordx4 v107, s[32:35], s67 offen offset:0 lds
    v_mfma_f32_16x16x32_bf16 v[132:135], v[84:87], v[36:39], v[132:135]
    ds_read_b64_tr_b16 v[10:11], v100 offset:33280
    v_mfma_f32_16x16x32_bf16 v[136:139], v[88:91], v[36:39], v[136:139]
    ds_read_b128 v[64:67], v98 offset:0
    v_mfma_f32_16x16x32_bf16 v[140:143], v[92:95], v[36:39], v[140:143]
    ds_read_b128 v[68:71], v98 offset:2048
    buffer_load_dwordx4 v108, s[32:35], s67 offen offset:1024 lds
    v_mfma_f32_16x16x32_bf16 v[156:159], v[92:95], v[40:43], v[156:159]
    ds_read_b128 v[72:75], v98 offset:4096
    v_mfma_f32_16x16x32_bf16 v[152:155], v[88:91], v[40:43], v[152:155]
    ds_read_b128 v[76:79], v98 offset:6144
    v_mfma_f32_16x16x32_bf16 v[148:151], v[84:87], v[40:43], v[148:151]
    ds_read_b64_tr_b16 v[12:13], v101 offset:32768
    s_add_u32 s67, s67, s68
    s_add_u32 s69, s69, 128
    s_add_u32 s70, s70, 32768
    s_cmp_eq_u32 s70, 98304
    s_cselect_b32 s70, 0, s70
    s_add_u32 m0, s70, s78
    s_nop 0
    buffer_load_dwordx4 v105, s[28:31], s69 offen offset:0 lds
    v_mfma_f32_16x16x32_bf16 v[144:147], v[80:83], v[40:43], v[144:147]
    ds_read_b64_tr_b16 v[14:15], v101 offset:33280
    v_mfma_f32_16x16x32_bf16 v[160:163], v[80:83], v[44:47], v[160:163]
    ds_read_b64_tr_b16 v[16:17], v100 offset:36864
    v_mfma_f32_16x16x32_bf16 v[164:167], v[84:87], v[44:47], v[164:167]
    ds_read_b64_tr_b16 v[18:19], v100 offset:37376
    buffer_load_dwordx4 v106, s[28:31], s69 offen offset:1024 lds
    v_mfma_f32_16x16x32_bf16 v[168:171], v[88:91], v[44:47], v[168:171]
    ds_read_b64_tr_b16 v[20:21], v101 offset:36864
    v_mfma_f32_16x16x32_bf16 v[172:175], v[92:95], v[44:47], v[172:175]
    ds_read_b64_tr_b16 v[22:23], v101 offset:37376
    v_mfma_f32_16x16x32_bf16 v[188:191], v[92:95], v[48:51], v[188:191]
    ds_read_b64_tr_b16 v[24:25], v102 offset:32768
    s_sub_u32 s10, s10, 1
    s_cbranch_scc0 PFs2
    buffer_load_dword v3, v109, s[88:91], s84 offen
    s_mov_b32 s10, s3
    s_add_u32 s84, s84, 8192
    s_mov_b32 s3, 1000
PFs2:
    v_mfma_f32_16x16x32_bf16 v[184:187], v[88:91], v[48:51], v[184:187]
    ds_read_b64_tr_b16 v[26:27], v102 offset:33792
    v_mfma_f32_16x16x32_bf16 v[180:183], v[84:87], v[48:51], v[180:183]
    ds_read_b64_tr_b16 v[28:29], v103 offset:32768
    v_mfma_f32_16x16x32_bf16 v[176:179], v[80:83], v[48:51], v[176:179]
    ds_read_b64_tr_b16 v[30:31], v103 offset:33792
    v_mfma_f32_16x16x32_bf16 v[192:195], v[52:55], v[80:83], v[192:195]
    ds_read_b64_tr_b16 v[32:33], v104 offset:32768
    v_mfma_f32_16x16x32_bf16 v[196:199], v[52:55], v[84:87], v[196:199]
    ds_read_b64_tr_b16 v[34:35], v104 offset:33792
    v_mfma_f32_16x16x32_bf16 v[200:203], v[52:55], v[88:91], v[200:203]
    v_mfma_f32_16x16x32_bf16 v[204:207], v[52:55], v[92:95], v[204:207]
    v_mfma_f32_16x16x32_bf16 v[220:223], v[56:59], v[92:95], v[220:223]
    v_mfma_f32_16x16x32_bf16 v[216:219], v[56:59], v[88:91], v[216:219]
    v_mfma_f32_16x16x32_bf16 v[212:215], v[56:59], v[84:87], v[212:215]
    v_mfma_f32_16x16x32_bf16 v[208:211], v[56:59], v[80:83], v[208:211]
    v_mfma_f32_16x16x32_bf16 v[224:227], v[60:63], v[80:83], v[224:227]
    v_mfma_f32_16x16x32_bf16 v[228:231], v[60:63], v[84:87], v[228:231]
    v_mfma_f32_16x16x32_bf16 v[232:235], v[60:63], v[88:91], v[232:235]
    v_mfma_f32_16x16x32_bf16 v[236:239], v[60:63], v[92:95], v[236:239]
    s_waitcnt vmcnt(8) lgkmcnt(0)
    s_barrier
    v_mfma_f32_16x16x32_bf16 v[128:131], v[64:67], v[8:11], v[128:131]
    ds_read_b64_tr_b16 v[36:37], v100 offset:49152
    s_add_u32 m0, s77, 32768
    s_nop 0
    buffer_load_dwordx4 v107, s[32:35], s67 offen offset:0 lds
    v_mfma_f32_16x16x32_bf16 v[132:135], v[68:71], v[8:11], v[132:135]
    ds_read_b64_tr_b16 v[38:39], v100 offset:49664
    v_mfma_f32_16x16x32_bf16 v[136:139], v[72:75], v[8:11], v[136:139]
    ds_read_b128 v[80:83], v99 offset:0
    v_mfma_f32_16x16x32_bf16 v[140:143], v[76:79], v[8:11], v[140:143]
    ds_read_b128 v[84:87], v99 offset:2048
    buffer_load_dwordx4 v108, s[32:35], s67 offen offset:1024 lds
    v_mfma_f32_16x16x32_bf16 v[156:159], v[76:79], v[12:15], v[156:159]
    ds_read_b128 v[88:91], v99 offset:4096
    v_mfma_f32_16x16x32_bf16 v[152:155], v[72:75], v[12:15], v[152:155]
    ds_read_b128 v[92:95], v99 offset:6144
    v_mfma_f32_16x16x32_bf16 v[148:151], v[68:71], v[12:15], v[148:151]
    ds_read_b64_tr_b16 v[40:41], v101 offset:49152
    s_add_u32 s67, s67, s68
    s_add_u32 s73, s69, 262144
    s_add_u32 s74, s70, s78
    s_add_u32 m0, s74, 16384
    s_nop 0
    buffer_load_dwordx4 v105, s[28:31], s73 offen offset:0 lds
    v_mfma_f32_16x16x32_bf16 v[144:147], v[64:67], v[12:15], v[144:147]
    ds_read_b64_tr_b16 v[42:43], v101 offset:49664
    v_mfma_f32_16x16x32_bf16 v[160:163], v[64:67], v[16:19], v[160:163]
    ds_read_b64_tr_b16 v[44:45], v100 offset:53248
    v_mfma_f32_16x16x32_bf16 v[164:167], v[68:71], v[16:19], v[164:167]
    ds_read_b64_tr_b16 v[46:47], v100 offset:53760
    buffer_load_dwordx4 v106, s[28:31], s73 offen offset:1024 lds
    v_mfma_f32_16x16x32_bf16 v[168:171], v[72:75], v[16:19], v[168:171]
    ds_read_b64_tr_b16 v[48:49], v101 offset:53248
    v_mfma_f32_16x16x32_bf16 v[172:175], v[76:79], v[16:19], v[172:175]
    ds_read_b64_tr_b16 v[50:51], v101 offset:53760
    v_mfma_f32_16x16x32_bf16 v[188:191], v[76:79], v[20:23], v[188:191]
    ds_read_b64_tr_b16 v[52:53], v102 offset:49152
    s_sub_u32 s10, s10, 1
    s_cbranch_scc0 PFs3
    buffer_load_dword v3, v109, s[88:91], s84 offen
    s_mov_b32 s10, s3
    s_add_u32 s84, s84, 8192
    s_mov_b32 s3, 1000
PFs3:
    v_mfma_f32_16x16x32_bf16 v[184:187], v[72:75], v[20:23], v[184:187]
    ds_read_b64_tr_b16 v[54:55], v102 offset:50176
    v_mfma_f32_16x16x32_bf16 v[180:183], v[68:71], v[20:23], v[180:183]
    ds_read_b64_tr_b16 v[56:57], v103 offset:49152
    v_mfma_f32_16x16x32_bf16 v[176:179], v[64:67], v[20:23], v[176:179]
    ds_read_b64_tr_b16 v[58:59], v103 offset:50176
    v_mfma_f32_16x16x32_bf16 v[192:195], v[24:27], v[64:67], v[192:195]
    ds_read_b64_tr_b16 v[60:61], v104 offset:49152
    v_mfma_f32_16x16x32_bf16 v[196:199], v[24:27], v[68:71], v[196:199]
    ds_read_b64_tr_b16 v[62:63], v104 offset:50176
    v_mfma_f32_16x16x32_bf16 v[200:203], v[24:27], v[72:75], v[200:203]
    v_mfma_f32_16x16x32_bf16 v[204:207], v[24:27], v[76:79], v[204:207]
    v_mfma_f32_16x16x32_bf16 v[220:223], v[28:31], v[76:79], v[220:223]
    v_mfma_f32_16x16x32_bf16 v[216:219], v[28:31], v[72:75], v[216:219]
    v_mfma_f32_16x16x32_bf16 v[212:215], v[28:31], v[68:71], v[212:215]
    v_mfma_f32_16x16x32_bf16 v[208:211], v[28:31], v[64:67], v[208:211]
    v_mfma_f32_16x16x32_bf16 v[224:227], v[32:35], v[64:67], v[224:227]
    v_mfma_f32_16x16x32_bf16 v[228:231], v[32:35], v[68:71], v[228:231]
    v_mfma_f32_16x16x32_bf16 v[232:235], v[32:35], v[72:75], v[232:235]
    v_mfma_f32_16x16x32_bf16 v[236:239], v[32:35], v[76:79], v[236:239]
    s_waitcnt vmcnt(8) lgkmcnt(0)
    s_barrier
    s_add_u32 s71, s71, 32768
    s_cmp_eq_u32 s71, 98304
    s_cselect_b32 s71, 0, s71
    v_add_u32 v98, s71, v96
    v_add_u32 v99, s71, v97
    v_mfma_f32_16x16x32_bf16 v[128:131], v[80:83], v[36:39], v[128:131]
    ds_read_b64_tr_b16 v[8:9], v100 offset:0
    s_add_u32 m0, s77, 49152
    s_nop 0
    buffer_load_dwordx4 v107, s[32:35], s67 offen offset:0 lds
    v_mfma_f32_16x16x32_bf16 v[132:135], v[84:87], v[36:39], v[132:135]
    ds_read_b64_tr_b16 v[10:11], v100 offset:512
    v_mfma_f32_16x16x32_bf16 v[136:139], v[88:91], v[36:39], v[136:139]
    ds_read_b128 v[64:67], v98 offset:0
    v_mfma_f32_16x16x32_bf16 v[140:143], v[92:95], v[36:39], v[140:143]
    ds_read_b128 v[68:71], v98 offset:2048
    buffer_load_dwordx4 v108, s[32:35], s67 offen offset:1024 lds
    v_mfma_f32_16x16x32_bf16 v[156:159], v[92:95], v[40:43], v[156:159]
    ds_read_b128 v[72:75], v98 offset:4096
    v_mfma_f32_16x16x32_bf16 v[152:155], v[88:91], v[40:43], v[152:155]
    ds_read_b128 v[76:79], v98 offset:6144
    v_mfma_f32_16x16x32_bf16 v[148:151], v[84:87], v[40:43], v[148:151]
    ds_read_b64_tr_b16 v[12:13], v101 offset:0
    s_add_u32 s67, s67, s68
    s_add_u32 s69, s69, 128
    s_add_u32 s70, s70, 32768
    s_cmp_eq_u32 s70, 98304
    s_cselect_b32 s70, 0, s70
    s_add_u32 m0, s70, s78
    s_nop 0
    buffer_load_dwordx4 v105, s[28:31], s69 offen offset:0 lds
    v_mfma_f32_16x16x32_bf16 v[144:147], v[80:83], v[40:43], v[144:147]
    ds_read_b64_tr_b16 v[14:15], v101 offset:512
    v_mfma_f32_16x16x32_bf16 v[160:163], v[80:83], v[44:47], v[160:163]
    ds_read_b64_tr_b16 v[16:17], v100 offset:4096
    v_mfma_f32_16x16x32_bf16 v[164:167], v[84:87], v[44:47], v[164:167]
    ds_read_b64_tr_b16 v[18:19], v100 offset:4608
    buffer_load_dwordx4 v106, s[28:31], s69 offen offset:1024 lds
    v_mfma_f32_16x16x32_bf16 v[168:171], v[88:91], v[44:47], v[168:171]
    ds_read_b64_tr_b16 v[20:21], v101 offset:4096
    v_mfma_f32_16x16x32_bf16 v[172:175], v[92:95], v[44:47], v[172:175]
    ds_read_b64_tr_b16 v[22:23], v101 offset:4608
    v_mfma_f32_16x16x32_bf16 v[188:191], v[92:95], v[48:51], v[188:191]
    ds_read_b64_tr_b16 v[24:25], v102 offset:0
    s_sub_u32 s10, s10, 1
    s_cbranch_scc0 PFs4
    buffer_load_dword v3, v109, s[88:91], s84 offen
    s_mov_b32 s10, s3
    s_add_u32 s84, s84, 8192
    s_mov_b32 s3, 1000
PFs4:
    v_mfma_f32_16x16x32_bf16 v[184:187], v[88:91], v[48:51], v[184:187]
    ds_read_b64_tr_b16 v[26:27], v102 offset:1024
    v_mfma_f32_16x16x32_bf16 v[180:183], v[84:87], v[48:51], v[180:183]
    ds_read_b64_tr_b16 v[28:29], v103 offset:0
    v_mfma_f32_16x16x32_bf16 v[176:179], v[80:83], v[48:51], v[176:179]
    ds_read_b64_tr_b16 v[30:31], v103 offset:1024
    v_mfma_f32_16x16x32_bf16 v[192:195], v[52:55], v[80:83], v[192:195]
    ds_read_b64_tr_b16 v[32:33], v104 offset:0
    v_mfma_f32_16x16x32_bf16 v[196:199], v[52:55], v[84:87], v[196:199]
    ds_read_b64_tr_b16 v[34:35], v104 offset:1024
    v_mfma_f32_16x16x32_bf16 v[200:203], v[52:55], v[88:91], v[200:203]
    v_mfma_f32_16x16x32_bf16 v[204:207], v[52:55], v[92:95], v[204:207]
    v_mfma_f32_16x16x32_bf16 v[220:223], v[56:59], v[92:95], v[220:223]
    v_mfma_f32_16x16x32_bf16 v[216:219], v[56:59], v[88:91], v[216:219]
    v_mfma_f32_16x16x32_bf16 v[212:215], v[56:59], v[84:87], v[212:215]
    v_mfma_f32_16x16x32_bf16 v[208:211], v[56:59], v[80:83], v[208:211]
    v_mfma_f32_16x16x32_bf16 v[224:227], v[60:63], v[80:83], v[224:227]
    v_mfma_f32_16x16x32_bf16 v[228:231], v[60:63], v[84:87], v[228:231]
    v_mfma_f32_16x16x32_bf16 v[232:235], v[60:63], v[88:91], v[232:235]
    v_mfma_f32_16x16x32_bf16 v[236:239], v[60:63], v[92:95], v[236:239]
    s_waitcnt vmcnt(8) lgkmcnt(0)
    s_barrier
    s_add_u32 s72, s72, 1
    s_cmp_lt_u32 s72, 7
    s_cbranch_scc1 K1_v00_loop
    v_mfma_f32_16x16x32_bf16 v[128:131], v[64:67], v[8:11], v[128:131]
    ds_read_b64_tr_b16 v[36:37], v100 offset:16384
    buffer_load_dwordx4 v[240:243], v113, s[28:31], s98 offen
    v_mfma_f32_16x16x32_bf16 v[132:135], v[68:71], v[8:11], v[132:135]
    ds_read_b64_tr_b16 v[38:39], v100 offset:16896
    v_mfma_f32_16x16x32_bf16 v[136:139], v[72:75], v[8:11], v[136:139]
    ds_read_b128 v[80:83], v99 offset:0
    v_mfma_f32_16x16x32_bf16 v[140:143], v[76:79], v[8:11], v[140:143]
    ds_read_b128 v[84:87], v99 offset:2048
    buffer_load_dwordx4 v[244:247], v113, s[28:31], s98 offen offset:1024
    v_mfma_f32_16x16x32_bf16 v[156:159], v[76:79], v[12:15], v[156:159]
    ds_read_b128 v[88:91], v99 offset:4096
    v_mfma_f32_16x16x32_bf16 v[152:155], v[72:75], v[12:15], v[152:155]
    ds_read_b128 v[92:95], v99 offset:6144
    v_mfma_f32_16x16x32_bf16 v[148:151], v[68:71], v[12:15], v[148:151]
    ds_read_b64_tr_b16 v[40:41], v101 offset:16384
    buffer_load_dwordx4 v[248:251], v113, s[52:55], 0 offen
    v_mfma_f32_16x16x32_bf16 v[144:147], v[64:67], v[12:15], v[144:147]
    ds_read_b64_tr_b16 v[42:43], v101 offset:16896
    v_mfma_f32_16x16x32_bf16 v[160:163], v[64:67], v[16:19], v[160:163]
    ds_read_b64_tr_b16 v[44:45], v100 offset:20480
    v_mfma_f32_16x16x32_bf16 v[164:167], v[68:71], v[16:19], v[164:167]
    ds_read_b64_tr_b16 v[46:47], v100 offset:20992
    buffer_load_dwordx4 v[252:255], v113, s[52:55], 0 offen offset:1024
    v_mfma_f32_16x16x32_bf16 v[168:171], v[72:75], v[16:19], v[168:171]
    ds_read_b64_tr_b16 v[48:49], v101 offset:20480
    v_mfma_f32_16x16x32_bf16 v[172:175], v[76:79], v[16:19], v[172:175]
    ds_read_b64_tr_b16 v[50:51], v101 offset:20992
    v_mfma_f32_16x16x32_bf16 v[188:191], v[76:79], v[20:23], v[188:191]
    ds_read_b64_tr_b16 v[52:53], v102 offset:16384
    buffer_load_dword v110, off, s[40:43], 0 sc1
    v_mfma_f32_16x16x32_bf16 v[184:187], v[72:75], v[20:23], v[184:187]
    ds_read_b64_tr_b16 v[54:55], v102 offset:17408
    v_mfma_f32_16x16x32_bf16 v[180:183], v[68:71], v[20:23], v[180:183]
    ds_read_b64_tr_b16 v[56:57], v103 offset:16384
    v_mfma_f32_16x16x32_bf16 v[176:179], v[64:67], v[20:23], v[176:179]
    ds_read_b64_tr_b16 v[58:59], v103 offset:17408
    s_lshl_b32 s75, s93, 3
    s_add_u32 s75, s75, s59
    s_lshl_b32 s75, s75, 7
    s_add_u32 s75, s75, 38797312
    s_lshl_b32 s76, s57, 7
    s_add_u32 s76, s76, 19988480
    v_mov_b32 v6, s76
    v_writelane_b32 v6, s75, 0
    v_writelane_b32 v6, s100, 1
    v_writelane_b32 v6, s87, 2
    buffer_load_dword v3, v6, s[36:39], 0 offen sc1
    v_mfma_f32_16x16x32_bf16 v[192:195], v[24:27], v[64:67], v[192:195]
    ds_read_b64_tr_b16 v[60:61], v104 offset:16384
    v_mfma_f32_16x16x32_bf16 v[196:199], v[24:27], v[68:71], v[196:199]
    ds_read_b64_tr_b16 v[62:63], v104 offset:17408
    v_mfma_f32_16x16x32_bf16 v[200:203], v[24:27], v[72:75], v[200:203]
    v_mfma_f32_16x16x32_bf16 v[204:207], v[24:27], v[76:79], v[204:207]
    v_mfma_f32_16x16x32_bf16 v[220:223], v[28:31], v[76:79], v[220:223]
    v_mfma_f32_16x16x32_bf16 v[216:219], v[28:31], v[72:75], v[216:219]
    v_mfma_f32_16x16x32_bf16 v[212:215], v[28:31], v[68:71], v[212:215]
    v_mfma_f32_16x16x32_bf16 v[208:211], v[28:31], v[64:67], v[208:211]
    v_mfma_f32_16x16x32_bf16 v[224:227], v[32:35], v[64:67], v[224:227]
    v_mfma_f32_16x16x32_bf16 v[228:231], v[32:35], v[68:71], v[228:231]
    v_mfma_f32_16x16x32_bf16 v[232:235], v[32:35], v[72:75], v[232:235]
    v_mfma_f32_16x16x32_bf16 v[236:239], v[32:35], v[76:79], v[236:239]
    s_waitcnt vmcnt(10) lgkmcnt(0)
    s_barrier
    s_add_u32 s71, s71, 32768
    s_cmp_eq_u32 s71, 98304
    s_cselect_b32 s71, 0, s71
    v_add_u32 v98, s71, v96
    v_add_u32 v99, s71, v97
    v_mfma_f32_16x16x32_bf16 v[128:131], v[80:83], v[36:39], v[128:131]
    ds_read_b64_tr_b16 v[8:9], v100 offset:32768
    v_mfma_f32_16x16x32_bf16 v[132:135], v[84:87], v[36:39], v[132:135]
    ds_read_b64_tr_b16 v[10:11], v100 offset:33280
    v_mfma_f32_16x16x32_bf16 v[136:139], v[88:91], v[36:39], v[136:139]
    ds_read_b128 v[64:67], v98 offset:0
    v_mfma_f32_16x16x32_bf16 v[140:143], v[92:95], v[36:39], v[140:143]
    ds_read_b128 v[68:71], v98 offset:2048
    v_mfma_f32_16x16x32_bf16 v[156:159], v[92:95], v[40:43], v[156:159]
    ds_read_b128 v[72:75], v98 offset:4096
    v_mfma_f32_16x16x32_bf16 v[152:155], v[88:91], v[40:43], v[152:155]
    ds_read_b128 v[76:79], v98 offset:6144
    v_mfma_f32_16x16x32_bf16 v[148:151], v[84:87], v[40:43], v[148:151]
    ds_read_b64_tr_b16 v[12:13], v101 offset:32768
    v_mfma_f32_16x16x32_bf16 v[144:147], v[80:83], v[40:43], v[144:147]
    ds_read_b64_tr_b16 v[14:15], v101 offset:33280
    v_mfma_f32_16x16x32_bf16 v[160:163], v[80:83], v[44:47], v[160:163]
    ds_read_b64_tr_b16 v[16:17], v100 offset:36864
    v_mfma_f32_16x16x32_bf16 v[164:167], v[84:87], v[44:47], v[164:167]
    ds_read_b64_tr_b16 v[18:19], v100 offset:37376
    v_mfma_f32_16x16x32_bf16 v[168:171], v[88:91], v[44:47], v[168:171]
    ds_read_b64_tr_b16 v[20:21], v101 offset:36864
    v_mfma_f32_16x16x32_bf16 v[172:175], v[92:95], v[44:47], v[172:175]
    ds_read_b64_tr_b16 v[22:23], v101 offset:37376
    v_mfma_f32_16x16x32_bf16 v[188:191], v[92:95], v[48:51], v[188:191]
    ds_read_b64_tr_b16 v[24:25], v102 offset:32768
    v_mfma_f32_16x16x32_bf16 v[184:187], v[88:91], v[48:51], v[184:187]
    ds_read_b64_tr_b16 v[26:27], v102 offset:33792
    v_mfma_f32_16x16x32_bf16 v[180:183], v[84:87], v[48:51], v[180:183]
    ds_read_b64_tr_b16 v[28:29], v103 offset:32768
    v_mfma_f32_16x16x32_bf16 v[176:179], v[80:83], v[48:51], v[176:179]
    ds_read_b64_tr_b16 v[30:31], v103 offset:33792
    v_mfma_f32_16x16x32_bf16 v[192:195], v[52:55], v[80:83], v[192:195]
    ds_read_b64_tr_b16 v[32:33], v104 offset:32768
    v_mfma_f32_16x16x32_bf16 v[196:199], v[52:55], v[84:87], v[196:199]
    ds_read_b64_tr_b16 v[34:35], v104 offset:33792
    v_mfma_f32_16x16x32_bf16 v[200:203], v[52:55], v[88:91], v[200:203]
    v_mfma_f32_16x16x32_bf16 v[204:207], v[52:55], v[92:95], v[204:207]
    v_mfma_f32_16x16x32_bf16 v[220:223], v[56:59], v[92:95], v[220:223]
    v_mfma_f32_16x16x32_bf16 v[216:219], v[56:59], v[88:91], v[216:219]
    v_mfma_f32_16x16x32_bf16 v[212:215], v[56:59], v[84:87], v[212:215]
    v_mfma_f32_16x16x32_bf16 v[208:211], v[56:59], v[80:83], v[208:211]
    v_mfma_f32_16x16x32_bf16 v[224:227], v[60:63], v[80:83], v[224:227]
    v_mfma_f32_16x16x32_bf16 v[228:231], v[60:63], v[84:87], v[228:231]
    v_mfma_f32_16x16x32_bf16 v[232:235], v[60:63], v[88:91], v[232:235]
    v_mfma_f32_16x16x32_bf16 v[236:239], v[60:63], v[92:95], v[236:239]
    s_waitcnt vmcnt(0) lgkmcnt(0)
    s_barrier
    v_mfma_f32_16x16x32_bf16 v[128:131], v[64:67], v[8:11], v[128:131]
    ds_read_b64_tr_b16 v[36:37], v100 offset:49152
    v_mov_b32 v5, 0
    v_dot2_f32_bf16 v5, v240, v248, v5
    v_mfma_f32_16x16x32_bf16 v[132:135], v[68:71], v[8:11], v[132:135]
    ds_read_b64_tr_b16 v[38:39], v100 offset:49664
    v_dot2_f32_bf16 v5, v241, v249, v5
    v_dot2_f32_bf16 v5, v242, v250, v5
    v_mfma_f32_16x16x32_bf16 v[136:139], v[72:75], v[8:11], v[136:139]
    ds_read_b128 v[80:83], v99 offset:0
    v_dot2_f32_bf16 v5, v243, v251, v5
    v_dot2_f32_bf16 v5, v244, v252, v5
    v_mfma_f32_16x16x32_bf16 v[140:143], v[76:79], v[8:11], v[140:143]
    ds_read_b128 v[84:87], v99 offset:2048
    v_dot2_f32_bf16 v5, v245, v253, v5
    v_dot2_f32_bf16 v5, v246, v254, v5
    v_mfma_f32_16x16x32_bf16 v[156:159], v[76:79], v[12:15], v[156:159]
    ds_read_b128 v[88:91], v99 offset:4096
    v_dot2_f32_bf16 v5, v247, v255, v5
    s_nop 2
    v_mfma_f32_16x16x32_bf16 v[152:155], v[72:75], v[12:15], v[152:155]
    ds_read_b128 v[92:95], v99 offset:6144
    v_add_f32_dpp v5, v5, v5 row_shr:1 row_mask:0xf bank_mask:0xf bound_ctrl:0
    s_nop 1
    v_add_f32_dpp v5, v5, v5 row_shr:2 row_mask:0xf bank_mask:0xf bound_ctrl:0
    v_mfma_f32_16x16x32_bf16 v[148:151], v[68:71], v[12:15], v[148:151]
    ds_read_b64_tr_b16 v[40:41], v101 offset:49152
    v_add_f32_dpp v5, v5, v5 row_shr:4 row_mask:0xf bank_mask:0xf bound_ctrl:0
    s_nop 1
    v_add_f32_dpp v5, v5, v5 row_shr:8 row_mask:0xf bank_mask:0xf bound_ctrl:0
    v_mfma_f32_16x16x32_bf16 v[144:147], v[64:67], v[12:15], v[144:147]
    ds_read_b64_tr_b16 v[42:43], v101 offset:49664
    v_add_f32_dpp v5, v5, v5 row_bcast:15 row_mask:0xa bank_mask:0xf
    s_nop 1
    v_add_f32_dpp v5, v5, v5 row_bcast:31 row_mask:0xc bank_mask:0xf
    v_mfma_f32_16x16x32_bf16 v[160:163], v[64:67], v[16:19], v[160:163]
    ds_read_b64_tr_b16 v[44:45], v100 offset:53248
    v_mov_b32 v6, 0x42200000
    v_med3_f32 v5, v5, -v6, v6
    v_mfma_f32_16x16x32_bf16 v[164:167], v[68:71], v[16:19], v[164:167]
    ds_read_b64_tr_b16 v[46:47], v100 offset:53760
    v_mul_f32 v5, s80, v5
    v_exp_f32 v5, v5
    v_mfma_f32_16x16x32_bf16 v[168:171], v[72:75], v[16:19], v[168:171]
    ds_read_b64_tr_b16 v[48:49], v101 offset:53248
    v_readlane_b32 s76, v5, 63
    s_nop 1
    v_mov_b32 v5, s76
    v_mfma_f32_16x16x32_bf16 v[172:175], v[76:79], v[16:19], v[172:175]
    ds_read_b64_tr_b16 v[50:51], v101 offset:53760
    buffer_store_dword v5, off, s[36:39], s87 sc1
    v_mfma_f32_16x16x32_bf16 v[188:191], v[76:79], v[20:23], v[188:191]
    ds_read_b64_tr_b16 v[52:53], v102 offset:49152
    v_mfma_f32_16x16x32_bf16 v[184:187], v[72:75], v[20:23], v[184:187]
    ds_read_b64_tr_b16 v[54:55], v102 offset:50176
    v_mfma_f32_16x16x32_bf16 v[180:183], v[68:71], v[20:23], v[180:183]
    ds_read_b64_tr_b16 v[56:57], v103 offset:49152
    v_mfma_f32_16x16x32_bf16 v[176:179], v[64:67], v[20:23], v[176:179]
    ds_read_b64_tr_b16 v[58:59], v103 offset:50176
    v_mfma_f32_16x16x32_bf16 v[192:195], v[24:27], v[64:67], v[192:195]
    ds_read_b64_tr_b16 v[60:61], v104 offset:49152
    v_mfma_f32_16x16x32_bf16 v[196:199], v[24:27], v[68:71], v[196:199]
    ds_read_b64_tr_b16 v[62:63], v104 offset:50176
    v_mfma_f32_16x16x32_bf16 v[200:203], v[24:27], v[72:75], v[200:203]
    v_mfma_f32_16x16x32_bf16 v[204:207], v[24:27], v[76:79], v[204:207]
    v_mfma_f32_16x16x32_bf16 v[220:223], v[28:31], v[76:79], v[220:223]
    v_mfma_f32_16x16x32_bf16 v[216:219], v[28:31], v[72:75], v[216:219]
    v_mfma_f32_16x16x32_bf16 v[212:215], v[28:31], v[68:71], v[212:215]
    v_mfma_f32_16x16x32_bf16 v[208:211], v[28:31], v[64:67], v[208:211]
    v_mfma_f32_16x16x32_bf16 v[224:227], v[32:35], v[64:67], v[224:227]
    v_mfma_f32_16x16x32_bf16 v[228:231], v[32:35], v[68:71], v[228:231]
    v_mfma_f32_16x16x32_bf16 v[232:235], v[32:35], v[72:75], v[232:235]
    v_mfma_f32_16x16x32_bf16 v[236:239], v[32:35], v[76:79], v[236:239]
    s_waitcnt vmcnt(63) lgkmcnt(0)
    s_barrier
    v_mfma_f32_16x16x32_bf16 v[128:131], v[80:83], v[36:39], v[128:131]
    s_add_u32 m0, s101, 0
    s_add_u32 s73, s97, 262144
    buffer_load_dwordx4 v114, s[44:47], s73 offen lds
    s_add_u32 m0, s101, 8192
    s_add_u32 s73, s97, 327680
    buffer_load_dwordx4 v114, s[44:47], s73 offen lds
    v_mfma_f32_16x16x32_bf16 v[132:135], v[84:87], v[36:39], v[132:135]
    v_mfma_f32_16x16x32_bf16 v[136:139], v[88:91], v[36:39], v[136:139]
    v_mfma_f32_16x16x32_bf16 v[140:143], v[92:95], v[36:39], v[140:143]
    s_add_u32 m0, s101, 16384
    s_add_u32 s73, s97, 524288
    buffer_load_dwordx4 v114, s[44:47], s73 offen lds
    s_add_u32 m0, s101, 24576
    s_add_u32 s73, s97, 589824
    buffer_load_dwordx4 v114, s[44:47], s73 offen lds
    v_mfma_f32_16x16x32_bf16 v[156:159], v[92:95], v[40:43], v[156:159]
    v_mfma_f32_16x16x32_bf16 v[152:155], v[88:91], v[40:43], v[152:155]
    v_mfma_f32_16x16x32_bf16 v[148:151], v[84:87], v[40:43], v[148:151]
    s_add_u32 m0, s101, 32768
    s_add_u32 s73, s97, 1179648
    buffer_load_dwordx4 v114, s[44:47], s73 offen lds
    s_add_u32 m0, s101, 40960
    s_add_u32 s73, s97, 1245184
    buffer_load_dwordx4 v114, s[44:47], s73 offen lds
    v_mfma_f32_16x16x32_bf16 v[144:147], v[80:83], v[40:43], v[144:147]
    v_mfma_f32_16x16x32_bf16 v[160:163], v[80:83], v[44:47], v[160:163]
    v_mfma_f32_16x16x32_bf16 v[164:167], v[84:87], v[44:47], v[164:167]
    s_add_u32 m0, s101, 49152
    s_add_u32 s73, s97, 1441792
    buffer_load_dwordx4 v114, s[44:47], s73 offen lds
    s_add_u32 m0, s101, 57344
    s_add_u32 s73, s97, 1507328
    buffer_load_dwordx4 v114, s[44:47], s73 offen lds
    v_mfma_f32_16x16x32_bf16 v[168:171], v[88:91], v[44:47], v[168:171]
    v_mfma_f32_16x16x32_bf16 v[172:175], v[92:95], v[44:47], v[172:175]
    v_mfma_f32_16x16x32_bf16 v[188:191], v[92:95], v[48:51], v[188:191]
    s_add_u32 m0, s101, 65536
    s_add_u32 s73, s97, 196608
    buffer_load_dwordx4 v114, s[44:47], s73 offen lds
    s_add_u32 m0, s101, 73728
    s_add_u32 s73, s97, 393216
    buffer_load_dwordx4 v114, s[44:47], s73 offen lds
    v_mfma_f32_16x16x32_bf16 v[184:187], v[88:91], v[48:51], v[184:187]
    v_mfma_f32_16x16x32_bf16 v[180:183], v[84:87], v[48:51], v[180:183]
    v_mfma_f32_16x16x32_bf16 v[176:179], v[80:83], v[48:51], v[176:179]
    s_add_u32 m0, s101, 81920
    s_add_u32 s73, s97, 458752
    buffer_load_dwordx4 v114, s[44:47], s73 offen lds
    s_add_u32 m0, s101, 90112
    s_add_u32 s73, s97, 655360
    buffer_load_dwordx4 v114, s[44:47], s73 offen lds
    v_mfma_f32_16x16x32_bf16 v[192:195], v[52:55], v[80:83], v[192:195]
    v_mfma_f32_16x16x32_bf16 v[196:199], v[52:55], v[84:87], v[196:199]
    v_mfma_f32_16x16x32_bf16 v[200:203], v[52:55], v[88:91], v[200:203]
    s_add_u32 m0, s101, 98304
    s_add_u32 s73, s97, 1114112
    buffer_load_dwordx4 v114, s[44:47], s73 offen lds
    s_add_u32 m0, s101, 106496
    s_add_u32 s73, s97, 1310720
    buffer_load_dwordx4 v114, s[44:47], s73 offen lds
    v_mfma_f32_16x16x32_bf16 v[204:207], v[52:55], v[92:95], v[204:207]
    v_mfma_f32_16x16x32_bf16 v[220:223], v[56:59], v[92:95], v[220:223]
    v_mfma_f32_16x16x32_bf16 v[216:219], v[56:59], v[88:91], v[216:219]
    v_mfma_f32_16x16x32_bf16 v[212:215], v[56:59], v[84:87], v[212:215]
    v_mfma_f32_16x16x32_bf16 v[208:211], v[56:59], v[80:83], v[208:211]
    v_mfma_f32_16x16x32_bf16 v[224:227], v[60:63], v[80:83], v[224:227]
    v_mfma_f32_16x16x32_bf16 v[228:231], v[60:63], v[84:87], v[228:231]
    v_mfma_f32_16x16x32_bf16 v[232:235], v[60:63], v[88:91], v[232:235]
    v_mfma_f32_16x16x32_bf16 v[236:239], v[60:63], v[92:95], v[236:239]
    s_setprio 2
    s_nop 7
    v_pk_mul_f32 v[240:241], v[128:129], s[80:81] op_sel_hi:[1,0]
    v_pk_mul_f32 v[242:243], v[130:131], s[80:81] op_sel_hi:[1,0]
    v_min_f32 v240, 0, v240
    v_min_f32 v241, 0, v241
    v_min_f32 v242, 0, v242
    v_min_f32 v243, 0, v243
    v_exp_f32 v240, v240
    v_exp_f32 v241, v241
    v_exp_f32 v242, v242
    v_exp_f32 v243, v243
    v_max_f32 v128, 0, v128
    v_max_f32 v129, 0, v129
    v_max_f32 v130, 0, v130
    v_max_f32 v131, 0, v131
    v_pk_add_f32 v[128:129], v[128:129], v[240:241]
    v_pk_add_f32 v[130:131], v[130:131], v[242:243]
    v_add_f32 v128, s86, v128
    v_add_f32 v129, s86, v129
    v_add_f32 v130, s86, v130
    v_add_f32 v131, s86, v131
    v_pk_mul_f32 v[244:245], v[132:133], s[80:81] op_sel_hi:[1,0]
    v_pk_mul_f32 v[246:247], v[134:135], s[80:81] op_sel_hi:[1,0]
    v_min_f32 v244, 0, v244
    v_min_f32 v245, 0, v245
    v_min_f32 v246, 0, v246
    v_min_f32 v247, 0, v247
    v_exp_f32 v244, v244
    v_exp_f32 v245, v245
    v_exp_f32 v246, v246
    v_exp_f32 v247, v247
    v_max_f32 v132, 0, v132
    v_max_f32 v133, 0, v133
    v_max_f32 v134, 0, v134
    v_max_f32 v135, 0, v135
    v_pk_add_f32 v[132:133], v[132:133], v[244:245]
    v_pk_add_f32 v[134:135], v[134:135], v[246:247]
    v_add_f32 v132, s86, v132
    v_add_f32 v133, s86, v133
    v_add_f32 v134, s86, v134
    v_add_f32 v135, s86, v135
    v_pk_mul_f32 v[240:241], v[136:137], s[80:81] op_sel_hi:[1,0]
    v_pk_mul_f32 v[242:243], v[138:139], s[80:81] op_sel_hi:[1,0]
    v_min_f32 v240, 0, v240
    v_min_f32 v241, 0, v241
    v_min_f32 v242, 0, v242
    v_min_f32 v243, 0, v243
    v_exp_f32 v240, v240
    v_exp_f32 v241, v241
    v_exp_f32 v242, v242
    v_exp_f32 v243, v243
    v_max_f32 v136, 0, v136
    v_max_f32 v137, 0, v137
    v_max_f32 v138, 0, v138
    v_max_f32 v139, 0, v139
    v_pk_add_f32 v[136:137], v[136:137], v[240:241]
    v_pk_add_f32 v[138:139], v[138:139], v[242:243]
    v_add_f32 v136, s86, v136
    v_add_f32 v137, s86, v137
    v_add_f32 v138, s86, v138
    v_add_f32 v139, s86, v139
    v_pk_mul_f32 v[244:245], v[140:141], s[80:81] op_sel_hi:[1,0]
    v_pk_mul_f32 v[246:247], v[142:143], s[80:81] op_sel_hi:[1,0]
    v_min_f32 v244, 0, v244
    v_min_f32 v245, 0, v245
    v_min_f32 v246, 0, v246
    v_min_f32 v247, 0, v247
    v_exp_f32 v244, v244
    v_exp_f32 v245, v245
    v_exp_f32 v246, v246
    v_exp_f32 v247, v247
    v_max_f32 v140, 0, v140
    v_max_f32 v141, 0, v141
    v_max_f32 v142, 0, v142
    v_max_f32 v143, 0, v143
    v_pk_add_f32 v[140:141], v[140:141], v[244:245]
    v_pk_add_f32 v[142:143], v[142:143], v[246:247]
    v_add_f32 v140, s86, v140
    v_add_f32 v141, s86, v141
    v_add_f32 v142, s86, v142
    v_add_f32 v143, s86, v143
    v_pk_mul_f32 v[240:241], v[144:145], s[80:81] op_sel_hi:[1,0]
    v_pk_mul_f32 v[242:243], v[146:147], s[80:81] op_sel_hi:[1,0]
    v_min_f32 v240, 0, v240
    v_min_f32 v241, 0, v241
    v_min_f32 v242, 0, v242
    v_min_f32 v243, 0, v243
    v_exp_f32 v240, v240
    v_exp_f32 v241, v241
    v_exp_f32 v242, v242
    v_exp_f32 v243, v243
    v_max_f32 v144, 0, v144
    v_max_f32 v145, 0, v145
    v_max_f32 v146, 0, v146
    v_max_f32 v147, 0, v147
    v_pk_add_f32 v[144:145], v[144:145], v[240:241]
    v_pk_add_f32 v[146:147], v[146:147], v[242:243]
    v_add_f32 v144, s86, v144
    v_add_f32 v145, s86, v145
    v_add_f32 v146, s86, v146
    v_add_f32 v147, s86, v147
    v_pk_mul_f32 v[244:245], v[148:149], s[80:81] op_sel_hi:[1,0]
    v_pk_mul_f32 v[246:247], v[150:151], s[80:81] op_sel_hi:[1,0]
    v_min_f32 v244, 0, v244
    v_min_f32 v245, 0, v245
    v_min_f32 v246, 0, v246
    v_min_f32 v247, 0, v247
    v_exp_f32 v244, v244
    v_exp_f32 v245, v245
    v_exp_f32 v246, v246
    v_exp_f32 v247, v247
    v_max_f32 v148, 0, v148
    v_max_f32 v149, 0, v149
    v_max_f32 v150, 0, v150
    v_max_f32 v151, 0, v151
    v_pk_add_f32 v[148:149], v[148:149], v[244:245]
    v_pk_add_f32 v[150:151], v[150:151], v[246:247]
    v_add_f32 v148, s86, v148
    v_add_f32 v149, s86, v149
    v_add_f32 v150, s86, v150
    v_add_f32 v151, s86, v151
    v_pk_mul_f32 v[240:241], v[152:153], s[80:81] op_sel_hi:[1,0]
    v_pk_mul_f32 v[242:243], v[154:155], s[80:81] op_sel_hi:[1,0]
    v_min_f32 v240, 0, v240
    v_min_f32 v241, 0, v241
    v_min_f32 v242, 0, v242
    v_min_f32 v243, 0, v243
    v_exp_f32 v240, v240
    v_exp_f32 v241, v241
    v_exp_f32 v242, v242
    v_exp_f32 v243, v243
    v_max_f32 v152, 0, v152
    v_max_f32 v153, 0, v153
    v_max_f32 v154, 0, v154
    v_max_f32 v155, 0, v155
    v_pk_add_f32 v[152:153], v[152:153], v[240:241]
    v_pk_add_f32 v[154:155], v[154:155], v[242:243]
    v_add_f32 v152, s86, v152
    v_add_f32 v153, s86, v153
    v_add_f32 v154, s86, v154
    v_add_f32 v155, s86, v155
    v_pk_mul_f32 v[244:245], v[156:157], s[80:81] op_sel_hi:[1,0]
    v_pk_mul_f32 v[246:247], v[158:159], s[80:81] op_sel_hi:[1,0]
    v_min_f32 v244, 0, v244
    v_min_f32 v245, 0, v245
    v_min_f32 v246, 0, v246
    v_min_f32 v247, 0, v247
    v_exp_f32 v244, v244
    v_exp_f32 v245, v245
    v_exp_f32 v246, v246
    v_exp_f32 v247, v247
    v_max_f32 v156, 0, v156
    v_max_f32 v157, 0, v157
    v_max_f32 v158, 0, v158
    v_max_f32 v159, 0, v159
    v_pk_add_f32 v[156:157], v[156:157], v[244:245]
    v_pk_add_f32 v[158:159], v[158:159], v[246:247]
    v_add_f32 v156, s86, v156
    v_add_f32 v157, s86, v157
    v_add_f32 v158, s86, v158
    v_add_f32 v159, s86, v159
    v_mov_b32 v40, 0x3f803f80
    v_mov_b32 v41, 0x3f803f80
    v_mov_b32 v42, 0x3f803f80
    v_mov_b32 v43, 0x3f803f80
    v_cvt_pk_bf16_f32 v24, v160, v161
    v_cvt_pk_bf16_f32 v25, v162, v163
    v_cvt_pk_bf16_f32 v26, v164, v165
    v_cvt_pk_bf16_f32 v27, v166, v167
    v_cvt_pk_bf16_f32 v28, v168, v169
    v_cvt_pk_bf16_f32 v29, v170, v171
    v_cvt_pk_bf16_f32 v30, v172, v173
    v_cvt_pk_bf16_f32 v31, v174, v175
    v_cvt_pk_bf16_f32 v32, v176, v177
    v_cvt_pk_bf16_f32 v33, v178, v179
    v_cvt_pk_bf16_f32 v34, v180, v181
    v_cvt_pk_bf16_f32 v35, v182, v183
    v_cvt_pk_bf16_f32 v36, v184, v185
    v_cvt_pk_bf16_f32 v37, v186, v187
    v_cvt_pk_bf16_f32 v38, v188, v189
    v_cvt_pk_bf16_f32 v39, v190, v191
    v_cvt_pk_bf16_f32 v8, v128, v129
    v_cvt_pk_bf16_f32 v9, v130, v131
    v_cvt_pk_bf16_f32 v10, v132, v133
    v_cvt_pk_bf16_f32 v11, v134, v135
    v_cvt_pk_bf16_f32 v12, v136, v137
    v_cvt_pk_bf16_f32 v13, v138, v139
    v_cvt_pk_bf16_f32 v14, v140, v141
    v_cvt_pk_bf16_f32 v15, v142, v143
    v_cvt_pk_bf16_f32 v16, v144, v145
    v_cvt_pk_bf16_f32 v17, v146, v147
    v_cvt_pk_bf16_f32 v18, v148, v149
    v_cvt_pk_bf16_f32 v19, v150, v151
    v_cvt_pk_bf16_f32 v20, v152, v153
    v_cvt_pk_bf16_f32 v21, v154, v155
    v_cvt_pk_bf16_f32 v22, v156, v157
    v_cvt_pk_bf16_f32 v23, v158, v159
    v_mfma_f32_16x16x32_bf16 v[44:47], v[8:11], v[24:27], 0
    v_mfma_f32_16x16x32_bf16 v[48:51], v[16:19], v[24:27], 0
    v_mfma_f32_16x16x32_bf16 v[52:55], v[8:11], v[32:35], 0
    v_mfma_f32_16x16x32_bf16 v[56:59], v[16:19], v[32:35], 0
    v_mfma_f32_16x16x32_bf16 v[60:63], v[8:11], v[40:43], 0
    v_mfma_f32_16x16x32_bf16 v[64:67], v[16:19], v[40:43], 0
    v_mfma_f32_16x16x32_bf16 v[44:47], v[12:15], v[28:31], v[44:47]
    v_mfma_f32_16x16x32_bf16 v[48:51], v[20:23], v[28:31], v[48:51]
    v_mfma_f32_16x16x32_bf16 v[52:55], v[12:15], v[36:39], v[52:55]
    v_mfma_f32_16x16x32_bf16 v[56:59], v[20:23], v[36:39], v[56:59]
    v_mfma_f32_16x16x32_bf16 v[60:63], v[12:15], v[40:43], v[60:63]
    v_mfma_f32_16x16x32_bf16 v[64:67], v[20:23], v[40:43], v[64:67]
    s_mul_i32 s73, s59, 6144
    s_add_u32 s73, s73, 114688
    v_add_u32 v116, s73, v113
    ds_write_b128 v116, v[44:47] offset:0
    ds_write_b128 v116, v[48:51] offset:1024
    ds_write_b128 v116, v[52:55] offset:2048
    ds_write_b128 v116, v[56:59] offset:3072
    ds_write_b128 v116, v[60:63] offset:4096
    ds_write_b128 v116, v[64:67] offset:5120
    s_waitcnt lgkmcnt(0)
    s_barrier
    s_cmp_lg_u32 s60, 0
    s_cbranch_scc1 K1_v00_nosum
    ds_read_b128 v[68:71], v116 offset:6144
    ds_read_b128 v[72:75], v116 offset:7168
    ds_read_b128 v[76:79], v116 offset:8192
    ds_read_b128 v[80:83], v116 offset:9216
    ds_read_b128 v[84:87], v116 offset:10240
    ds_read_b128 v[88:91], v116 offset:11264
    ds_read_b128 v[8:11], v116 offset:12288
    ds_read_b128 v[12:15], v116 offset:13312
    ds_read_b128 v[16:19], v116 offset:14336
    ds_read_b128 v[20:23], v116 offset:15360
    ds_read_b128 v[24:27], v116 offset:16384
    ds_read_b128 v[28:31], v116 offset:17408
    ds_read_b128 v[128:131], v116 offset:18432
    ds_read_b128 v[132:135], v116 offset:19456
    ds_read_b128 v[136:139], v116 offset:20480
    ds_read_b128 v[140:143], v116 offset:21504
    ds_read_b128 v[144:147], v116 offset:22528
    ds_read_b128 v[148:151], v116 offset:23552
    s_lshl_b32 s73, s82, 3
    s_add_u32 s73, s73, s56
    s_mul_i32 s74, s73, 6144
    s_add_u32 s74, s74, 20971520
    s_add_u32 s76, s74, 4096
    s_waitcnt lgkmcnt(12)
    v_pk_add_f32 v[44:45], v[44:45], v[68:69]
    v_pk_add_f32 v[46:47], v[46:47], v[70:71]
    v_pk_add_f32 v[48:49], v[48:49], v[72:73]
    v_pk_add_f32 v[50:51], v[50:51], v[74:75]
    v_pk_add_f32 v[52:53], v[52:53], v[76:77]
    v_pk_add_f32 v[54:55], v[54:55], v[78:79]
    v_pk_add_f32 v[56:57], v[56:57], v[80:81]
    v_pk_add_f32 v[58:59], v[58:59], v[82:83]
    v_pk_add_f32 v[60:61], v[60:61], v[84:85]
    v_pk_add_f32 v[62:63], v[62:63], v[86:87]
    v_pk_add_f32 v[64:65], v[64:65], v[88:89]
    v_pk_add_f32 v[66:67], v[66:67], v[90:91]
    s_waitcnt lgkmcnt(6)
    v_pk_add_f32 v[44:45], v[44:45], v[8:9]
    v_pk_add_f32 v[46:47], v[46:47], v[10:11]
    v_pk_add_f32 v[48:49], v[48:49], v[12:13]
    v_pk_add_f32 v[50:51], v[50:51], v[14:15]
    v_pk_add_f32 v[52:53], v[52:53], v[16:17]
    v_pk_add_f32 v[54:55], v[54:55], v[18:19]
    v_pk_add_f32 v[56:57], v[56:57], v[20:21]
    v_pk_add_f32 v[58:59], v[58:59], v[22:23]
    v_pk_add_f32 v[60:61], v[60:61], v[24:25]
    v_pk_add_f32 v[62:63], v[62:63], v[26:27]
    v_pk_add_f32 v[64:65], v[64:65], v[28:29]
    v_pk_add_f32 v[66:67], v[66:67], v[30:31]
    s_waitcnt lgkmcnt(0)
    v_pk_add_f32 v[44:45], v[44:45], v[128:129]
    v_pk_add_f32 v[46:47], v[46:47], v[130:131]
    v_pk_add_f32 v[48:49], v[48:49], v[132:133]
    v_pk_add_f32 v[50:51], v[50:51], v[134:135]
    v_pk_add_f32 v[52:53], v[52:53], v[136:137]
    v_pk_add_f32 v[54:55], v[54:55], v[138:139]
    v_pk_add_f32 v[56:57], v[56:57], v[140:141]
    v_pk_add_f32 v[58:59], v[58:59], v[142:143]
    v_pk_add_f32 v[60:61], v[60:61], v[144:145]
    v_pk_add_f32 v[62:63], v[62:63], v[146:147]
    v_pk_add_f32 v[64:65], v[64:65], v[148:149]
    v_pk_add_f32 v[66:67], v[66:67], v[150:151]
    buffer_store_dwordx4 v[44:47], v113, s[36:39], s74 offen offset:0 sc1
    buffer_store_dwordx4 v[48:51], v113, s[36:39], s74 offen offset:1024 sc1
    buffer_store_dwordx4 v[52:55], v113, s[36:39], s74 offen offset:2048 sc1
    buffer_store_dwordx4 v[56:59], v113, s[36:39], s74 offen offset:3072 sc1
    buffer_store_dwordx4 v[60:63], v113, s[36:39], s76 offen offset:0 sc1
    buffer_store_dwordx4 v[64:67], v113, s[36:39], s76 offen offset:1024 sc1
    s_lshl_b32 s73, s57, 7
    s_lshl_b32 s74, s56, 2
    s_add_u32 s73, s73, s74
    s_add_u32 s73, s73, 19988480
    s_waitcnt vmcnt(0)
    s_mov_b32 s79, 0
K1_v00a_nchk:
    v_readfirstlane_b32 s83, v110
    s_nop 1
    s_cmp_lg_u32 s83, 0
    s_cbranch_scc1 K1_v00a_nok
    s_sleep 8
    buffer_load_dword v110, off, s[40:43], 0 sc1
    s_add_u32 s79, s79, 1
    s_waitcnt vmcnt(0)
    s_cmp_lt_u32 s79, 100000
    s_cbranch_scc1 K1_v00a_nchk
K1_v00a_nok:
    buffer_store_dword v110, off, s[36:39], s73 sc1
K1_v00_nosum:
    s_add_u32 s75, s62, 0
    s_lshr_b32 s75, s75, 1
    s_lshl_b32 s75, s75, 10
    s_add_u32 s75, s75, s92
    v_pk_mul_f32 v[240:241], v[192:193], s[80:81] op_sel_hi:[1,0]
    v_pk_mul_f32 v[242:243], v[194:195], s[80:81] op_sel_hi:[1,0]
    v_exp_f32 v240, v240
    v_exp_f32 v241, v241
    v_exp_f32 v242, v242
    v_exp_f32 v243, v243
    v_pk_fma_f32 v[244:245], v[240:241], -0.5, -1.0 op_sel_hi:[1,0,0]
    v_pk_fma_f32 v[246:247], v[242:243], -0.5, -1.0 op_sel_hi:[1,0,0]
    v_pk_fma_f32 v[244:245], v[240:241], v[244:245], -1.0 op_sel_hi:[1,1,0]
    v_pk_fma_f32 v[246:247], v[242:243], v[246:247], -1.0 op_sel_hi:[1,1,0]
    v_rcp_f32 v244, v244
    v_rcp_f32 v245, v245
    v_rcp_f32 v246, v246
    v_rcp_f32 v247, v247
    v_pk_fma_f32 v[192:193], v[192:193], v[244:245], v[192:193]
    v_pk_fma_f32 v[194:195], v[194:195], v[246:247], v[194:195]
    v_pk_mul_f32 v[116:117], v[208:209], s[80:81] op_sel_hi:[1,0]
    v_pk_mul_f32 v[118:119], v[210:211], s[80:81] op_sel_hi:[1,0]
    v_exp_f32 v116, v116
    v_exp_f32 v117, v117
    v_exp_f32 v118, v118
    v_exp_f32 v119, v119
    v_pk_fma_f32 v[120:121], v[116:117], -0.5, -1.0 op_sel_hi:[1,0,0]
    v_pk_fma_f32 v[122:123], v[118:119], -0.5, -1.0 op_sel_hi:[1,0,0]
    v_pk_fma_f32 v[120:121], v[116:117], v[120:121], -1.0 op_sel_hi:[1,1,0]
    v_pk_fma_f32 v[122:123], v[118:119], v[122:123], -1.0 op_sel_hi:[1,1,0]
    v_rcp_f32 v120, v120
    v_rcp_f32 v121, v121
    v_rcp_f32 v122, v122
    v_rcp_f32 v123, v123
    v_pk_fma_f32 v[208:209], v[208:209], v[120:121], v[208:209]
    v_pk_fma_f32 v[210:211], v[210:211], v[122:123], v[210:211]
    v_cvt_pk_bf16_f32 v72, v192, v193
    v_cvt_pk_bf16_f32 v73, v194, v195
    v_cvt_pk_bf16_f32 v74, v208, v209
    v_cvt_pk_bf16_f32 v75, v210, v211
    buffer_store_dwordx4 v[72:75], v113, s[36:39], s75 offen sc1
    s_add_u32 s75, s75, 147456
    v_pk_mul_f32 v[240:241], v[196:197], s[80:81] op_sel_hi:[1,0]
    v_pk_mul_f32 v[242:243], v[198:199], s[80:81] op_sel_hi:[1,0]
    v_exp_f32 v240, v240
    v_exp_f32 v241, v241
    v_exp_f32 v242, v242
    v_exp_f32 v243, v243
    v_pk_fma_f32 v[244:245], v[240:241], -0.5, -1.0 op_sel_hi:[1,0,0]
    v_pk_fma_f32 v[246:247], v[242:243], -0.5, -1.0 op_sel_hi:[1,0,0]
    v_pk_fma_f32 v[244:245], v[240:241], v[244:245], -1.0 op_sel_hi:[1,1,0]
    v_pk_fma_f32 v[246:247], v[242:243], v[246:247], -1.0 op_sel_hi:[1,1,0]
    v_rcp_f32 v244, v244
    v_rcp_f32 v245, v245
    v_rcp_f32 v246, v246
    v_rcp_f32 v247, v247
    v_pk_fma_f32 v[196:197], v[196:197], v[244:245], v[196:197]
    v_pk_fma_f32 v[198:199], v[198:199], v[246:247], v[198:199]
    v_pk_mul_f32 v[116:117], v[212:213], s[80:81] op_sel_hi:[1,0]
    v_pk_mul_f32 v[118:119], v[214:215], s[80:81] op_sel_hi:[1,0]
    v_exp_f32 v116, v116
    v_exp_f32 v117, v117
    v_exp_f32 v118, v118
    v_exp_f32 v119, v119
    v_pk_fma_f32 v[120:121], v[116:117], -0.5, -1.0 op_sel_hi:[1,0,0]
    v_pk_fma_f32 v[122:123], v[118:119], -0.5, -1.0 op_sel_hi:[1,0,0]
    v_pk_fma_f32 v[120:121], v[116:117], v[120:121], -1.0 op_sel_hi:[1,1,0]
    v_pk_fma_f32 v[122:123], v[118:119], v[122:123], -1.0 op_sel_hi:[1,1,0]
    v_rcp_f32 v120, v120
    v_rcp_f32 v121, v121
    v_rcp_f32 v122, v122
    v_rcp_f32 v123, v123
    v_pk_fma_f32 v[212:213], v[212:213], v[120:121], v[212:213]
    v_pk_fma_f32 v[214:215], v[214:215], v[122:123], v[214:215]
    v_cvt_pk_bf16_f32 v76, v196, v197
    v_cvt_pk_bf16_f32 v77, v198, v199
    v_cvt_pk_bf16_f32 v78, v212, v213
    v_cvt_pk_bf16_f32 v79, v214, v215
    buffer_store_dwordx4 v[76:79], v113, s[36:39], s75 offen sc1
    s_add_u32 s75, s75, 147456
    v_pk_mul_f32 v[240:241], v[200:201], s[80:81] op_sel_hi:[1,0]
    v_pk_mul_f32 v[242:243], v[202:203], s[80:81] op_sel_hi:[1,0]
    v_exp_f32 v240, v240
    v_exp_f32 v241, v241
    v_exp_f32 v242, v242
    v_exp_f32 v243, v243
    v_pk_fma_f32 v[244:245], v[240:241], -0.5, -1.0 op_sel_hi:[1,0,0]
    v_pk_fma_f32 v[246:247], v[242:243], -0.5, -1.0 op_sel_hi:[1,0,0]
    v_pk_fma_f32 v[244:245], v[240:241], v[244:245], -1.0 op_sel_hi:[1,1,0]
    v_pk_fma_f32 v[246:247], v[242:243], v[246:247], -1.0 op_sel_hi:[1,1,0]
    v_rcp_f32 v244, v244
    v_rcp_f32 v245, v245
    v_rcp_f32 v246, v246
    v_rcp_f32 v247, v247
    v_pk_fma_f32 v[200:201], v[200:201], v[244:245], v[200:201]
    v_pk_fma_f32 v[202:203], v[202:203], v[246:247], v[202:203]
    v_pk_mul_f32 v[116:117], v[216:217], s[80:81] op_sel_hi:[1,0]
    v_pk_mul_f32 v[118:119], v[218:219], s[80:81] op_sel_hi:[1,0]
    v_exp_f32 v116, v116
    v_exp_f32 v117, v117
    v_exp_f32 v118, v118
    v_exp_f32 v119, v119
    v_pk_fma_f32 v[120:121], v[116:117], -0.5, -1.0 op_sel_hi:[1,0,0]
    v_pk_fma_f32 v[122:123], v[118:119], -0.5, -1.0 op_sel_hi:[1,0,0]
    v_pk_fma_f32 v[120:121], v[116:117], v[120:121], -1.0 op_sel_hi:[1,1,0]
    v_pk_fma_f32 v[122:123], v[118:119], v[122:123], -1.0 op_sel_hi:[1,1,0]
    v_rcp_f32 v120, v120
    v_rcp_f32 v121, v121
    v_rcp_f32 v122, v122
    v_rcp_f32 v123, v123
    v_pk_fma_f32 v[216:217], v[216:217], v[120:121], v[216:217]
    v_pk_fma_f32 v[218:219], v[218:219], v[122:123], v[218:219]
    v_cvt_pk_bf16_f32 v72, v200, v201
    v_cvt_pk_bf16_f32 v73, v202, v203
    v_cvt_pk_bf16_f32 v74, v216, v217
    v_cvt_pk_bf16_f32 v75, v218, v219
    buffer_store_dwordx4 v[72:75], v113, s[36:39], s75 offen sc1
    s_add_u32 s75, s75, 147456
    v_pk_mul_f32 v[240:241], v[204:205], s[80:81] op_sel_hi:[1,0]
    v_pk_mul_f32 v[242:243], v[206:207], s[80:81] op_sel_hi:[1,0]
    v_exp_f32 v240, v240
    v_exp_f32 v241, v241
    v_exp_f32 v242, v242
    v_exp_f32 v243, v243
    v_pk_fma_f32 v[244:245], v[240:241], -0.5, -1.0 op_sel_hi:[1,0,0]
    v_pk_fma_f32 v[246:247], v[242:243], -0.5, -1.0 op_sel_hi:[1,0,0]
    v_pk_fma_f32 v[244:245], v[240:241], v[244:245], -1.0 op_sel_hi:[1,1,0]
    v_pk_fma_f32 v[246:247], v[242:243], v[246:247], -1.0 op_sel_hi:[1,1,0]
    v_rcp_f32 v244, v244
    v_rcp_f32 v245, v245
    v_rcp_f32 v246, v246
    v_rcp_f32 v247, v247
    v_pk_fma_f32 v[204:205], v[204:205], v[244:245], v[204:205]
    v_pk_fma_f32 v[206:207], v[206:207], v[246:247], v[206:207]
    v_pk_mul_f32 v[116:117], v[220:221], s[80:81] op_sel_hi:[1,0]
    v_pk_mul_f32 v[118:119], v[222:223], s[80:81] op_sel_hi:[1,0]
    v_exp_f32 v116, v116
    v_exp_f32 v117, v117
    v_exp_f32 v118, v118
    v_exp_f32 v119, v119
    v_pk_fma_f32 v[120:121], v[116:117], -0.5, -1.0 op_sel_hi:[1,0,0]
    v_pk_fma_f32 v[122:123], v[118:119], -0.5, -1.0 op_sel_hi:[1,0,0]
    v_pk_fma_f32 v[120:121], v[116:117], v[120:121], -1.0 op_sel_hi:[1,1,0]
    v_pk_fma_f32 v[122:123], v[118:119], v[122:123], -1.0 op_sel_hi:[1,1,0]
    v_rcp_f32 v120, v120
    v_rcp_f32 v121, v121
    v_rcp_f32 v122, v122
    v_rcp_f32 v123, v123
    v_pk_fma_f32 v[220:221], v[220:221], v[120:121], v[220:221]
    v_pk_fma_f32 v[222:223], v[222:223], v[122:123], v[222:223]
    v_cvt_pk_bf16_f32 v76, v204, v205
    v_cvt_pk_bf16_f32 v77, v206, v207
    v_cvt_pk_bf16_f32 v78, v220, v221
    v_cvt_pk_bf16_f32 v79, v222, v223
    buffer_store_dwordx4 v[76:79], v113, s[36:39], s75 offen sc1
    s_lshr_b32 s75, s64, 1
    s_lshl_b32 s75, s75, 10
    s_add_u32 s75, s75, s92
    s_and_b32 s76, s64, 1
    s_mul_i32 s76, s76, 147456
    s_add_u32 s75, s75, s76
    v_pk_mul_f32 v[240:241], v[224:225], s[80:81] op_sel_hi:[1,0]
    v_pk_mul_f32 v[242:243], v[226:227], s[80:81] op_sel_hi:[1,0]
    v_exp_f32 v240, v240
    v_exp_f32 v241, v241
    v_exp_f32 v242, v242
    v_exp_f32 v243, v243
    v_pk_fma_f32 v[244:245], v[240:241], -0.5, -1.0 op_sel_hi:[1,0,0]
    v_pk_fma_f32 v[246:247], v[242:243], -0.5, -1.0 op_sel_hi:[1,0,0]
    v_pk_fma_f32 v[244:245], v[240:241], v[244:245], -1.0 op_sel_hi:[1,1,0]
    v_pk_fma_f32 v[246:247], v[242:243], v[246:247], -1.0 op_sel_hi:[1,1,0]
    v_rcp_f32 v244, v244
    v_rcp_f32 v245, v245
    v_rcp_f32 v246, v246
    v_rcp_f32 v247, v247
    v_pk_fma_f32 v[224:225], v[224:225], v[244:245], v[224:225]
    v_pk_fma_f32 v[226:227], v[226:227], v[246:247], v[226:227]
    v_pk_mul_f32 v[116:117], v[228:229], s[80:81] op_sel_hi:[1,0]
    v_pk_mul_f32 v[118:119], v[230:231], s[80:81] op_sel_hi:[1,0]
    v_exp_f32 v116, v116
    v_exp_f32 v117, v117
    v_exp_f32 v118, v118
    v_exp_f32 v119, v119
    v_pk_fma_f32 v[120:121], v[116:117], -0.5, -1.0 op_sel_hi:[1,0,0]
    v_pk_fma_f32 v[122:123], v[118:119], -0.5, -1.0 op_sel_hi:[1,0,0]
    v_pk_fma_f32 v[120:121], v[116:117], v[120:121], -1.0 op_sel_hi:[1,1,0]
    v_pk_fma_f32 v[122:123], v[118:119], v[122:123], -1.0 op_sel_hi:[1,1,0]
    v_rcp_f32 v120, v120
    v_rcp_f32 v121, v121
    v_rcp_f32 v122, v122
    v_rcp_f32 v123, v123
    v_pk_fma_f32 v[228:229], v[228:229], v[120:121], v[228:229]
    v_pk_fma_f32 v[230:231], v[230:231], v[122:123], v[230:231]
    v_cvt_pk_bf16_f32 v72, v224, v225
    v_cvt_pk_bf16_f32 v73, v226, v227
    v_cvt_pk_bf16_f32 v74, v228, v229
    v_cvt_pk_bf16_f32 v75, v230, v231
    buffer_store_dwordx4 v[72:75], v113, s[36:39], s75 offen sc1
    s_add_u32 s75, s75, 294912
    v_pk_mul_f32 v[240:241], v[232:233], s[80:81] op_sel_hi:[1,0]
    v_pk_mul_f32 v[242:243], v[234:235], s[80:81] op_sel_hi:[1,0]
    v_exp_f32 v240, v240
    v_exp_f32 v241, v241
    v_exp_f32 v242, v242
    v_exp_f32 v243, v243
    v_pk_fma_f32 v[244:245], v[240:241], -0.5, -1.0 op_sel_hi:[1,0,0]
    v_pk_fma_f32 v[246:247], v[242:243], -0.5, -1.0 op_sel_hi:[1,0,0]
    v_pk_fma_f32 v[244:245], v[240:241], v[244:245], -1.0 op_sel_hi:[1,1,0]
    v_pk_fma_f32 v[246:247], v[242:243], v[246:247], -1.0 op_sel_hi:[1,1,0]
    v_rcp_f32 v244, v244
    v_rcp_f32 v245, v245
    v_rcp_f32 v246, v246
    v_rcp_f32 v247, v247
    v_pk_fma_f32 v[232:233], v[232:233], v[244:245], v[232:233]
    v_pk_fma_f32 v[234:235], v[234:235], v[246:247], v[234:235]
    v_pk_mul_f32 v[116:117], v[236:237], s[80:81] op_sel_hi:[1,0]
    v_pk_mul_f32 v[118:119], v[238:239], s[80:81] op_sel_hi:[1,0]
    v_exp_f32 v116, v116
    v_exp_f32 v117, v117
    v_exp_f32 v118, v118
    v_exp_f32 v119, v119
    v_pk_fma_f32 v[120:121], v[116:117], -0.5, -1.0 op_sel_hi:[1,0,0]
    v_pk_fma_f32 v[122:123], v[118:119], -0.5, -1.0 op_sel_hi:[1,0,0]
    v_pk_fma_f32 v[120:121], v[116:117], v[120:121], -1.0 op_sel_hi:[1,1,0]
    v_pk_fma_f32 v[122:123], v[118:119], v[122:123], -1.0 op_sel_hi:[1,1,0]
    v_rcp_f32 v120, v120
    v_rcp_f32 v121, v121
    v_rcp_f32 v122, v122
    v_rcp_f32 v123, v123
    v_pk_fma_f32 v[236:237], v[236:237], v[120:121], v[236:237]
    v_pk_fma_f32 v[238:239], v[238:239], v[122:123], v[238:239]
    v_cvt_pk_bf16_f32 v76, v232, v233
    v_cvt_pk_bf16_f32 v77, v234, v235
    v_cvt_pk_bf16_f32 v78, v236, v237
    v_cvt_pk_bf16_f32 v79, v238, v239
    buffer_store_dwordx4 v[76:79], v113, s[36:39], s75 offen sc1
    s_branch P2_start
K1_v01:
    s_barrier
    ds_read_b64_tr_b16 v[8:9], v100 offset:0
    ds_read_b64_tr_b16 v[10:11], v100 offset:512
    ds_read_b128 v[64:67], v98 offset:0
    ds_read_b128 v[68:71], v98 offset:2048
    ds_read_b128 v[72:75], v98 offset:4096
    ds_read_b128 v[76:79], v98 offset:6144
    ds_read_b64_tr_b16 v[12:13], v101 offset:0
    ds_read_b64_tr_b16 v[14:15], v101 offset:512
    ds_read_b64_tr_b16 v[16:17], v100 offset:4096
    ds_read_b64_tr_b16 v[18:19], v100 offset:4608
    ds_read_b64_tr_b16 v[20:21], v101 offset:4096
    ds_read_b64_tr_b16 v[22:23], v101 offset:4608
    ds_read_b64_tr_b16 v[24:25], v102 offset:0
    ds_read_b64_tr_b16 v[26:27], v102 offset:1024
    ds_read_b64_tr_b16 v[28:29], v103 offset:0
    ds_read_b64_tr_b16 v[30:31], v103 offset:1024
    s_mov_b32 s72, 1
    s_waitcnt vmcnt(6) lgkmcnt(0)
    s_barrier
    v_mfma_f32_16x16x32_bf16 v[128:131], v[64:67], v[8:11], v[128:131]
    ds_read_b64_tr_b16 v[36:37], v100 offset:16384
    v_mfma_f32_16x16x32_bf16 v[132:135], v[68:71], v[8:11], v[132:135]
    ds_read_b64_tr_b16 v[38:39], v100 offset:16896
    s_add_u32 m0, s77, 49152
    s_nop 0
    buffer_load_dwordx4 v107, s[32:35], s67 offen offset:0 lds
    v_mfma_f32_16x16x32_bf16 v[136:139], v[72:75], v[8:11], v[136:139]
    ds_read_b128 v[80:83], v99 offset:0
    v_mfma_f32_16x16x32_bf16 v[140:143], v[76:79], v[8:11], v[140:143]
    ds_read_b128 v[84:87], v99 offset:2048
    v_mfma_f32_16x16x32_bf16 v[156:159], v[76:79], v[12:15], v[156:159]
    ds_read_b128 v[88:91], v99 offset:4096
    buffer_load_dwordx4 v108, s[32:35], s67 offen offset:1024 lds
    v_mfma_f32_16x16x32_bf16 v[152:155], v[72:75], v[12:15], v[152:155]
    ds_read_b128 v[92:95], v99 offset:6144
    v_mfma_f32_16x16x32_bf16 v[148:151], v[68:71], v[12:15], v[148:151]
    ds_read_b64_tr_b16 v[40:41], v101 offset:16384
    v_mfma_f32_16x16x32_bf16 v[144:147], v[64:67], v[12:15], v[144:147]
    ds_read_b64_tr_b16 v[42:43], v101 offset:16896
    s_add_u32 s67, s67, s68
    s_add_u32 s69, s69, 128
    s_add_u32 s70, s70, 32768
    s_cmp_eq_u32 s70, 98304
    s_cselect_b32 s70, 0, s70
    s_add_u32 m0, s70, s78
    s_nop 0
    buffer_load_dwordx4 v105, s[28:31], s69 offen offset:0 lds
    v_mfma_f32_16x16x32_bf16 v[160:163], v[64:67], v[16:19], v[160:163]
    ds_read_b64_tr_b16 v[44:45], v100 offset:20480
    v_mfma_f32_16x16x32_bf16 v[164:167], v[68:71], v[16:19], v[164:167]
    ds_read_b64_tr_b16 v[46:47], v100 offset:20992
    v_mfma_f32_16x16x32_bf16 v[168:171], v[72:75], v[16:19], v[168:171]
    ds_read_b64_tr_b16 v[48:49], v101 offset:20480
    buffer_load_dwordx4 v106, s[28:31], s69 offen offset:1024 lds
    v_mfma_f32_16x16x32_bf16 v[172:175], v[76:79], v[16:19], v[172:175]
    ds_read_b64_tr_b16 v[50:51], v101 offset:20992
    v_mfma_f32_16x16x32_bf16 v[188:191], v[76:79], v[20:23], v[188:191]
    ds_read_b64_tr_b16 v[52:53], v102 offset:16384
    v_mfma_f32_16x16x32_bf16 v[184:187], v[72:75], v[20:23], v[184:187]
    ds_read_b64_tr_b16 v[54:55], v102 offset:17408
    s_add_u32 m0, s77, 0
    s_nop 0
    buffer_load_dwordx4 v107, s[32:35], s67 offen offset:0 lds
    v_mfma_f32_16x16x32_bf16 v[180:183], v[68:71], v[20:23], v[180:183]
    ds_read_b64_tr_b16 v[56:57], v103 offset:16384
    v_mfma_f32_16x16x32_bf16 v[176:179], v[64:67], v[20:23], v[176:179]
    ds_read_b64_tr_b16 v[58:59], v103 offset:17408
    v_mfma_f32_16x16x32_bf16 v[192:195], v[24:27], v[64:67], v[192:195]
    buffer_load_dwordx4 v108, s[32:35], s67 offen offset:1024 lds
    v_mfma_f32_16x16x32_bf16 v[196:199], v[24:27], v[68:71], v[196:199]
    v_mfma_f32_16x16x32_bf16 v[200:203], v[24:27], v[72:75], v[200:203]
    v_mfma_f32_16x16x32_bf16 v[204:207], v[24:27], v[76:79], v[204:207]
    s_add_u32 s67, s67, s68
    s_add_u32 s73, s69, 262144
    s_add_u32 s74, s70, s78
    s_add_u32 m0, s74, 16384
    s_nop 0
    buffer_load_dwordx4 v105, s[28:31], s73 offen offset:0 lds
    v_mfma_f32_16x16x32_bf16 v[220:223], v[28:31], v[76:79], v[220:223]
    v_mfma_f32_16x16x32_bf16 v[216:219], v[28:31], v[72:75], v[216:219]
    v_mfma_f32_16x16x32_bf16 v[212:215], v[28:31], v[68:71], v[212:215]
    buffer_load_dwordx4 v106, s[28:31], s73 offen offset:1024 lds
    v_mfma_f32_16x16x32_bf16 v[208:211], v[28:31], v[64:67], v[208:211]
    s_waitcnt vmcnt(8) lgkmcnt(0)
    s_barrier
    s_add_u32 s71, s71, 32768
    s_cmp_eq_u32 s71, 98304
    s_cselect_b32 s71, 0, s71
    v_add_u32 v98, s71, v96
    v_add_u32 v99, s71, v97
    v_mfma_f32_16x16x32_bf16 v[128:131], v[80:83], v[36:39], v[128:131]
    ds_read_b64_tr_b16 v[8:9], v100 offset:32768
    v_mfma_f32_16x16x32_bf16 v[132:135], v[84:87], v[36:39], v[132:135]
    ds_read_b64_tr_b16 v[10:11], v100 offset:33280
    s_add_u32 m0, s77, 16384
    s_nop 0
    buffer_load_dwordx4 v107, s[32:35], s67 offen offset:0 lds
    v_mfma_f32_16x16x32_bf16 v[136:139], v[88:91], v[36:39], v[136:139]
    ds_read_b128 v[64:67], v98 offset:0
    v_mfma_f32_16x16x32_bf16 v[140:143], v[92:95], v[36:39], v[140:143]
    ds_read_b128 v[68:71], v98 offset:2048
    v_mfma_f32_16x16x32_bf16 v[156:159], v[92:95], v[40:43], v[156:159]
    ds_read_b128 v[72:75], v98 offset:4096
    buffer_load_dwordx4 v108, s[32:35], s67 offen offset:1024 lds
    v_mfma_f32_16x16x32_bf16 v[152:155], v[88:91], v[40:43], v[152:155]
    ds_read_b128 v[76:79], v98 offset:6144
    v_mfma_f32_16x16x32_bf16 v[148:151], v[84:87], v[40:43], v[148:151]
    ds_read_b64_tr_b16 v[12:13], v101 offset:32768
    v_mfma_f32_16x16x32_bf16 v[144:147], v[80:83], v[40:43], v[144:147]
    ds_read_b64_tr_b16 v[14:15], v101 offset:33280
    s_add_u32 s67, s67, s68
    s_add_u32 s69, s69, 128
    s_add_u32 s70, s70, 32768
    s_cmp_eq_u32 s70, 98304
    s_cselect_b32 s70, 0, s70
    s_add_u32 m0, s70, s78
    s_nop 0
    buffer_load_dwordx4 v105, s[28:31], s69 offen offset:0 lds
    v_mfma_f32_16x16x32_bf16 v[160:163], v[80:83], v[44:47], v[160:163]
    ds_read_b64_tr_b16 v[16:17], v100 offset:36864
    v_mfma_f32_16x16x32_bf16 v[164:167], v[84:87], v[44:47], v[164:167]
    ds_read_b64_tr_b16 v[18:19], v100 offset:37376
    v_mfma_f32_16x16x32_bf16 v[168:171], v[88:91], v[44:47], v[168:171]
    ds_read_b64_tr_b16 v[20:21], v101 offset:36864
    buffer_load_dwordx4 v106, s[28:31], s69 offen offset:1024 lds
    v_mfma_f32_16x16x32_bf16 v[172:175], v[92:95], v[44:47], v[172:175]
    ds_read_b64_tr_b16 v[22:23], v101 offset:37376
    v_mfma_f32_16x16x32_bf16 v[188:191], v[92:95], v[48:51], v[188:191]
    ds_read_b64_tr_b16 v[24:25], v102 offset:32768
    v_mfma_f32_16x16x32_bf16 v[184:187], v[88:91], v[48:51], v[184:187]
    ds_read_b64_tr_b16 v[26:27], v102 offset:33792
    v_mfma_f32_16x16x32_bf16 v[180:183], v[84:87], v[48:51], v[180:183]
    ds_read_b64_tr_b16 v[28:29], v103 offset:32768
    v_mfma_f32_16x16x32_bf16 v[176:179], v[80:83], v[48:51], v[176:179]
    ds_read_b64_tr_b16 v[30:31], v103 offset:33792
    v_mfma_f32_16x16x32_bf16 v[192:195], v[52:55], v[80:83], v[192:195]
    v_mfma_f32_16x16x32_bf16 v[196:199], v[52:55], v[84:87], v[196:199]
    v_mfma_f32_16x16x32_bf16 v[200:203], v[52:55], v[88:91], v[200:203]
    v_mfma_f32_16x16x32_bf16 v[204:207], v[52:55], v[92:95], v[204:207]
    v_mfma_f32_16x16x32_bf16 v[220:223], v[56:59], v[92:95], v[220:223]
    v_mfma_f32_16x16x32_bf16 v[216:219], v[56:59], v[88:91], v[216:219]
    v_mfma_f32_16x16x32_bf16 v[212:215], v[56:59], v[84:87], v[212:215]
    v_mfma_f32_16x16x32_bf16 v[208:211], v[56:59], v[80:83], v[208:211]
    s_waitcnt vmcnt(8) lgkmcnt(0)
    s_barrier
    v_mfma_f32_16x16x32_bf16 v[128:131], v[64:67], v[8:11], v[128:131]
    ds_read_b64_tr_b16 v[36:37], v100 offset:49152
    v_mfma_f32_16x16x32_bf16 v[132:135], v[68:71], v[8:11], v[132:135]
    ds_read_b64_tr_b16 v[38:39], v100 offset:49664
    s_add_u32 m0, s77, 32768
    s_nop 0
    buffer_load_dwordx4 v107, s[32:35], s67 offen offset:0 lds
    v_mfma_f32_16x16x32_bf16 v[136:139], v[72:75], v[8:11], v[136:139]
    ds_read_b128 v[80:83], v99 offset:0
    v_mfma_f32_16x16x32_bf16 v[140:143], v[76:79], v[8:11], v[140:143]
    ds_read_b128 v[84:87], v99 offset:2048
    v_mfma_f32_16x16x32_bf16 v[156:159], v[76:79], v[12:15], v[156:159]
    ds_read_b128 v[88:91], v99 offset:4096
    buffer_load_dwordx4 v108, s[32:35], s67 offen offset:1024 lds
    v_mfma_f32_16x16x32_bf16 v[152:155], v[72:75], v[12:15], v[152:155]
    ds_read_b128 v[92:95], v99 offset:6144
    v_mfma_f32_16x16x32_bf16 v[148:151], v[68:71], v[12:15], v[148:151]
    ds_read_b64_tr_b16 v[40:41], v101 offset:49152
    v_mfma_f32_16x16x32_bf16 v[144:147], v[64:67], v[12:15], v[144:147]
    ds_read_b64_tr_b16 v[42:43], v101 offset:49664
    s_add_u32 s67, s67, s68
    s_add_u32 s73, s69, 262144
    s_add_u32 s74, s70, s78
    s_add_u32 m0, s74, 16384
    s_nop 0
    buffer_load_dwordx4 v105, s[28:31], s73 offen offset:0 lds
    v_mfma_f32_16x16x32_bf16 v[160:163], v[64:67], v[16:19], v[160:163]
    ds_read_b64_tr_b16 v[44:45], v100 offset:53248
    v_mfma_f32_16x16x32_bf16 v[164:167], v[68:71], v[16:19], v[164:167]
    ds_read_b64_tr_b16 v[46:47], v100 offset:53760
    v_mfma_f32_16x16x32_bf16 v[168:171], v[72:75], v[16:19], v[168:171]
    ds_read_b64_tr_b16 v[48:49], v101 offset:53248
    buffer_load_dwordx4 v106, s[28:31], s73 offen offset:1024 lds
    v_mfma_f32_16x16x32_bf16 v[172:175], v[76:79], v[16:19], v[172:175]
    ds_read_b64_tr_b16 v[50:51], v101 offset:53760
    v_mfma_f32_16x16x32_bf16 v[188:191], v[76:79], v[20:23], v[188:191]
    ds_read_b64_tr_b16 v[52:53], v102 offset:49152
    v_mfma_f32_16x16x32_bf16 v[184:187], v[72:75], v[20:23], v[184:187]
    ds_read_b64_tr_b16 v[54:55], v102 offset:50176
    v_mfma_f32_16x16x32_bf16 v[180:183], v[68:71], v[20:23], v[180:183]
    ds_read_b64_tr_b16 v[56:57], v103 offset:49152
    v_mfma_f32_16x16x32_bf16 v[176:179], v[64:67], v[20:23], v[176:179]
    ds_read_b64_tr_b16 v[58:59], v103 offset:50176
    v_mfma_f32_16x16x32_bf16 v[192:195], v[24:27], v[64:67], v[192:195]
    v_mfma_f32_16x16x32_bf16 v[196:199], v[24:27], v[68:71], v[196:199]
    v_mfma_f32_16x16x32_bf16 v[200:203], v[24:27], v[72:75], v[200:203]
    v_mfma_f32_16x16x32_bf16 v[204:207], v[24:27], v[76:79], v[204:207]
    v_mfma_f32_16x16x32_bf16 v[220:223], v[28:31], v[76:79], v[220:223]
    v_mfma_f32_16x16x32_bf16 v[216:219], v[28:31], v[72:75], v[216:219]
    v_mfma_f32_16x16x32_bf16 v[212:215], v[28:31], v[68:71], v[212:215]
    v_mfma_f32_16x16x32_bf16 v[208:211], v[28:31], v[64:67], v[208:211]
    s_waitcnt vmcnt(8) lgkmcnt(0)
    s_barrier
    s_add_u32 s71, s71, 32768
    s_cmp_eq_u32 s71, 98304
    s_cselect_b32 s71, 0, s71
    v_add_u32 v98, s71, v96
    v_add_u32 v99, s71, v97
    v_mfma_f32_16x16x32_bf16 v[128:131], v[80:83], v[36:39], v[128:131]
    ds_read_b64_tr_b16 v[8:9], v100 offset:0
    v_mfma_f32_16x16x32_bf16 v[132:135], v[84:87], v[36:39], v[132:135]
    ds_read_b64_tr_b16 v[10:11], v100 offset:512
    s_add_u32 m0, s77, 49152
    s_nop 0
    buffer_load_dwordx4 v107, s[32:35], s67 offen offset:0 lds
    v_mfma_f32_16x16x32_bf16 v[136:139], v[88:91], v[36:39], v[136:139]
    ds_read_b128 v[64:67], v98 offset:0
    v_mfma_f32_16x16x32_bf16 v[140:143], v[92:95], v[36:39], v[140:143]
    ds_read_b128 v[68:71], v98 offset:2048
    v_mfma_f32_16x16x32_bf16 v[156:159], v[92:95], v[40:43], v[156:159]
    ds_read_b128 v[72:75], v98 offset:4096
    buffer_load_dwordx4 v108, s[32:35], s67 offen offset:1024 lds
    v_mfma_f32_16x16x32_bf16 v[152:155], v[88:91], v[40:43], v[152:155]
    ds_read_b128 v[76:79], v98 offset:6144
    v_mfma_f32_16x16x32_bf16 v[148:151], v[84:87], v[40:43], v[148:151]
    ds_read_b64_tr_b16 v[12:13], v101 offset:0
    v_mfma_f32_16x16x32_bf16 v[144:147], v[80:83], v[40:43], v[144:147]
    ds_read_b64_tr_b16 v[14:15], v101 offset:512
    s_add_u32 s67, s67, s68
    s_add_u32 s69, s69, 128
    s_add_u32 s70, s70, 32768
    s_cmp_eq_u32 s70, 98304
    s_cselect_b32 s70, 0, s70
    s_add_u32 m0, s70, s78
    s_nop 0
    buffer_load_dwordx4 v105, s[28:31], s69 offen offset:0 lds
    v_mfma_f32_16x16x32_bf16 v[160:163], v[80:83], v[44:47], v[160:163]
    ds_read_b64_tr_b16 v[16:17], v100 offset:4096
    v_mfma_f32_16x16x32_bf16 v[164:167], v[84:87], v[44:47], v[164:167]
    ds_read_b64_tr_b16 v[18:19], v100 offset:4608
    v_mfma_f32_16x16x32_bf16 v[168:171], v[88:91], v[44:47], v[168:171]
    ds_read_b64_tr_b16 v[20:21], v101 offset:4096
    buffer_load_dwordx4 v106, s[28:31], s69 offen offset:1024 lds
    v_mfma_f32_16x16x32_bf16 v[172:175], v[92:95], v[44:47], v[172:175]
    ds_read_b64_tr_b16 v[22:23], v101 offset:4608
    v_mfma_f32_16x16x32_bf16 v[188:191], v[92:95], v[48:51], v[188:191]
    ds_read_b64_tr_b16 v[24:25], v102 offset:0
    v_mfma_f32_16x16x32_bf16 v[184:187], v[88:91], v[48:51], v[184:187]
    ds_read_b64_tr_b16 v[26:27], v102 offset:1024
    v_mfma_f32_16x16x32_bf16 v[180:183], v[84:87], v[48:51], v[180:183]
    ds_read_b64_tr_b16 v[28:29], v103 offset:0
    v_mfma_f32_16x16x32_bf16 v[176:179], v[80:83], v[48:51], v[176:179]
    ds_read_b64_tr_b16 v[30:31], v103 offset:1024
    v_mfma_f32_16x16x32_bf16 v[192:195], v[52:55], v[80:83], v[192:195]
    v_mfma_f32_16x16x32_bf16 v[196:199], v[52:55], v[84:87], v[196:199]
    v_mfma_f32_16x16x32_bf16 v[200:203], v[52:55], v[88:91], v[200:203]
    v_mfma_f32_16x16x32_bf16 v[204:207], v[52:55], v[92:95], v[204:207]
    v_mfma_f32_16x16x32_bf16 v[220:223], v[56:59], v[92:95], v[220:223]
    v_mfma_f32_16x16x32_bf16 v[216:219], v[56:59], v[88:91], v[216:219]
    v_mfma_f32_16x16x32_bf16 v[212:215], v[56:59], v[84:87], v[212:215]
    v_mfma_f32_16x16x32_bf16 v[208:211], v[56:59], v[80:83], v[208:211]
    s_waitcnt vmcnt(8) lgkmcnt(0)
    s_barrier
K1_v01_loop:
    v_mfma_f32_16x16x32_bf16 v[128:131], v[64:67], v[8:11], v[128:131]
    ds_read_b64_tr_b16 v[36:37], v100 offset:16384
    v_mfma_f32_16x16x32_bf16 v[132:135], v[68:71], v[8:11], v[132:135]
    ds_read_b64_tr_b16 v[38:39], v100 offset:16896
    s_add_u32 m0, s77, 0
    s_nop 0
    buffer_load_dwordx4 v107, s[32:35], s67 offen offset:0 lds
    v_mfma_f32_16x16x32_bf16 v[136:139], v[72:75], v[8:11], v[136:139]
    ds_read_b128 v[80:83], v99 offset:0
    v_mfma_f32_16x16x32_bf16 v[140:143], v[76:79], v[8:11], v[140:143]
    ds_read_b128 v[84:87], v99 offset:2048
    v_mfma_f32_16x16x32_bf16 v[156:159], v[76:79], v[12:15], v[156:159]
    ds_read_b128 v[88:91], v99 offset:4096
    buffer_load_dwordx4 v108, s[32:35], s67 offen offset:1024 lds
    v_mfma_f32_16x16x32_bf16 v[152:155], v[72:75], v[12:15], v[152:155]
    ds_read_b128 v[92:95], v99 offset:6144
    v_mfma_f32_16x16x32_bf16 v[148:151], v[68:71], v[12:15], v[148:151]
    ds_read_b64_tr_b16 v[40:41], v101 offset:16384
    v_mfma_f32_16x16x32_bf16 v[144:147], v[64:67], v[12:15], v[144:147]
    ds_read_b64_tr_b16 v[42:43], v101 offset:16896
    s_add_u32 s67, s67, s68
    s_add_u32 s73, s69, 262144
    s_add_u32 s74, s70, s78
    s_add_u32 m0, s74, 16384
    s_nop 0
    buffer_load_dwordx4 v105, s[28:31], s73 offen offset:0 lds
    v_mfma_f32_16x16x32_bf16 v[160:163], v[64:67], v[16:19], v[160:163]
    ds_read_b64_tr_b16 v[44:45], v100 offset:20480
    v_mfma_f32_16x16x32_bf16 v[164:167], v[68:71], v[16:19], v[164:167]
    ds_read_b64_tr_b16 v[46:47], v100 offset:20992
    v_mfma_f32_16x16x32_bf16 v[168:171], v[72:75], v[16:19], v[168:171]
    ds_read_b64_tr_b16 v[48:49], v101 offset:20480
    buffer_load_dwordx4 v106, s[28:31], s73 offen offset:1024 lds
    v_mfma_f32_16x16x32_bf16 v[172:175], v[76:79], v[16:19], v[172:175]
    ds_read_b64_tr_b16 v[50:51], v101 offset:20992
    v_mfma_f32_16x16x32_bf16 v[188:191], v[76:79], v[20:23], v[188:191]
    ds_read_b64_tr_b16 v[52:53], v102 offset:16384
    v_mfma_f32_16x16x32_bf16 v[184:187], v[72:75], v[20:23], v[184:187]
    ds_read_b64_tr_b16 v[54:55], v102 offset:17408
    s_sub_u32 s10, s10, 1
    s_cbranch_scc0 PFs5
    buffer_load_dword v3, v109, s[88:91], s84 offen
    s_mov_b32 s10, s3
    s_add_u32 s84, s84, 8192
    s_mov_b32 s3, 1000
PFs5:
    v_mfma_f32_16x16x32_bf16 v[180:183], v[68:71], v[20:23], v[180:183]
    ds_read_b64_tr_b16 v[56:57], v103 offset:16384
    v_mfma_f32_16x16x32_bf16 v[176:179], v[64:67], v[20:23], v[176:179]
    ds_read_b64_tr_b16 v[58:59], v103 offset:17408
    v_mfma_f32_16x16x32_bf16 v[192:195], v[24:27], v[64:67], v[192:195]
    v_mfma_f32_16x16x32_bf16 v[196:199], v[24:27], v[68:71], v[196:199]
    v_mfma_f32_16x16x32_bf16 v[200:203], v[24:27], v[72:75], v[200:203]
    v_mfma_f32_16x16x32_bf16 v[204:207], v[24:27], v[76:79], v[204:207]
    v_mfma_f32_16x16x32_bf16 v[220:223], v[28:31], v[76:79], v[220:223]
    v_mfma_f32_16x16x32_bf16 v[216:219], v[28:31], v[72:75], v[216:219]
    v_mfma_f32_16x16x32_bf16 v[212:215], v[28:31], v[68:71], v[212:215]
    v_mfma_f32_16x16x32_bf16 v[208:211], v[28:31], v[64:67], v[208:211]
    s_waitcnt vmcnt(8) lgkmcnt(0)
    s_barrier
    s_add_u32 s71, s71, 32768
    s_cmp_eq_u32 s71, 98304
    s_cselect_b32 s71, 0, s71
    v_add_u32 v98, s71, v96
    v_add_u32 v99, s71, v97
    v_mfma_f32_16x16x32_bf16 v[128:131], v[80:83], v[36:39], v[128:131]
    ds_read_b64_tr_b16 v[8:9], v100 offset:32768
    v_mfma_f32_16x16x32_bf16 v[132:135], v[84:87], v[36:39], v[132:135]
    ds_read_b64_tr_b16 v[10:11], v100 offset:33280
    s_add_u32 m0, s77, 16384
    s_nop 0
    buffer_load_dwordx4 v107, s[32:35], s67 offen offset:0 lds
    v_mfma_f32_16x16x32_bf16 v[136:139], v[88:91], v[36:39], v[136:139]
    ds_read_b128 v[64:67], v98 offset:0
    v_mfma_f32_16x16x32_bf16 v[140:143], v[92:95], v[36:39], v[140:143]
    ds_read_b128 v[68:71], v98 offset:2048
    v_mfma_f32_16x16x32_bf16 v[156:159], v[92:95], v[40:43], v[156:159]
    ds_read_b128 v[72:75], v98 offset:4096
    buffer_load_dwordx4 v108, s[32:35], s67 offen offset:1024 lds
    v_mfma_f32_16x16x32_bf16 v[152:155], v[88:91], v[40:43], v[152:155]
    ds_read_b128 v[76:79], v98 offset:6144
    v_mfma_f32_16x16x32_bf16 v[148:151], v[84:87], v[40:43], v[148:151]
    ds_read_b64_tr_b16 v[12:13], v101 offset:32768
    v_mfma_f32_16x16x32_bf16 v[144:147], v[80:83], v[40:43], v[144:147]
    ds_read_b64_tr_b16 v[14:15], v101 offset:33280
    s_add_u32 s67, s67, s68
    s_add_u32 s69, s69, 128
    s_add_u32 s70, s70, 32768
    s_cmp_eq_u32 s70, 98304
    s_cselect_b32 s70, 0, s70
    s_add_u32 m0, s70, s78
    s_nop 0
    buffer_load_dwordx4 v105, s[28:31], s69 offen offset:0 lds
    v_mfma_f32_16x16x32_bf16 v[160:163], v[80:83], v[44:47], v[160:163]
    ds_read_b64_tr_b16 v[16:17], v100 offset:36864
    v_mfma_f32_16x16x32_bf16 v[164:167], v[84:87], v[44:47], v[164:167]
    ds_read_b64_tr_b16 v[18:19], v100 offset:37376
    v_mfma_f32_16x16x32_bf16 v[168:171], v[88:91], v[44:47], v[168:171]
    ds_read_b64_tr_b16 v[20:21], v101 offset:36864
    buffer_load_dwordx4 v106, s[28:31], s69 offen offset:1024 lds
    v_mfma_f32_16x16x32_bf16 v[172:175], v[92:95], v[44:47], v[172:175]
    ds_read_b64_tr_b16 v[22:23], v101 offset:37376
    v_mfma_f32_16x16x32_bf16 v[188:191], v[92:95], v[48:51], v[188:191]
    ds_read_b64_tr_b16 v[24:25], v102 offset:32768
    v_mfma_f32_16x16x32_bf16 v[184:187], v[88:91], v[48:51], v[184:187]
    ds_read_b64_tr_b16 v[26:27], v102 offset:33792
    s_sub_u32 s10, s10, 1
    s_cbranch_scc0 PFs6
    buffer_load_dword v3, v109, s[88:91], s84 offen
    s_mov_b32 s10, s3
    s_add_u32 s84, s84, 8192
    s_mov_b32 s3, 1000
PFs6:
    v_mfma_f32_16x16x32_bf16 v[180:183], v[84:87], v[48:51], v[180:183]
    ds_read_b64_tr_b16 v[28:29], v103 offset:32768
    v_mfma_f32_16x16x32_bf16 v[176:179], v[80:83], v[48:51], v[176:179]
    ds_read_b64_tr_b16 v[30:31], v103 offset:33792
    v_mfma_f32_16x16x32_bf16 v[192:195], v[52:55], v[80:83], v[192:195]
    v_mfma_f32_16x16x32_bf16 v[196:199], v[52:55], v[84:87], v[196:199]
    v_mfma_f32_16x16x32_bf16 v[200:203], v[52:55], v[88:91], v[200:203]
    v_mfma_f32_16x16x32_bf16 v[204:207], v[52:55], v[92:95], v[204:207]
    v_mfma_f32_16x16x32_bf16 v[220:223], v[56:59], v[92:95], v[220:223]
    v_mfma_f32_16x16x32_bf16 v[216:219], v[56:59], v[88:91], v[216:219]
    v_mfma_f32_16x16x32_bf16 v[212:215], v[56:59], v[84:87], v[212:215]
    v_mfma_f32_16x16x32_bf16 v[208:211], v[56:59], v[80:83], v[208:211]
    s_waitcnt vmcnt(8) lgkmcnt(0)
    s_barrier
    v_mfma_f32_16x16x32_bf16 v[128:131], v[64:67], v[8:11], v[128:131]
    ds_read_b64_tr_b16 v[36:37], v100 offset:49152
    v_mfma_f32_16x16x32_bf16 v[132:135], v[68:71], v[8:11], v[132:135]
    ds_read_b64_tr_b16 v[38:39], v100 offset:49664
    s_add_u32 m0, s77, 32768
    s_nop 0
    buffer_load_dwordx4 v107, s[32:35], s67 offen offset:0 lds
    v_mfma_f32_16x16x32_bf16 v[136:139], v[72:75], v[8:11], v[136:139]
    ds_read_b128 v[80:83], v99 offset:0
    v_mfma_f32_16x16x32_bf16 v[140:143], v[76:79], v[8:11], v[140:143]
    ds_read_b128 v[84:87], v99 offset:2048
    v_mfma_f32_16x16x32_bf16 v[156:159], v[76:79], v[12:15], v[156:159]
    ds_read_b128 v[88:91], v99 offset:4096
    buffer_load_dwordx4 v108, s[32:35], s67 offen offset:1024 lds
    v_mfma_f32_16x16x32_bf16 v[152:155], v[72:75], v[12:15], v[152:155]
    ds_read_b128 v[92:95], v99 offset:6144
    v_mfma_f32_16x16x32_bf16 v[148:151], v[68:71], v[12:15], v[148:151]
    ds_read_b64_tr_b16 v[40:41], v101 offset:49152
    v_mfma_f32_16x16x32_bf16 v[144:147], v[64:67], v[12:15], v[144:147]
    ds_read_b64_tr_b16 v[42:43], v101 offset:49664
    s_add_u32 s67, s67, s68
    s_add_u32 s73, s69, 262144
    s_add_u32 s74, s70, s78
    s_add_u32 m0, s74, 16384
    s_nop 0
    buffer_load_dwordx4 v105, s[28:31], s73 offen offset:0 lds
    v_mfma_f32_16x16x32_bf16 v[160:163], v[64:67], v[16:19], v[160:163]
    ds_read_b64_tr_b16 v[44:45], v100 offset:53248
    v_mfma_f32_16x16x32_bf16 v[164:167], v[68:71], v[16:19], v[164:167]
    ds_read_b64_tr_b16 v[46:47], v100 offset:53760
    v_mfma_f32_16x16x32_bf16 v[168:171], v[72:75], v[16:19], v[168:171]
    ds_read_b64_tr_b16 v[48:49], v101 offset:53248
    buffer_load_dwordx4 v106, s[28:31], s73 offen offset:1024 lds
    v_mfma_f32_16x16x32_bf16 v[172:175], v[76:79], v[16:19], v[172:175]
    ds_read_b64_tr_b16 v[50:51], v101 offset:53760
    v_mfma_f32_16x16x32_bf16 v[188:191], v[76:79], v[20:23], v[188:191]
    ds_read_b64_tr_b16 v[52:53], v102 offset:49152
    v_mfma_f32_16x16x32_bf16 v[184:187], v[72:75], v[20:23], v[184:187]
    ds_read_b64_tr_b16 v[54:55], v102 offset:50176
    s_sub_u32 s10, s10, 1
    s_cbranch_scc0 PFs7
    buffer_load_dword v3, v109, s[88:91], s84 offen
    s_mov_b32 s10, s3
    s_add_u32 s84, s84, 8192
    s_mov_b32 s3, 1000
PFs7:
    v_mfma_f32_16x16x32_bf16 v[180:183], v[68:71], v[20:23], v[180:183]
    ds_read_b64_tr_b16 v[56:57], v103 offset:49152
    v_mfma_f32_16x16x32_bf16 v[176:179], v[64:67], v[20:23], v[176:179]
    ds_read_b64_tr_b16 v[58:59], v103 offset:50176
    v_mfma_f32_16x16x32_bf16 v[192:195], v[24:27], v[64:67], v[192:195]
    v_mfma_f32_16x16x32_bf16 v[196:199], v[24:27], v[68:71], v[196:199]
    v_mfma_f32_16x16x32_bf16 v[200:203], v[24:27], v[72:75], v[200:203]
    v_mfma_f32_16x16x32_bf16 v[204:207], v[24:27], v[76:79], v[204:207]
    v_mfma_f32_16x16x32_bf16 v[220:223], v[28:31], v[76:79], v[220:223]
    v_mfma_f32_16x16x32_bf16 v[216:219], v[28:31], v[72:75], v[216:219]
    v_mfma_f32_16x16x32_bf16 v[212:215], v[28:31], v[68:71], v[212:215]
    v_mfma_f32_16x16x32_bf16 v[208:211], v[28:31], v[64:67], v[208:211]
    s_waitcnt vmcnt(8) lgkmcnt(0)
    s_barrier
    s_add_u32 s71, s71, 32768
    s_cmp_eq_u32 s71, 98304
    s_cselect_b32 s71, 0, s71
    v_add_u32 v98, s71, v96
    v_add_u32 v99, s71, v97
    v_mfma_f32_16x16x32_bf16 v[128:131], v[80:83], v[36:39], v[128:131]
    ds_read_b64_tr_b16 v[8:9], v100 offset:0
    v_mfma_f32_16x16x32_bf16 v[132:135], v[84:87], v[36:39], v[132:135]
    ds_read_b64_tr_b16 v[10:11], v100 offset:512
    s_add_u32 m0, s77, 49152
    s_nop 0
    buffer_load_dwordx4 v107, s[32:35], s67 offen offset:0 lds
    v_mfma_f32_16x16x32_bf16 v[136:139], v[88:91], v[36:39], v[136:139]
    ds_read_b128 v[64:67], v98 offset:0
    v_mfma_f32_16x16x32_bf16 v[140:143], v[92:95], v[36:39], v[140:143]
    ds_read_b128 v[68:71], v98 offset:2048
    v_mfma_f32_16x16x32_bf16 v[156:159], v[92:95], v[40:43], v[156:159]
    ds_read_b128 v[72:75], v98 offset:4096
    buffer_load_dwordx4 v108, s[32:35], s67 offen offset:1024 lds
    v_mfma_f32_16x16x32_bf16 v[152:155], v[88:91], v[40:43], v[152:155]
    ds_read_b128 v[76:79], v98 offset:6144
    v_mfma_f32_16x16x32_bf16 v[148:151], v[84:87], v[40:43], v[148:151]
    ds_read_b64_tr_b16 v[12:13], v101 offset:0
    v_mfma_f32_16x16x32_bf16 v[144:147], v[80:83], v[40:43], v[144:147]
    ds_read_b64_tr_b16 v[14:15], v101 offset:512
    s_add_u32 s67, s67, s68
    s_add_u32 s69, s69, 128
    s_add_u32 s70, s70, 32768
    s_cmp_eq_u32 s70, 98304
    s_cselect_b32 s70, 0, s70
    s_add_u32 m0, s70, s78
    s_nop 0
    buffer_load_dwordx4 v105, s[28:31], s69 offen offset:0 lds
    v_mfma_f32_16x16x32_bf16 v[160:163], v[80:83], v[44:47], v[160:163]
    ds_read_b64_tr_b16 v[16:17], v100 offset:4096
    v_mfma_f32_16x16x32_bf16 v[164:167], v[84:87], v[44:47], v[164:167]
    ds_read_b64_tr_b16 v[18:19], v100 offset:4608
    v_mfma_f32_16x16x32_bf16 v[168:171], v[88:91], v[44:47], v[168:171]
    ds_read_b64_tr_b16 v[20:21], v101 offset:4096
    buffer_load_dwordx4 v106, s[28:31], s69 offen offset:1024 lds
    v_mfma_f32_16x16x32_bf16 v[172:175], v[92:95], v[44:47], v[172:175]
    ds_read_b64_tr_b16 v[22:23], v101 offset:4608
    v_mfma_f32_16x16x32_bf16 v[188:191], v[92:95], v[48:51], v[188:191]
    ds_read_b64_tr_b16 v[24:25], v102 offset:0
    v_mfma_f32_16x16x32_bf16 v[184:187], v[88:91], v[48:51], v[184:187]
    ds_read_b64_tr_b16 v[26:27], v102 offset:1024
    s_sub_u32 s10, s10, 1
    s_cbranch_scc0 PFs8
    buffer_load_dword v3, v109, s[88:91], s84 offen
    s_mov_b32 s10, s3
    s_add_u32 s84, s84, 8192
    s_mov_b32 s3, 1000
PFs8:
    v_mfma_f32_16x16x32_bf16 v[180:183], v[84:87], v[48:51], v[180:183]
    ds_read_b64_tr_b16 v[28:29], v103 offset:0
    v_mfma_f32_16x16x32_bf16 v[176:179], v[80:83], v[48:51], v[176:179]
    ds_read_b64_tr_b16 v[30:31], v103 offset:1024
    v_mfma_f32_16x16x32_bf16 v[192:195], v[52:55], v[80:83], v[192:195]
    v_mfma_f32_16x16x32_bf16 v[196:199], v[52:55], v[84:87], v[196:199]
    v_mfma_f32_16x16x32_bf16 v[200:203], v[52:55], v[88:91], v[200:203]
    v_mfma_f32_16x16x32_bf16 v[204:207], v[52:55], v[92:95], v[204:207]
    v_mfma_f32_16x16x32_bf16 v[220:223], v[56:59], v[92:95], v[220:223]
    v_mfma_f32_16x16x32_bf16 v[216:219], v[56:59], v[88:91], v[216:219]
    v_mfma_f32_16x16x32_bf16 v[212:215], v[56:59], v[84:87], v[212:215]
    v_mfma_f32_16x16x32_bf16 v[208:211], v[56:59], v[80:83], v[208:211]
    s_waitcnt vmcnt(8) lgkmcnt(0)
    s_barrier
    s_add_u32 s72, s72, 1
    s_cmp_lt_u32 s72, 7
    s_cbranch_scc1 K1_v01_loop
    v_mfma_f32_16x16x32_bf16 v[128:131], v[64:67], v[8:11], v[128:131]
    ds_read_b64_tr_b16 v[36:37], v100 offset:16384
    v_mfma_f32_16x16x32_bf16 v[132:135], v[68:71], v[8:11], v[132:135]
    ds_read_b64_tr_b16 v[38:39], v100 offset:16896
    buffer_load_dwordx4 v[240:243], v113, s[28:31], s98 offen
    v_mfma_f32_16x16x32_bf16 v[136:139], v[72:75], v[8:11], v[136:139]
    ds_read_b128 v[80:83], v99 offset:0
    v_mfma_f32_16x16x32_bf16 v[140:143], v[76:79], v[8:11], v[140:143]
    ds_read_b128 v[84:87], v99 offset:2048
    v_mfma_f32_16x16x32_bf16 v[156:159], v[76:79], v[12:15], v[156:159]
    ds_read_b128 v[88:91], v99 offset:4096
    buffer_load_dwordx4 v[244:247], v113, s[28:31], s98 offen offset:1024
    v_mfma_f32_16x16x32_bf16 v[152:155], v[72:75], v[12:15], v[152:155]
    ds_read_b128 v[92:95], v99 offset:6144
    v_mfma_f32_16x16x32_bf16 v[148:151], v[68:71], v[12:15], v[148:151]
    ds_read_b64_tr_b16 v[40:41], v101 offset:16384
    v_mfma_f32_16x16x32_bf16 v[144:147], v[64:67], v[12:15], v[144:147]
    ds_read_b64_tr_b16 v[42:43], v101 offset:16896
    buffer_load_dwordx4 v[248:251], v113, s[52:55], 0 offen
    v_mfma_f32_16x16x32_bf16 v[160:163], v[64:67], v[16:19], v[160:163]
    ds_read_b64_tr_b16 v[44:45], v100 offset:20480
    v_mfma_f32_16x16x32_bf16 v[164:167], v[68:71], v[16:19], v[164:167]
    ds_read_b64_tr_b16 v[46:47], v100 offset:20992
    v_mfma_f32_16x16x32_bf16 v[168:171], v[72:75], v[16:19], v[168:171]
    ds_read_b64_tr_b16 v[48:49], v101 offset:20480
    buffer_load_dwordx4 v[252:255], v113, s[52:55], 0 offen offset:1024
    v_mfma_f32_16x16x32_bf16 v[172:175], v[76:79], v[16:19], v[172:175]
    ds_read_b64_tr_b16 v[50:51], v101 offset:20992
    v_mfma_f32_16x16x32_bf16 v[188:191], v[76:79], v[20:23], v[188:191]
    ds_read_b64_tr_b16 v[52:53], v102 offset:16384
    v_mfma_f32_16x16x32_bf16 v[184:187], v[72:75], v[20:23], v[184:187]
    ds_read_b64_tr_b16 v[54:55], v102 offset:17408
    buffer_load_dword v110, off, s[40:43], 0 sc1
    v_mfma_f32_16x16x32_bf16 v[180:183], v[68:71], v[20:23], v[180:183]
    ds_read_b64_tr_b16 v[56:57], v103 offset:16384
    v_mfma_f32_16x16x32_bf16 v[176:179], v[64:67], v[20:23], v[176:179]
    ds_read_b64_tr_b16 v[58:59], v103 offset:17408
    v_mfma_f32_16x16x32_bf16 v[192:195], v[24:27], v[64:67], v[192:195]
    s_lshl_b32 s75, s93, 3
    s_add_u32 s75, s75, s59
    s_lshl_b32 s75, s75, 7
    s_add_u32 s75, s75, 38797312
    s_lshl_b32 s76, s57, 7
    s_add_u32 s76, s76, 19988480
    v_mov_b32 v6, s76
    v_writelane_b32 v6, s75, 0
    v_writelane_b32 v6, s100, 1
    v_writelane_b32 v6, s87, 2
    buffer_load_dword v3, v6, s[36:39], 0 offen sc1
    v_mfma_f32_16x16x32_bf16 v[196:199], v[24:27], v[68:71], v[196:199]
    v_mfma_f32_16x16x32_bf16 v[200:203], v[24:27], v[72:75], v[200:203]
    v_mfma_f32_16x16x32_bf16 v[204:207], v[24:27], v[76:79], v[204:207]
    v_mfma_f32_16x16x32_bf16 v[220:223], v[28:31], v[76:79], v[220:223]
    v_mfma_f32_16x16x32_bf16 v[216:219], v[28:31], v[72:75], v[216:219]
    v_mfma_f32_16x16x32_bf16 v[212:215], v[28:31], v[68:71], v[212:215]
    v_mfma_f32_16x16x32_bf16 v[208:211], v[28:31], v[64:67], v[208:211]
    s_waitcnt vmcnt(10) lgkmcnt(0)
    s_barrier
    s_add_u32 s71, s71, 32768
    s_cmp_eq_u32 s71, 98304
    s_cselect_b32 s71, 0, s71
    v_add_u32 v98, s71, v96
    v_add_u32 v99, s71, v97
    v_mfma_f32_16x16x32_bf16 v[128:131], v[80:83], v[36:39], v[128:131]
    ds_read_b64_tr_b16 v[8:9], v100 offset:32768
    v_mfma_f32_16x16x32_bf16 v[132:135], v[84:87], v[36:39], v[132:135]
    ds_read_b64_tr_b16 v[10:11], v100 offset:33280
    v_mfma_f32_16x16x32_bf16 v[136:139], v[88:91], v[36:39], v[136:139]
    ds_read_b128 v[64:67], v98 offset:0
    v_mfma_f32_16x16x32_bf16 v[140:143], v[92:95], v[36:39], v[140:143]
    ds_read_b128 v[68:71], v98 offset:2048
    v_mfma_f32_16x16x32_bf16 v[156:159], v[92:95], v[40:43], v[156:159]
    ds_read_b128 v[72:75], v98 offset:4096
    v_mfma_f32_16x16x32_bf16 v[152:155], v[88:91], v[40:43], v[152:155]
    ds_read_b128 v[76:79], v98 offset:6144
    v_mfma_f32_16x16x32_bf16 v[148:151], v[84:87], v[40:43], v[148:151]
    ds_read_b64_tr_b16 v[12:13], v101 offset:32768
    v_mfma_f32_16x16x32_bf16 v[144:147], v[80:83], v[40:43], v[144:147]
    ds_read_b64_tr_b16 v[14:15], v101 offset:33280
    v_mfma_f32_16x16x32_bf16 v[160:163], v[80:83], v[44:47], v[160:163]
    ds_read_b64_tr_b16 v[16:17], v100 offset:36864
    v_mfma_f32_16x16x32_bf16 v[164:167], v[84:87], v[44:47], v[164:167]
    ds_read_b64_tr_b16 v[18:19], v100 offset:37376
    v_mfma_f32_16x16x32_bf16 v[168:171], v[88:91], v[44:47], v[168:171]
    ds_read_b64_tr_b16 v[20:21], v101 offset:36864
    v_mfma_f32_16x16x32_bf16 v[172:175], v[92:95], v[44:47], v[172:175]
    ds_read_b64_tr_b16 v[22:23], v101 offset:37376
    v_mfma_f32_16x16x32_bf16 v[188:191], v[92:95], v[48:51], v[188:191]
    ds_read_b64_tr_b16 v[24:25], v102 offset:32768
    v_mfma_f32_16x16x32_bf16 v[184:187], v[88:91], v[48:51], v[184:187]
    ds_read_b64_tr_b16 v[26:27], v102 offset:33792
    v_mfma_f32_16x16x32_bf16 v[180:183], v[84:87], v[48:51], v[180:183]
    ds_read_b64_tr_b16 v[28:29], v103 offset:32768
    v_mfma_f32_16x16x32_bf16 v[176:179], v[80:83], v[48:51], v[176:179]
    ds_read_b64_tr_b16 v[30:31], v103 offset:33792
    v_mfma_f32_16x16x32_bf16 v[192:195], v[52:55], v[80:83], v[192:195]
    v_mfma_f32_16x16x32_bf16 v[196:199], v[52:55], v[84:87], v[196:199]
    v_mfma_f32_16x16x32_bf16 v[200:203], v[52:55], v[88:91], v[200:203]
    v_mfma_f32_16x16x32_bf16 v[204:207], v[52:55], v[92:95], v[204:207]
    v_mfma_f32_16x16x32_bf16 v[220:223], v[56:59], v[92:95], v[220:223]
    v_mfma_f32_16x16x32_bf16 v[216:219], v[56:59], v[88:91], v[216:219]
    v_mfma_f32_16x16x32_bf16 v[212:215], v[56:59], v[84:87], v[212:215]
    v_mfma_f32_16x16x32_bf16 v[208:211], v[56:59], v[80:83], v[208:211]
    s_waitcnt vmcnt(0) lgkmcnt(0)
    s_barrier
    v_mfma_f32_16x16x32_bf16 v[128:131], v[64:67], v[8:11], v[128:131]
    ds_read_b64_tr_b16 v[36:37], v100 offset:49152
    v_mov_b32 v5, 0
    v_dot2_f32_bf16 v5, v240, v248, v5
    v_mfma_f32_16x16x32_bf16 v[132:135], v[68:71], v[8:11], v[132:135]
    ds_read_b64_tr_b16 v[38:39], v100 offset:49664
    v_dot2_f32_bf16 v5, v241, v249, v5
    v_dot2_f32_bf16 v5, v242, v250, v5
    v_mfma_f32_16x16x32_bf16 v[136:139], v[72:75], v[8:11], v[136:139]
    ds_read_b128 v[80:83], v99 offset:0
    v_dot2_f32_bf16 v5, v243, v251, v5
    v_dot2_f32_bf16 v5, v244, v252, v5
    v_mfma_f32_16x16x32_bf16 v[140:143], v[76:79], v[8:11], v[140:143]
    ds_read_b128 v[84:87], v99 offset:2048
    v_dot2_f32_bf16 v5, v245, v253, v5
    v_dot2_f32_bf16 v5, v246, v254, v5
    v_mfma_f32_16x16x32_bf16 v[156:159], v[76:79], v[12:15], v[156:159]
    ds_read_b128 v[88:91], v99 offset:4096
    v_dot2_f32_bf16 v5, v247, v255, v5
    s_nop 2
    v_mfma_f32_16x16x32_bf16 v[152:155], v[72:75], v[12:15], v[152:155]
    ds_read_b128 v[92:95], v99 offset:6144
    v_add_f32_dpp v5, v5, v5 row_shr:1 row_mask:0xf bank_mask:0xf bound_ctrl:0
    s_nop 1
    v_add_f32_dpp v5, v5, v5 row_shr:2 row_mask:0xf bank_mask:0xf bound_ctrl:0
    v_mfma_f32_16x16x32_bf16 v[148:151], v[68:71], v[12:15], v[148:151]
    ds_read_b64_tr_b16 v[40:41], v101 offset:49152
    v_add_f32_dpp v5, v5, v5 row_shr:4 row_mask:0xf bank_mask:0xf bound_ctrl:0
    s_nop 1
    v_add_f32_dpp v5, v5, v5 row_shr:8 row_mask:0xf bank_mask:0xf bound_ctrl:0
    v_mfma_f32_16x16x32_bf16 v[144:147], v[64:67], v[12:15], v[144:147]
    ds_read_b64_tr_b16 v[42:43], v101 offset:49664
    v_add_f32_dpp v5, v5, v5 row_bcast:15 row_mask:0xa bank_mask:0xf
    s_nop 1
    v_add_f32_dpp v5, v5, v5 row_bcast:31 row_mask:0xc bank_mask:0xf
    v_mfma_f32_16x16x32_bf16 v[160:163], v[64:67], v[16:19], v[160:163]
    ds_read_b64_tr_b16 v[44:45], v100 offset:53248
    v_mov_b32 v6, 0x42200000
    v_med3_f32 v5, v5, -v6, v6
    v_mfma_f32_16x16x32_bf16 v[164:167], v[68:71], v[16:19], v[164:167]
    ds_read_b64_tr_b16 v[46:47], v100 offset:53760
    v_mul_f32 v5, s80, v5
    v_exp_f32 v5, v5
    v_mfma_f32_16x16x32_bf16 v[168:171], v[72:75], v[16:19], v[168:171]
    ds_read_b64_tr_b16 v[48:49], v101 offset:53248
    v_readlane_b32 s76, v5, 63
    s_nop 1
    v_mov_b32 v5, s76
    v_mfma_f32_16x16x32_bf16 v[172:175], v[76:79], v[16:19], v[172:175]
    ds_read_b64_tr_b16 v[50:51], v101 offset:53760
    buffer_store_dword v5, off, s[36:39], s87 sc1
    v_mfma_f32_16x16x32_bf16 v[188:191], v[76:79], v[20:23], v[188:191]
    ds_read_b64_tr_b16 v[52:53], v102 offset:49152
    v_mfma_f32_16x16x32_bf16 v[184:187], v[72:75], v[20:23], v[184:187]
    ds_read_b64_tr_b16 v[54:55], v102 offset:50176
    v_mfma_f32_16x16x32_bf16 v[180:183], v[68:71], v[20:23], v[180:183]
    ds_read_b64_tr_b16 v[56:57], v103 offset:49152
    v_mfma_f32_16x16x32_bf16 v[176:179], v[64:67], v[20:23], v[176:179]
    ds_read_b64_tr_b16 v[58:59], v103 offset:50176
    v_mfma_f32_16x16x32_bf16 v[192:195], v[24:27], v[64:67], v[192:195]
    v_mfma_f32_16x16x32_bf16 v[196:199], v[24:27], v[68:71], v[196:199]
    v_mfma_f32_16x16x32_bf16 v[200:203], v[24:27], v[72:75], v[200:203]
    v_mfma_f32_16x16x32_bf16 v[204:207], v[24:27], v[76:79], v[204:207]
    v_mfma_f32_16x16x32_bf16 v[220:223], v[28:31], v[76:79], v[220:223]
    v_mfma_f32_16x16x32_bf16 v[216:219], v[28:31], v[72:75], v[216:219]
    v_mfma_f32_16x16x32_bf16 v[212:215], v[28:31], v[68:71], v[212:215]
    v_mfma_f32_16x16x32_bf16 v[208:211], v[28:31], v[64:67], v[208:211]
    s_waitcnt vmcnt(63) lgkmcnt(0)
    s_barrier
    v_mfma_f32_16x16x32_bf16 v[128:131], v[80:83], v[36:39], v[128:131]
    v_mfma_f32_16x16x32_bf16 v[132:135], v[84:87], v[36:39], v[132:135]
    s_add_u32 m0, s101, 0
    s_add_u32 s73, s97, 262144
    buffer_load_dwordx4 v114, s[44:47], s73 offen lds
    s_add_u32 m0, s101, 8192
    s_add_u32 s73, s97, 327680
    buffer_load_dwordx4 v114, s[44:47], s73 offen lds
    v_mfma_f32_16x16x32_bf16 v[136:139], v[88:91], v[36:39], v[136:139]
    v_mfma_f32_16x16x32_bf16 v[140:143], v[92:95], v[36:39], v[140:143]
    v_mfma_f32_16x16x32_bf16 v[156:159], v[92:95], v[40:43], v[156:159]
    s_add_u32 m0, s101, 16384
    s_add_u32 s73, s97, 524288
    buffer_load_dwordx4 v114, s[44:47], s73 offen lds
    s_add_u32 m0, s101, 24576
    s_add_u32 s73, s97, 589824
    buffer_load_dwordx4 v114, s[44:47], s73 offen lds
    v_mfma_f32_16x16x32_bf16 v[152:155], v[88:91], v[40:43], v[152:155]
    v_mfma_f32_16x16x32_bf16 v[148:151], v[84:87], v[40:43], v[148:151]
    v_mfma_f32_16x16x32_bf16 v[144:147], v[80:83], v[40:43], v[144:147]
    s_add_u32 m0, s101, 32768
    s_add_u32 s73, s97, 1179648
    buffer_load_dwordx4 v114, s[44:47], s73 offen lds
    s_add_u32 m0, s101, 40960
    s_add_u32 s73, s97, 1245184
    buffer_load_dwordx4 v114, s[44:47], s73 offen lds
    v_mfma_f32_16x16x32_bf16 v[160:163], v[80:83], v[44:47], v[160:163]
    v_mfma_f32_16x16x32_bf16 v[164:167], v[84:87], v[44:47], v[164:167]
    v_mfma_f32_16x16x32_bf16 v[168:171], v[88:91], v[44:47], v[168:171]
    s_add_u32 m0, s101, 49152
    s_add_u32 s73, s97, 1441792
    buffer_load_dwordx4 v114, s[44:47], s73 offen lds
    s_add_u32 m0, s101, 57344
    s_add_u32 s73, s97, 1507328
    buffer_load_dwordx4 v114, s[44:47], s73 offen lds
    v_mfma_f32_16x16x32_bf16 v[172:175], v[92:95], v[44:47], v[172:175]
    v_mfma_f32_16x16x32_bf16 v[188:191], v[92:95], v[48:51], v[188:191]
    v_mfma_f32_16x16x32_bf16 v[184:187], v[88:91], v[48:51], v[184:187]
    s_add_u32 m0, s101, 65536
    s_add_u32 s73, s97, 196608
    buffer_load_dwordx4 v114, s[44:47], s73 offen lds
    s_add_u32 m0, s101, 73728
    s_add_u32 s73, s97, 393216
    buffer_load_dwordx4 v114, s[44:47], s73 offen lds
    v_mfma_f32_16x16x32_bf16 v[180:183], v[84:87], v[48:51], v[180:183]
    v_mfma_f32_16x16x32_bf16 v[176:179], v[80:83], v[48:51], v[176:179]
    v_mfma_f32_16x16x32_bf16 v[192:195], v[52:55], v[80:83], v[192:195]
    s_add_u32 m0, s101, 81920
    s_add_u32 s73, s97, 458752
    buffer_load_dwordx4 v114, s[44:47], s73 offen lds
    s_add_u32 m0, s101, 90112
    s_add_u32 s73, s97, 655360
    buffer_load_dwordx4 v114, s[44:47], s73 offen lds
    v_mfma_f32_16x16x32_bf16 v[196:199], v[52:55], v[84:87], v[196:199]
    v_mfma_f32_16x16x32_bf16 v[200:203], v[52:55], v[88:91], v[200:203]
    v_mfma_f32_16x16x32_bf16 v[204:207], v[52:55], v[92:95], v[204:207]
    s_add_u32 m0, s101, 98304
    s_add_u32 s73, s97, 1114112
    buffer_load_dwordx4 v114, s[44:47], s73 offen lds
    s_add_u32 m0, s101, 106496
    s_add_u32 s73, s97, 1310720
    buffer_load_dwordx4 v114, s[44:47], s73 offen lds
    v_mfma_f32_16x16x32_bf16 v[220:223], v[56:59], v[92:95], v[220:223]
    v_mfma_f32_16x16x32_bf16 v[216:219], v[56:59], v[88:91], v[216:219]
    v_mfma_f32_16x16x32_bf16 v[212:215], v[56:59], v[84:87], v[212:215]
    v_mfma_f32_16x16x32_bf16 v[208:211], v[56:59], v[80:83], v[208:211]
    s_setprio 2
    s_nop 7
    v_pk_mul_f32 v[240:241], v[128:129], s[80:81] op_sel_hi:[1,0]
    v_pk_mul_f32 v[242:243], v[130:131], s[80:81] op_sel_hi:[1,0]
    v_min_f32 v240, 0, v240
    v_min_f32 v241, 0, v241
    v_min_f32 v242, 0, v242
    v_min_f32 v243, 0, v243
    v_exp_f32 v240, v240
    v_exp_f32 v241, v241
    v_exp_f32 v242, v242
    v_exp_f32 v243, v243
    v_max_f32 v128, 0, v128
    v_max_f32 v129, 0, v129
    v_max_f32 v130, 0, v130
    v_max_f32 v131, 0, v131
    v_pk_add_f32 v[128:129], v[128:129], v[240:241]
    v_pk_add_f32 v[130:131], v[130:131], v[242:243]
    v_add_f32 v128, s86, v128
    v_add_f32 v129, s86, v129
    v_add_f32 v130, s86, v130
    v_add_f32 v131, s86, v131
    v_pk_mul_f32 v[244:245], v[132:133], s[80:81] op_sel_hi:[1,0]
    v_pk_mul_f32 v[246:247], v[134:135], s[80:81] op_sel_hi:[1,0]
    v_min_f32 v244, 0, v244
    v_min_f32 v245, 0, v245
    v_min_f32 v246, 0, v246
    v_min_f32 v247, 0, v247
    v_exp_f32 v244, v244
    v_exp_f32 v245, v245
    v_exp_f32 v246, v246
    v_exp_f32 v247, v247
    v_max_f32 v132, 0, v132
    v_max_f32 v133, 0, v133
    v_max_f32 v134, 0, v134
    v_max_f32 v135, 0, v135
    v_pk_add_f32 v[132:133], v[132:133], v[244:245]
    v_pk_add_f32 v[134:135], v[134:135], v[246:247]
    v_add_f32 v132, s86, v132
    v_add_f32 v133, s86, v133
    v_add_f32 v134, s86, v134
    v_add_f32 v135, s86, v135
    v_pk_mul_f32 v[240:241], v[136:137], s[80:81] op_sel_hi:[1,0]
    v_pk_mul_f32 v[242:243], v[138:139], s[80:81] op_sel_hi:[1,0]
    v_min_f32 v240, 0, v240
    v_min_f32 v241, 0, v241
    v_min_f32 v242, 0, v242
    v_min_f32 v243, 0, v243
    v_exp_f32 v240, v240
    v_exp_f32 v241, v241
    v_exp_f32 v242, v242
    v_exp_f32 v243, v243
    v_max_f32 v136, 0, v136
    v_max_f32 v137, 0, v137
    v_max_f32 v138, 0, v138
    v_max_f32 v139, 0, v139
    v_pk_add_f32 v[136:137], v[136:137], v[240:241]
    v_pk_add_f32 v[138:139], v[138:139], v[242:243]
    v_add_f32 v136, s86, v136
    v_add_f32 v137, s86, v137
    v_add_f32 v138, s86, v138
    v_add_f32 v139, s86, v139
    v_pk_mul_f32 v[244:245], v[140:141], s[80:81] op_sel_hi:[1,0]
    v_pk_mul_f32 v[246:247], v[142:143], s[80:81] op_sel_hi:[1,0]
    v_min_f32 v244, 0, v244
    v_min_f32 v245, 0, v245
    v_min_f32 v246, 0, v246
    v_min_f32 v247, 0, v247
    v_exp_f32 v244, v244
    v_exp_f32 v245, v245
    v_exp_f32 v246, v246
    v_exp_f32 v247, v247
    v_max_f32 v140, 0, v140
    v_max_f32 v141, 0, v141
    v_max_f32 v142, 0, v142
    v_max_f32 v143, 0, v143
    v_pk_add_f32 v[140:141], v[140:141], v[244:245]
    v_pk_add_f32 v[142:143], v[142:143], v[246:247]
    v_add_f32 v140, s86, v140
    v_add_f32 v141, s86, v141
    v_add_f32 v142, s86, v142
    v_add_f32 v143, s86, v143
    v_pk_mul_f32 v[240:241], v[144:145], s[80:81] op_sel_hi:[1,0]
    v_pk_mul_f32 v[242:243], v[146:147], s[80:81] op_sel_hi:[1,0]
    v_min_f32 v240, 0, v240
    v_min_f32 v241, 0, v241
    v_min_f32 v242, 0, v242
    v_min_f32 v243, 0, v243
    v_exp_f32 v240, v240
    v_exp_f32 v241, v241
    v_exp_f32 v242, v242
    v_exp_f32 v243, v243
    v_max_f32 v144, 0, v144
    v_max_f32 v145, 0, v145
    v_max_f32 v146, 0, v146
    v_max_f32 v147, 0, v147
    v_pk_add_f32 v[144:145], v[144:145], v[240:241]
    v_pk_add_f32 v[146:147], v[146:147], v[242:243]
    v_add_f32 v144, s86, v144
    v_add_f32 v145, s86, v145
    v_add_f32 v146, s86, v146
    v_add_f32 v147, s86, v147
    v_pk_mul_f32 v[244:245], v[148:149], s[80:81] op_sel_hi:[1,0]
    v_pk_mul_f32 v[246:247], v[150:151], s[80:81] op_sel_hi:[1,0]
    v_min_f32 v244, 0, v244
    v_min_f32 v245, 0, v245
    v_min_f32 v246, 0, v246
    v_min_f32 v247, 0, v247
    v_exp_f32 v244, v244
    v_exp_f32 v245, v245
    v_exp_f32 v246, v246
    v_exp_f32 v247, v247
    v_max_f32 v148, 0, v148
    v_max_f32 v149, 0, v149
    v_max_f32 v150, 0, v150
    v_max_f32 v151, 0, v151
    v_pk_add_f32 v[148:149], v[148:149], v[244:245]
    v_pk_add_f32 v[150:151], v[150:151], v[246:247]
    v_add_f32 v148, s86, v148
    v_add_f32 v149, s86, v149
    v_add_f32 v150, s86, v150
    v_add_f32 v151, s86, v151
    v_pk_mul_f32 v[240:241], v[152:153], s[80:81] op_sel_hi:[1,0]
    v_pk_mul_f32 v[242:243], v[154:155], s[80:81] op_sel_hi:[1,0]
    v_min_f32 v240, 0, v240
    v_min_f32 v241, 0, v241
    v_min_f32 v242, 0, v242
    v_min_f32 v243, 0, v243
    v_exp_f32 v240, v240
    v_exp_f32 v241, v241
    v_exp_f32 v242, v242
    v_exp_f32 v243, v243
    v_max_f32 v152, 0, v152
    v_max_f32 v153, 0, v153
    v_max_f32 v154, 0, v154
    v_max_f32 v155, 0, v155
    v_pk_add_f32 v[152:153], v[152:153], v[240:241]
    v_pk_add_f32 v[154:155], v[154:155], v[242:243]
    v_add_f32 v152, s86, v152
    v_add_f32 v153, s86, v153
    v_add_f32 v154, s86, v154
    v_add_f32 v155, s86, v155
    v_pk_mul_f32 v[244:245], v[156:157], s[80:81] op_sel_hi:[1,0]
    v_pk_mul_f32 v[246:247], v[158:159], s[80:81] op_sel_hi:[1,0]
    v_min_f32 v244, 0, v244
    v_min_f32 v245, 0, v245
    v_min_f32 v246, 0, v246
    v_min_f32 v247, 0, v247
    v_exp_f32 v244, v244
    v_exp_f32 v245, v245
    v_exp_f32 v246, v246
    v_exp_f32 v247, v247
    v_max_f32 v156, 0, v156
    v_max_f32 v157, 0, v157
    v_max_f32 v158, 0, v158
    v_max_f32 v159, 0, v159
    v_pk_add_f32 v[156:157], v[156:157], v[244:245]
    v_pk_add_f32 v[158:159], v[158:159], v[246:247]
    v_add_f32 v156, s86, v156
    v_add_f32 v157, s86, v157
    v_add_f32 v158, s86, v158
    v_add_f32 v159, s86, v159
    v_mov_b32 v40, 0x3f803f80
    v_mov_b32 v41, 0x3f803f80
    v_mov_b32 v42, 0x3f803f80
    v_mov_b32 v43, 0x3f803f80
    v_cvt_pk_bf16_f32 v24, v160, v161
    v_cvt_pk_bf16_f32 v25, v162, v163
    v_cvt_pk_bf16_f32 v26, v164, v165
    v_cvt_pk_bf16_f32 v27, v166, v167
    v_cvt_pk_bf16_f32 v28, v168, v169
    v_cvt_pk_bf16_f32 v29, v170, v171
    v_cvt_pk_bf16_f32 v30, v172, v173
    v_cvt_pk_bf16_f32 v31, v174, v175
    v_cvt_pk_bf16_f32 v32, v176, v177
    v_cvt_pk_bf16_f32 v33, v178, v179
    v_cvt_pk_bf16_f32 v34, v180, v181
    v_cvt_pk_bf16_f32 v35, v182, v183
    v_cvt_pk_bf16_f32 v36, v184, v185
    v_cvt_pk_bf16_f32 v37, v186, v187
    v_cvt_pk_bf16_f32 v38, v188, v189
    v_cvt_pk_bf16_f32 v39, v190, v191
    v_cvt_pk_bf16_f32 v8, v128, v129
    v_cvt_pk_bf16_f32 v9, v130, v131
    v_cvt_pk_bf16_f32 v10, v132, v133
    v_cvt_pk_bf16_f32 v11, v134, v135
    v_cvt_pk_bf16_f32 v12, v136, v137
    v_cvt_pk_bf16_f32 v13, v138, v139
    v_cvt_pk_bf16_f32 v14, v140, v141
    v_cvt_pk_bf16_f32 v15, v142, v143
    v_cvt_pk_bf16_f32 v16, v144, v145
    v_cvt_pk_bf16_f32 v17, v146, v147
    v_cvt_pk_bf16_f32 v18, v148, v149
    v_cvt_pk_bf16_f32 v19, v150, v151
    v_cvt_pk_bf16_f32 v20, v152, v153
    v_cvt_pk_bf16_f32 v21, v154, v155
    v_cvt_pk_bf16_f32 v22, v156, v157
    v_cvt_pk_bf16_f32 v23, v158, v159
    v_mfma_f32_16x16x32_bf16 v[44:47], v[8:11], v[24:27], 0
    v_mfma_f32_16x16x32_bf16 v[48:51], v[16:19], v[24:27], 0
    v_mfma_f32_16x16x32_bf16 v[52:55], v[8:11], v[32:35], 0
    v_mfma_f32_16x16x32_bf16 v[56:59], v[16:19], v[32:35], 0
    v_mfma_f32_16x16x32_bf16 v[60:63], v[8:11], v[40:43], 0
    v_mfma_f32_16x16x32_bf16 v[64:67], v[16:19], v[40:43], 0
    v_mfma_f32_16x16x32_bf16 v[44:47], v[12:15], v[28:31], v[44:47]
    v_mfma_f32_16x16x32_bf16 v[48:51], v[20:23], v[28:31], v[48:51]
    v_mfma_f32_16x16x32_bf16 v[52:55], v[12:15], v[36:39], v[52:55]
    v_mfma_f32_16x16x32_bf16 v[56:59], v[20:23], v[36:39], v[56:59]
    v_mfma_f32_16x16x32_bf16 v[60:63], v[12:15], v[40:43], v[60:63]
    v_mfma_f32_16x16x32_bf16 v[64:67], v[20:23], v[40:43], v[64:67]
    s_mul_i32 s73, s59, 6144
    s_add_u32 s73, s73, 114688
    v_add_u32 v116, s73, v113
    ds_write_b128 v116, v[44:47] offset:0
    ds_write_b128 v116, v[48:51] offset:1024
    ds_write_b128 v116, v[52:55] offset:2048
    ds_write_b128 v116, v[56:59] offset:3072
    ds_write_b128 v116, v[60:63] offset:4096
    ds_write_b128 v116, v[64:67] offset:5120
    s_waitcnt lgkmcnt(0)
    s_barrier
    s_cmp_lg_u32 s60, 0
    s_cbranch_scc1 K1_v01_nosum
    ds_read_b128 v[68:71], v116 offset:6144
    ds_read_b128 v[72:75], v116 offset:7168
    ds_read_b128 v[76:79], v116 offset:8192
    ds_read_b128 v[80:83], v116 offset:9216
    ds_read_b128 v[84:87], v116 offset:10240
    ds_read_b128 v[88:91], v116 offset:11264
    ds_read_b128 v[8:11], v116 offset:12288
    ds_read_b128 v[12:15], v116 offset:13312
    ds_read_b128 v[16:19], v116 offset:14336
    ds_read_b128 v[20:23], v116 offset:15360
    ds_read_b128 v[24:27], v116 offset:16384
    ds_read_b128 v[28:31], v116 offset:17408
    ds_read_b128 v[128:131], v116 offset:18432
    ds_read_b128 v[132:135], v116 offset:19456
    ds_read_b128 v[136:139], v116 offset:20480
    ds_read_b128 v[140:143], v116 offset:21504
    ds_read_b128 v[144:147], v116 offset:22528
    ds_read_b128 v[148:151], v116 offset:23552
    s_lshl_b32 s73, s82, 3
    s_add_u32 s73, s73, s56
    s_mul_i32 s74, s73, 6144
    s_add_u32 s74, s74, 20971520
    s_add_u32 s76, s74, 4096
    s_waitcnt lgkmcnt(12)
    v_pk_add_f32 v[44:45], v[44:45], v[68:69]
    v_pk_add_f32 v[46:47], v[46:47], v[70:71]
    v_pk_add_f32 v[48:49], v[48:49], v[72:73]
    v_pk_add_f32 v[50:51], v[50:51], v[74:75]
    v_pk_add_f32 v[52:53], v[52:53], v[76:77]
    v_pk_add_f32 v[54:55], v[54:55], v[78:79]
    v_pk_add_f32 v[56:57], v[56:57], v[80:81]
    v_pk_add_f32 v[58:59], v[58:59], v[82:83]
    v_pk_add_f32 v[60:61], v[60:61], v[84:85]
    v_pk_add_f32 v[62:63], v[62:63], v[86:87]
    v_pk_add_f32 v[64:65], v[64:65], v[88:89]
    v_pk_add_f32 v[66:67], v[66:67], v[90:91]
    s_waitcnt lgkmcnt(6)
    v_pk_add_f32 v[44:45], v[44:45], v[8:9]
    v_pk_add_f32 v[46:47], v[46:47], v[10:11]
    v_pk_add_f32 v[48:49], v[48:49], v[12:13]
    v_pk_add_f32 v[50:51], v[50:51], v[14:15]
    v_pk_add_f32 v[52:53], v[52:53], v[16:17]
    v_pk_add_f32 v[54:55], v[54:55], v[18:19]
    v_pk_add_f32 v[56:57], v[56:57], v[20:21]
    v_pk_add_f32 v[58:59], v[58:59], v[22:23]
    v_pk_add_f32 v[60:61], v[60:61], v[24:25]
    v_pk_add_f32 v[62:63], v[62:63], v[26:27]
    v_pk_add_f32 v[64:65], v[64:65], v[28:29]
    v_pk_add_f32 v[66:67], v[66:67], v[30:31]
    s_waitcnt lgkmcnt(0)
    v_pk_add_f32 v[44:45], v[44:45], v[128:129]
    v_pk_add_f32 v[46:47], v[46:47], v[130:131]
    v_pk_add_f32 v[48:49], v[48:49], v[132:133]
    v_pk_add_f32 v[50:51], v[50:51], v[134:135]
    v_pk_add_f32 v[52:53], v[52:53], v[136:137]
    v_pk_add_f32 v[54:55], v[54:55], v[138:139]
    v_pk_add_f32 v[56:57], v[56:57], v[140:141]
    v_pk_add_f32 v[58:59], v[58:59], v[142:143]
    v_pk_add_f32 v[60:61], v[60:61], v[144:145]
    v_pk_add_f32 v[62:63], v[62:63], v[146:147]
    v_pk_add_f32 v[64:65], v[64:65], v[148:149]
    v_pk_add_f32 v[66:67], v[66:67], v[150:151]
    buffer_store_dwordx4 v[44:47], v113, s[36:39], s74 offen offset:0 sc1
    buffer_store_dwordx4 v[48:51], v113, s[36:39], s74 offen offset:1024 sc1
    buffer_store_dwordx4 v[52:55], v113, s[36:39], s74 offen offset:2048 sc1
    buffer_store_dwordx4 v[56:59], v113, s[36:39], s74 offen offset:3072 sc1
    buffer_store_dwordx4 v[60:63], v113, s[36:39], s76 offen offset:0 sc1
    buffer_store_dwordx4 v[64:67], v113, s[36:39], s76 offen offset:1024 sc1
    s_lshl_b32 s73, s57, 7
    s_lshl_b32 s74, s56, 2
    s_add_u32 s73, s73, s74
    s_add_u32 s73, s73, 19988512
    s_waitcnt vmcnt(0)
    s_mov_b32 s79, 0
K1_v01a_nchk:
    v_readfirstlane_b32 s83, v110
    s_nop 1
    s_cmp_lg_u32 s83, 0
    s_cbranch_scc1 K1_v01a_nok
    s_sleep 8
    buffer_load_dword v110, off, s[40:43], 0 sc1
    s_add_u32 s79, s79, 1
    s_waitcnt vmcnt(0)
    s_cmp_lt_u32 s79, 100000
    s_cbranch_scc1 K1_v01a_nchk
K1_v01a_nok:
    buffer_store_dword v110, off, s[36:39], s73 sc1
K1_v01_nosum:
    s_add_u32 s75, s63, 0
    s_lshr_b32 s75, s75, 1
    s_lshl_b32 s75, s75, 10
    s_add_u32 s75, s75, s92
    v_pk_mul_f32 v[240:241], v[192:193], s[80:81] op_sel_hi:[1,0]
    v_pk_mul_f32 v[242:243], v[194:195], s[80:81] op_sel_hi:[1,0]
    v_exp_f32 v240, v240
    v_exp_f32 v241, v241
    v_exp_f32 v242, v242
    v_exp_f32 v243, v243
    v_pk_fma_f32 v[244:245], v[240:241], -0.5, -1.0 op_sel_hi:[1,0,0]
    v_pk_fma_f32 v[246:247], v[242:243], -0.5, -1.0 op_sel_hi:[1,0,0]
    v_pk_fma_f32 v[244:245], v[240:241], v[244:245], -1.0 op_sel_hi:[1,1,0]
    v_pk_fma_f32 v[246:247], v[242:243], v[246:247], -1.0 op_sel_hi:[1,1,0]
    v_rcp_f32 v244, v244
    v_rcp_f32 v245, v245
    v_rcp_f32 v246, v246
    v_rcp_f32 v247, v247
    v_pk_fma_f32 v[192:193], v[192:193], v[244:245], v[192:193]
    v_pk_fma_f32 v[194:195], v[194:195], v[246:247], v[194:195]
    v_pk_mul_f32 v[116:117], v[208:209], s[80:81] op_sel_hi:[1,0]
    v_pk_mul_f32 v[118:119], v[210:211], s[80:81] op_sel_hi:[1,0]
    v_exp_f32 v116, v116
    v_exp_f32 v117, v117
    v_exp_f32 v118, v118
    v_exp_f32 v119, v119
    v_pk_fma_f32 v[120:121], v[116:117], -0.5, -1.0 op_sel_hi:[1,0,0]
    v_pk_fma_f32 v[122:123], v[118:119], -0.5, -1.0 op_sel_hi:[1,0,0]
    v_pk_fma_f32 v[120:121], v[116:117], v[120:121], -1.0 op_sel_hi:[1,1,0]
    v_pk_fma_f32 v[122:123], v[118:119], v[122:123], -1.0 op_sel_hi:[1,1,0]
    v_rcp_f32 v120, v120
    v_rcp_f32 v121, v121
    v_rcp_f32 v122, v122
    v_rcp_f32 v123, v123
    v_pk_fma_f32 v[208:209], v[208:209], v[120:121], v[208:209]
    v_pk_fma_f32 v[210:211], v[210:211], v[122:123], v[210:211]
    v_cvt_pk_bf16_f32 v72, v192, v193
    v_cvt_pk_bf16_f32 v73, v194, v195
    v_cvt_pk_bf16_f32 v74, v208, v209
    v_cvt_pk_bf16_f32 v75, v210, v211
    buffer_store_dwordx4 v[72:75], v113, s[36:39], s75 offen sc1
    s_add_u32 s75, s75, 147456
    v_pk_mul_f32 v[240:241], v[196:197], s[80:81] op_sel_hi:[1,0]
    v_pk_mul_f32 v[242:243], v[198:199], s[80:81] op_sel_hi:[1,0]
    v_exp_f32 v240, v240
    v_exp_f32 v241, v241
    v_exp_f32 v242, v242
    v_exp_f32 v243, v243
    v_pk_fma_f32 v[244:245], v[240:241], -0.5, -1.0 op_sel_hi:[1,0,0]
    v_pk_fma_f32 v[246:247], v[242:243], -0.5, -1.0 op_sel_hi:[1,0,0]
    v_pk_fma_f32 v[244:245], v[240:241], v[244:245], -1.0 op_sel_hi:[1,1,0]
    v_pk_fma_f32 v[246:247], v[242:243], v[246:247], -1.0 op_sel_hi:[1,1,0]
    v_rcp_f32 v244, v244
    v_rcp_f32 v245, v245
    v_rcp_f32 v246, v246
    v_rcp_f32 v247, v247
    v_pk_fma_f32 v[196:197], v[196:197], v[244:245], v[196:197]
    v_pk_fma_f32 v[198:199], v[198:199], v[246:247], v[198:199]
    v_pk_mul_f32 v[116:117], v[212:213], s[80:81] op_sel_hi:[1,0]
    v_pk_mul_f32 v[118:119], v[214:215], s[80:81] op_sel_hi:[1,0]
    v_exp_f32 v116, v116
    v_exp_f32 v117, v117
    v_exp_f32 v118, v118
    v_exp_f32 v119, v119
    v_pk_fma_f32 v[120:121], v[116:117], -0.5, -1.0 op_sel_hi:[1,0,0]
    v_pk_fma_f32 v[122:123], v[118:119], -0.5, -1.0 op_sel_hi:[1,0,0]
    v_pk_fma_f32 v[120:121], v[116:117], v[120:121], -1.0 op_sel_hi:[1,1,0]
    v_pk_fma_f32 v[122:123], v[118:119], v[122:123], -1.0 op_sel_hi:[1,1,0]
    v_rcp_f32 v120, v120
    v_rcp_f32 v121, v121
    v_rcp_f32 v122, v122
    v_rcp_f32 v123, v123
    v_pk_fma_f32 v[212:213], v[212:213], v[120:121], v[212:213]
    v_pk_fma_f32 v[214:215], v[214:215], v[122:123], v[214:215]
    v_cvt_pk_bf16_f32 v76, v196, v197
    v_cvt_pk_bf16_f32 v77, v198, v199
    v_cvt_pk_bf16_f32 v78, v212, v213
    v_cvt_pk_bf16_f32 v79, v214, v215
    buffer_store_dwordx4 v[76:79], v113, s[36:39], s75 offen sc1
    s_add_u32 s75, s75, 147456
    v_pk_mul_f32 v[240:241], v[200:201], s[80:81] op_sel_hi:[1,0]
    v_pk_mul_f32 v[242:243], v[202:203], s[80:81] op_sel_hi:[1,0]
    v_exp_f32 v240, v240
    v_exp_f32 v241, v241
    v_exp_f32 v242, v242
    v_exp_f32 v243, v243
    v_pk_fma_f32 v[244:245], v[240:241], -0.5, -1.0 op_sel_hi:[1,0,0]
    v_pk_fma_f32 v[246:247], v[242:243], -0.5, -1.0 op_sel_hi:[1,0,0]
    v_pk_fma_f32 v[244:245], v[240:241], v[244:245], -1.0 op_sel_hi:[1,1,0]
    v_pk_fma_f32 v[246:247], v[242:243], v[246:247], -1.0 op_sel_hi:[1,1,0]
    v_rcp_f32 v244, v244
    v_rcp_f32 v245, v245
    v_rcp_f32 v246, v246
    v_rcp_f32 v247, v247
    v_pk_fma_f32 v[200:201], v[200:201], v[244:245], v[200:201]
    v_pk_fma_f32 v[202:203], v[202:203], v[246:247], v[202:203]
    v_pk_mul_f32 v[116:117], v[216:217], s[80:81] op_sel_hi:[1,0]
    v_pk_mul_f32 v[118:119], v[218:219], s[80:81] op_sel_hi:[1,0]
    v_exp_f32 v116, v116
    v_exp_f32 v117, v117
    v_exp_f32 v118, v118
    v_exp_f32 v119, v119
    v_pk_fma_f32 v[120:121], v[116:117], -0.5, -1.0 op_sel_hi:[1,0,0]
    v_pk_fma_f32 v[122:123], v[118:119], -0.5, -1.0 op_sel_hi:[1,0,0]
    v_pk_fma_f32 v[120:121], v[116:117], v[120:121], -1.0 op_sel_hi:[1,1,0]
    v_pk_fma_f32 v[122:123], v[118:119], v[122:123], -1.0 op_sel_hi:[1,1,0]
    v_rcp_f32 v120, v120
    v_rcp_f32 v121, v121
    v_rcp_f32 v122, v122
    v_rcp_f32 v123, v123
    v_pk_fma_f32 v[216:217], v[216:217], v[120:121], v[216:217]
    v_pk_fma_f32 v[218:219], v[218:219], v[122:123], v[218:219]
    v_cvt_pk_bf16_f32 v72, v200, v201
    v_cvt_pk_bf16_f32 v73, v202, v203
    v_cvt_pk_bf16_f32 v74, v216, v217
    v_cvt_pk_bf16_f32 v75, v218, v219
    buffer_store_dwordx4 v[72:75], v113, s[36:39], s75 offen sc1
    s_add_u32 s75, s75, 147456
    v_pk_mul_f32 v[240:241], v[204:205], s[80:81] op_sel_hi:[1,0]
    v_pk_mul_f32 v[242:243], v[206:207], s[80:81] op_sel_hi:[1,0]
    v_exp_f32 v240, v240
    v_exp_f32 v241, v241
    v_exp_f32 v242, v242
    v_exp_f32 v243, v243
    v_pk_fma_f32 v[244:245], v[240:241], -0.5, -1.0 op_sel_hi:[1,0,0]
    v_pk_fma_f32 v[246:247], v[242:243], -0.5, -1.0 op_sel_hi:[1,0,0]
    v_pk_fma_f32 v[244:245], v[240:241], v[244:245], -1.0 op_sel_hi:[1,1,0]
    v_pk_fma_f32 v[246:247], v[242:243], v[246:247], -1.0 op_sel_hi:[1,1,0]
    v_rcp_f32 v244, v244
    v_rcp_f32 v245, v245
    v_rcp_f32 v246, v246
    v_rcp_f32 v247, v247
    v_pk_fma_f32 v[204:205], v[204:205], v[244:245], v[204:205]
    v_pk_fma_f32 v[206:207], v[206:207], v[246:247], v[206:207]
    v_pk_mul_f32 v[116:117], v[220:221], s[80:81] op_sel_hi:[1,0]
    v_pk_mul_f32 v[118:119], v[222:223], s[80:81] op_sel_hi:[1,0]
    v_exp_f32 v116, v116
    v_exp_f32 v117, v117
    v_exp_f32 v118, v118
    v_exp_f32 v119, v119
    v_pk_fma_f32 v[120:121], v[116:117], -0.5, -1.0 op_sel_hi:[1,0,0]
    v_pk_fma_f32 v[122:123], v[118:119], -0.5, -1.0 op_sel_hi:[1,0,0]
    v_pk_fma_f32 v[120:121], v[116:117], v[120:121], -1.0 op_sel_hi:[1,1,0]
    v_pk_fma_f32 v[122:123], v[118:119], v[122:123], -1.0 op_sel_hi:[1,1,0]
    v_rcp_f32 v120, v120
    v_rcp_f32 v121, v121
    v_rcp_f32 v122, v122
    v_rcp_f32 v123, v123
    v_pk_fma_f32 v[220:221], v[220:221], v[120:121], v[220:221]
    v_pk_fma_f32 v[222:223], v[222:223], v[122:123], v[222:223]
    v_cvt_pk_bf16_f32 v76, v204, v205
    v_cvt_pk_bf16_f32 v77, v206, v207
    v_cvt_pk_bf16_f32 v78, v220, v221
    v_cvt_pk_bf16_f32 v79, v222, v223
    buffer_store_dwordx4 v[76:79], v113, s[36:39], s75 offen sc1
    s_branch P2_start
K1_v10:
    s_barrier
    ds_read_b64_tr_b16 v[8:9], v100 offset:0
    ds_read_b64_tr_b16 v[10:11], v100 offset:512
    ds_read_b128 v[64:67], v98 offset:0
    ds_read_b128 v[68:71], v98 offset:2048
    ds_read_b128 v[72:75], v98 offset:4096
    ds_read_b128 v[76:79], v98 offset:6144
    ds_read_b64_tr_b16 v[12:13], v101 offset:0
    ds_read_b64_tr_b16 v[14:15], v101 offset:512
    ds_read_b64_tr_b16 v[16:17], v100 offset:4096
    ds_read_b64_tr_b16 v[18:19], v100 offset:4608
    ds_read_b64_tr_b16 v[20:21], v101 offset:4096
    ds_read_b64_tr_b16 v[22:23], v101 offset:4608
    ds_read_b64_tr_b16 v[24:25], v102 offset:0
    ds_read_b64_tr_b16 v[26:27], v102 offset:1024
    ds_read_b64_tr_b16 v[28:29], v103 offset:0
    ds_read_b64_tr_b16 v[30:31], v103 offset:1024
    ds_read_b64_tr_b16 v[32:33], v104 offset:0
    ds_read_b64_tr_b16 v[34:35], v104 offset:1024
    s_mov_b32 s72, 1
    s_waitcnt vmcnt(6) lgkmcnt(0)
    s_barrier
    v_mfma_f32_16x16x32_bf16 v[128:131], v[8:11], v[64:67], v[128:131]
    ds_read_b64_tr_b16 v[36:37], v100 offset:16384
    s_add_u32 m0, s77, 49152
    s_nop 0
    buffer_load_dwordx4 v107, s[32:35], s67 offen offset:0 lds
    v_mfma_f32_16x16x32_bf16 v[132:135], v[8:11], v[68:71], v[132:135]
    ds_read_b64_tr_b16 v[38:39], v100 offset:16896
    v_mfma_f32_16x16x32_bf16 v[136:139], v[8:11], v[72:75], v[136:139]
    ds_read_b128 v[80:83], v99 offset:0
    v_mfma_f32_16x16x32_bf16 v[140:143], v[8:11], v[76:79], v[140:143]
    ds_read_b128 v[84:87], v99 offset:2048
    buffer_load_dwordx4 v108, s[32:35], s67 offen offset:1024 lds
    v_mfma_f32_16x16x32_bf16 v[156:159], v[12:15], v[76:79], v[156:159]
    ds_read_b128 v[88:91], v99 offset:4096
    v_mfma_f32_16x16x32_bf16 v[152:155], v[12:15], v[72:75], v[152:155]
    ds_read_b128 v[92:95], v99 offset:6144
    v_mfma_f32_16x16x32_bf16 v[148:151], v[12:15], v[68:71], v[148:151]
    ds_read_b64_tr_b16 v[40:41], v101 offset:16384
    s_add_u32 s67, s67, s68
    s_add_u32 s69, s69, 128
    s_add_u32 s70, s70, 32768
    s_cmp_eq_u32 s70, 98304
    s_cselect_b32 s70, 0, s70
    s_add_u32 m0, s70, s78
    s_nop 0
    buffer_load_dwordx4 v105, s[28:31], s69 offen offset:0 lds
    v_mfma_f32_16x16x32_bf16 v[144:147], v[12:15], v[64:67], v[144:147]
    ds_read_b64_tr_b16 v[42:43], v101 offset:16896
    v_mfma_f32_16x16x32_bf16 v[160:163], v[16:19], v[64:67], v[160:163]
    ds_read_b64_tr_b16 v[44:45], v100 offset:20480
    v_mfma_f32_16x16x32_bf16 v[164:167], v[16:19], v[68:71], v[164:167]
    ds_read_b64_tr_b16 v[46:47], v100 offset:20992
    buffer_load_dwordx4 v106, s[28:31], s69 offen offset:1024 lds
    v_mfma_f32_16x16x32_bf16 v[168:171], v[16:19], v[72:75], v[168:171]
    ds_read_b64_tr_b16 v[48:49], v101 offset:20480
    v_mfma_f32_16x16x32_bf16 v[172:175], v[16:19], v[76:79], v[172:175]
    ds_read_b64_tr_b16 v[50:51], v101 offset:20992
    v_mfma_f32_16x16x32_bf16 v[188:191], v[20:23], v[76:79], v[188:191]
    ds_read_b64_tr_b16 v[52:53], v102 offset:16384
    s_add_u32 m0, s77, 0
    s_nop 0
    buffer_load_dwordx4 v107, s[32:35], s67 offen offset:0 lds
    v_mfma_f32_16x16x32_bf16 v[184:187], v[20:23], v[72:75], v[184:187]
    ds_read_b64_tr_b16 v[54:55], v102 offset:17408
    v_mfma_f32_16x16x32_bf16 v[180:183], v[20:23], v[68:71], v[180:183]
    ds_read_b64_tr_b16 v[56:57], v103 offset:16384
    v_mfma_f32_16x16x32_bf16 v[176:179], v[20:23], v[64:67], v[176:179]
    ds_read_b64_tr_b16 v[58:59], v103 offset:17408
    buffer_load_dwordx4 v108, s[32:35], s67 offen offset:1024 lds
    v_mfma_f32_16x16x32_bf16 v[192:195], v[24:27], v[64:67], v[192:195]
    ds_read_b64_tr_b16 v[60:61], v104 offset:16384
    v_mfma_f32_16x16x32_bf16 v[196:199], v[24:27], v[68:71], v[196:199]
    ds_read_b64_tr_b16 v[62:63], v104 offset:17408
    v_mfma_f32_16x16x32_bf16 v[200:203], v[24:27], v[72:75], v[200:203]
    s_add_u32 s67, s67, s68
    s_add_u32 s73, s69, 262144
    s_add_u32 s74, s70, s78
    s_add_u32 m0, s74, 16384
    s_nop 0
    buffer_load_dwordx4 v105, s[28:31], s73 offen offset:0 lds
    v_mfma_f32_16x16x32_bf16 v[204:207], v[24:27], v[76:79], v[204:207]
    v_mfma_f32_16x16x32_bf16 v[220:223], v[28:31], v[76:79], v[220:223]
    v_mfma_f32_16x16x32_bf16 v[216:219], v[28:31], v[72:75], v[216:219]
    buffer_load_dwordx4 v106, s[28:31], s73 offen offset:1024 lds
    v_mfma_f32_16x16x32_bf16 v[212:215], v[28:31], v[68:71], v[212:215]
    v_mfma_f32_16x16x32_bf16 v[208:211], v[28:31], v[64:67], v[208:211]
    v_mfma_f32_16x16x32_bf16 v[224:227], v[32:35], v[64:67], v[224:227]
    v_mfma_f32_16x16x32_bf16 v[228:231], v[32:35], v[68:71], v[228:231]
    v_mfma_f32_16x16x32_bf16 v[232:235], v[32:35], v[72:75], v[232:235]
    v_mfma_f32_16x16x32_bf16 v[236:239], v[32:35], v[76:79], v[236:239]
    s_waitcnt vmcnt(8) lgkmcnt(0)
    s_barrier
    s_add_u32 s71, s71, 32768
    s_cmp_eq_u32 s71, 98304
    s_cselect_b32 s71, 0, s71
    v_add_u32 v98, s71, v96
    v_add_u32 v99, s71, v97
    v_mfma_f32_16x16x32_bf16 v[128:131], v[36:39], v[80:83], v[128:131]
    ds_read_b64_tr_b16 v[8:9], v100 offset:32768
    s_add_u32 m0, s77, 16384
    s_nop 0
    buffer_load_dwordx4 v107, s[32:35], s67 offen offset:0 lds
    v_mfma_f32_16x16x32_bf16 v[132:135], v[36:39], v[84:87], v[132:135]
    ds_read_b64_tr_b16 v[10:11], v100 offset:33280
    v_mfma_f32_16x16x32_bf16 v[136:139], v[36:39], v[88:91], v[136:139]
    ds_read_b128 v[64:67], v98 offset:0
    v_mfma_f32_16x16x32_bf16 v[140:143], v[36:39], v[92:95], v[140:143]
    ds_read_b128 v[68:71], v98 offset:2048
    buffer_load_dwordx4 v108, s[32:35], s67 offen offset:1024 lds
    v_mfma_f32_16x16x32_bf16 v[156:159], v[40:43], v[92:95], v[156:159]
    ds_read_b128 v[72:75], v98 offset:4096
    v_mfma_f32_16x16x32_bf16 v[152:155], v[40:43], v[88:91], v[152:155]
    ds_read_b128 v[76:79], v98 offset:6144
    v_mfma_f32_16x16x32_bf16 v[148:151], v[40:43], v[84:87], v[148:151]
    ds_read_b64_tr_b16 v[12:13], v101 offset:32768
    s_add_u32 s67, s67, s68
    s_add_u32 s69, s69, 128
    s_add_u32 s70, s70, 32768
    s_cmp_eq_u32 s70, 98304
    s_cselect_b32 s70, 0, s70
    s_add_u32 m0, s70, s78
    s_nop 0
    buffer_load_dwordx4 v105, s[28:31], s69 offen offset:0 lds
    v_mfma_f32_16x16x32_bf16 v[144:147], v[40:43], v[80:83], v[144:147]
    ds_read_b64_tr_b16 v[14:15], v101 offset:33280
    v_mfma_f32_16x16x32_bf16 v[160:163], v[44:47], v[80:83], v[160:163]
    ds_read_b64_tr_b16 v[16:17], v100 offset:36864
    v_mfma_f32_16x16x32_bf16 v[164:167], v[44:47], v[84:87], v[164:167]
    ds_read_b64_tr_b16 v[18:19], v100 offset:37376
    buffer_load_dwordx4 v106, s[28:31], s69 offen offset:1024 lds
    v_mfma_f32_16x16x32_bf16 v[168:171], v[44:47], v[88:91], v[168:171]
    ds_read_b64_tr_b16 v[20:21], v101 offset:36864
    v_mfma_f32_16x16x32_bf16 v[172:175], v[44:47], v[92:95], v[172:175]
    ds_read_b64_tr_b16 v[22:23], v101 offset:37376
    v_mfma_f32_16x16x32_bf16 v[188:191], v[48:51], v[92:95], v[188:191]
    ds_read_b64_tr_b16 v[24:25], v102 offset:32768
    v_mfma_f32_16x16x32_bf16 v[184:187], v[48:51], v[88:91], v[184:187]
    ds_read_b64_tr_b16 v[26:27], v102 offset:33792
    v_mfma_f32_16x16x32_bf16 v[180:183], v[48:51], v[84:87], v[180:183]
    ds_read_b64_tr_b16 v[28:29], v103 offset:32768
    v_mfma_f32_16x16x32_bf16 v[176:179], v[48:51], v[80:83], v[176:179]
    ds_read_b64_tr_b16 v[30:31], v103 offset:33792
    v_mfma_f32_16x16x32_bf16 v[192:195], v[52:55], v[80:83], v[192:195]
    ds_read_b64_tr_b16 v[32:33], v104 offset:32768
    v_mfma_f32_16x16x32_bf16 v[196:199], v[52:55], v[84:87], v[196:199]
    ds_read_b64_tr_b16 v[34:35], v104 offset:33792
    v_mfma_f32_16x16x32_bf16 v[200:203], v[52:55], v[88:91], v[200:203]
    v_mfma_f32_16x16x32_bf16 v[204:207], v[52:55], v[92:95], v[204:207]
    v_mfma_f32_16x16x32_bf16 v[220:223], v[56:59], v[92:95], v[220:223]
    v_mfma_f32_16x16x32_bf16 v[216:219], v[56:59], v[88:91], v[216:219]
    v_mfma_f32_16x16x32_bf16 v[212:215], v[56:59], v[84:87], v[212:215]
    v_mfma_f32_16x16x32_bf16 v[208:211], v[56:59], v[80:83], v[208:211]
    v_mfma_f32_16x16x32_bf16 v[224:227], v[60:63], v[80:83], v[224:227]
    v_mfma_f32_16x16x32_bf16 v[228:231], v[60:63], v[84:87], v[228:231]
    v_mfma_f32_16x16x32_bf16 v[232:235], v[60:63], v[88:91], v[232:235]
    v_mfma_f32_16x16x32_bf16 v[236:239], v[60:63], v[92:95], v[236:239]
    s_waitcnt vmcnt(8) lgkmcnt(0)
    s_barrier
    v_mfma_f32_16x16x32_bf16 v[128:131], v[8:11], v[64:67], v[128:131]
    ds_read_b64_tr_b16 v[36:37], v100 offset:49152
    s_add_u32 m0, s77, 32768
    s_nop 0
    buffer_load_dwordx4 v107, s[32:35], s67 offen offset:0 lds
    v_mfma_f32_16x16x32_bf16 v[132:135], v[8:11], v[68:71], v[132:135]
    ds_read_b64_tr_b16 v[38:39], v100 offset:49664
    v_mfma_f32_16x16x32_bf16 v[136:139], v[8:11], v[72:75], v[136:139]
    ds_read_b128 v[80:83], v99 offset:0
    v_mfma_f32_16x16x32_bf16 v[140:143], v[8:11], v[76:79], v[140:143]
    ds_read_b128 v[84:87], v99 offset:2048
    buffer_load_dwordx4 v108, s[32:35], s67 offen offset:1024 lds
    v_mfma_f32_16x16x32_bf16 v[156:159], v[12:15], v[76:79], v[156:159]
    ds_read_b128 v[88:91], v99 offset:4096
    v_mfma_f32_16x16x32_bf16 v[152:155], v[12:15], v[72:75], v[152:155]
    ds_read_b128 v[92:95], v99 offset:6144
    v_mfma_f32_16x16x32_bf16 v[148:151], v[12:15], v[68:71], v[148:151]
    ds_read_b64_tr_b16 v[40:41], v101 offset:49152
    s_add_u32 s67, s67, s68
    s_add_u32 s73, s69, 262144
    s_add_u32 s74, s70, s78
    s_add_u32 m0, s74, 16384
    s_nop 0
    buffer_load_dwordx4 v105, s[28:31], s73 offen offset:0 lds
    v_mfma_f32_16x16x32_bf16 v[144:147], v[12:15], v[64:67], v[144:147]
    ds_read_b64_tr_b16 v[42:43], v101 offset:49664
    v_mfma_f32_16x16x32_bf16 v[160:163], v[16:19], v[64:67], v[160:163]
    ds_read_b64_tr_b16 v[44:45], v100 offset:53248
    v_mfma_f32_16x16x32_bf16 v[164:167], v[16:19], v[68:71], v[164:167]
    ds_read_b64_tr_b16 v[46:47], v100 offset:53760
    buffer_load_dwordx4 v106, s[28:31], s73 offen offset:1024 lds
    v_mfma_f32_16x16x32_bf16 v[168:171], v[16:19], v[72:75], v[168:171]
    ds_read_b64_tr_b16 v[48:49], v101 offset:53248
    v_mfma_f32_16x16x32_bf16 v[172:175], v[16:19], v[76:79], v[172:175]
    ds_read_b64_tr_b16 v[50:51], v101 offset:53760
    v_mfma_f32_16x16x32_bf16 v[188:191], v[20:23], v[76:79], v[188:191]
    ds_read_b64_tr_b16 v[52:53], v102 offset:49152
    v_mfma_f32_16x16x32_bf16 v[184:187], v[20:23], v[72:75], v[184:187]
    ds_read_b64_tr_b16 v[54:55], v102 offset:50176
    v_mfma_f32_16x16x32_bf16 v[180:183], v[20:23], v[68:71], v[180:183]
    ds_read_b64_tr_b16 v[56:57], v103 offset:49152
    v_mfma_f32_16x16x32_bf16 v[176:179], v[20:23], v[64:67], v[176:179]
    ds_read_b64_tr_b16 v[58:59], v103 offset:50176
    v_mfma_f32_16x16x32_bf16 v[192:195], v[24:27], v[64:67], v[192:195]
    ds_read_b64_tr_b16 v[60:61], v104 offset:49152
    v_mfma_f32_16x16x32_bf16 v[196:199], v[24:27], v[68:71], v[196:199]
    ds_read_b64_tr_b16 v[62:63], v104 offset:50176
    v_mfma_f32_16x16x32_bf16 v[200:203], v[24:27], v[72:75], v[200:203]
    v_mfma_f32_16x16x32_bf16 v[204:207], v[24:27], v[76:79], v[204:207]
    v_mfma_f32_16x16x32_bf16 v[220:223], v[28:31], v[76:79], v[220:223]
    v_mfma_f32_16x16x32_bf16 v[216:219], v[28:31], v[72:75], v[216:219]
    v_mfma_f32_16x16x32_bf16 v[212:215], v[28:31], v[68:71], v[212:215]
    v_mfma_f32_16x16x32_bf16 v[208:211], v[28:31], v[64:67], v[208:211]
    v_mfma_f32_16x16x32_bf16 v[224:227], v[32:35], v[64:67], v[224:227]
    v_mfma_f32_16x16x32_bf16 v[228:231], v[32:35], v[68:71], v[228:231]
    v_mfma_f32_16x16x32_bf16 v[232:235], v[32:35], v[72:75], v[232:235]
    v_mfma_f32_16x16x32_bf16 v[236:239], v[32:35], v[76:79], v[236:239]
    s_waitcnt vmcnt(8) lgkmcnt(0)
    s_barrier
    s_add_u32 s71, s71, 32768
    s_cmp_eq_u32 s71, 98304
    s_cselect_b32 s71, 0, s71
    v_add_u32 v98, s71, v96
    v_add_u32 v99, s71, v97
    v_mfma_f32_16x16x32_bf16 v[128:131], v[36:39], v[80:83], v[128:131]
    ds_read_b64_tr_b16 v[8:9], v100 offset:0
    s_add_u32 m0, s77, 49152
    s_nop 0
    buffer_load_dwordx4 v107, s[32:35], s67 offen offset:0 lds
    v_mfma_f32_16x16x32_bf16 v[132:135], v[36:39], v[84:87], v[132:135]
    ds_read_b64_tr_b16 v[10:11], v100 offset:512
    v_mfma_f32_16x16x32_bf16 v[136:139], v[36:39], v[88:91], v[136:139]
    ds_read_b128 v[64:67], v98 offset:0
    v_mfma_f32_16x16x32_bf16 v[140:143], v[36:39], v[92:95], v[140:143]
    ds_read_b128 v[68:71], v98 offset:2048
    buffer_load_dwordx4 v108, s[32:35], s67 offen offset:1024 lds
    v_mfma_f32_16x16x32_bf16 v[156:159], v[40:43], v[92:95], v[156:159]
    ds_read_b128 v[72:75], v98 offset:4096
    v_mfma_f32_16x16x32_bf16 v[152:155], v[40:43], v[88:91], v[152:155]
    ds_read_b128 v[76:79], v98 offset:6144
    v_mfma_f32_16x16x32_bf16 v[148:151], v[40:43], v[84:87], v[148:151]
    ds_read_b64_tr_b16 v[12:13], v101 offset:0
    s_add_u32 s67, s67, s68
    s_add_u32 s69, s69, 128
    s_add_u32 s70, s70, 32768
    s_cmp_eq_u32 s70, 98304
    s_cselect_b32 s70, 0, s70
    s_add_u32 m0, s70, s78
    s_nop 0
    buffer_load_dwordx4 v105, s[28:31], s69 offen offset:0 lds
    v_mfma_f32_16x16x32_bf16 v[144:147], v[40:43], v[80:83], v[144:147]
    ds_read_b64_tr_b16 v[14:15], v101 offset:512
    v_mfma_f32_16x16x32_bf16 v[160:163], v[44:47], v[80:83], v[160:163]
    ds_read_b64_tr_b16 v[16:17], v100 offset:4096
    v_mfma_f32_16x16x32_bf16 v[164:167], v[44:47], v[84:87], v[164:167]
    ds_read_b64_tr_b16 v[18:19], v100 offset:4608
    buffer_load_dwordx4 v106, s[28:31], s69 offen offset:1024 lds
    v_mfma_f32_16x16x32_bf16 v[168:171], v[44:47], v[88:91], v[168:171]
    ds_read_b64_tr_b16 v[20:21], v101 offset:4096
    v_mfma_f32_16x16x32_bf16 v[172:175], v[44:47], v[92:95], v[172:175]
    ds_read_b64_tr_b16 v[22:23], v101 offset:4608
    v_mfma_f32_16x16x32_bf16 v[188:191], v[48:51], v[92:95], v[188:191]
    ds_read_b64_tr_b16 v[24:25], v102 offset:0
    v_mfma_f32_16x16x32_bf16 v[184:187], v[48:51], v[88:91], v[184:187]
    ds_read_b64_tr_b16 v[26:27], v102 offset:1024
    v_mfma_f32_16x16x32_bf16 v[180:183], v[48:51], v[84:87], v[180:183]
    ds_read_b64_tr_b16 v[28:29], v103 offset:0
    v_mfma_f32_16x16x32_bf16 v[176:179], v[48:51], v[80:83], v[176:179]
    ds_read_b64_tr_b16 v[30:31], v103 offset:1024
    v_mfma_f32_16x16x32_bf16 v[192:195], v[52:55], v[80:83], v[192:195]
    ds_read_b64_tr_b16 v[32:33], v104 offset:0
    v_mfma_f32_16x16x32_bf16 v[196:199], v[52:55], v[84:87], v[196:199]
    ds_read_b64_tr_b16 v[34:35], v104 offset:1024
    v_mfma_f32_16x16x32_bf16 v[200:203], v[52:55], v[88:91], v[200:203]
    v_mfma_f32_16x16x32_bf16 v[204:207], v[52:55], v[92:95], v[204:207]
    v_mfma_f32_16x16x32_bf16 v[220:223], v[56:59], v[92:95], v[220:223]
    v_mfma_f32_16x16x32_bf16 v[216:219], v[56:59], v[88:91], v[216:219]
    v_mfma_f32_16x16x32_bf16 v[212:215], v[56:59], v[84:87], v[212:215]
    v_mfma_f32_16x16x32_bf16 v[208:211], v[56:59], v[80:83], v[208:211]
    v_mfma_f32_16x16x32_bf16 v[224:227], v[60:63], v[80:83], v[224:227]
    v_mfma_f32_16x16x32_bf16 v[228:231], v[60:63], v[84:87], v[228:231]
    v_mfma_f32_16x16x32_bf16 v[232:235], v[60:63], v[88:91], v[232:235]
    v_mfma_f32_16x16x32_bf16 v[236:239], v[60:63], v[92:95], v[236:239]
    s_waitcnt vmcnt(8) lgkmcnt(0)
    s_barrier
K1_v10_loop:
    v_mfma_f32_16x16x32_bf16 v[128:131], v[8:11], v[64:67], v[128:131]
    ds_read_b64_tr_b16 v[36:37], v100 offset:16384
    s_add_u32 m0, s77, 0
    s_nop 0
    buffer_load_dwordx4 v107, s[32:35], s67 offen offset:0 lds
    v_mfma_f32_16x16x32_bf16 v[132:135], v[8:11], v[68:71], v[132:135]
    ds_read_b64_tr_b16 v[38:39], v100 offset:16896
    v_mfma_f32_16x16x32_bf16 v[136:139], v[8:11], v[72:75], v[136:139]
    ds_read_b128 v[80:83], v99 offset:0
    v_mfma_f32_16x16x32_bf16 v[140:143], v[8:11], v[76:79], v[140:143]
    ds_read_b128 v[84:87], v99 offset:2048
    buffer_load_dwordx4 v108, s[32:35], s67 offen offset:1024 lds
    v_mfma_f32_16x16x32_bf16 v[156:159], v[12:15], v[76:79], v[156:159]
    ds_read_b128 v[88:91], v99 offset:4096
    v_mfma_f32_16x16x32_bf16 v[152:155], v[12:15], v[72:75], v[152:155]
    ds_read_b128 v[92:95], v99 offset:6144
    v_mfma_f32_16x16x32_bf16 v[148:151], v[12:15], v[68:71], v[148:151]
    ds_read_b64_tr_b16 v[40:41], v101 offset:16384
    s_add_u32 s67, s67, s68
    s_add_u32 s73, s69, 262144
    s_add_u32 s74, s70, s78
    s_add_u32 m0, s74, 16384
    s_nop 0
    buffer_load_dwordx4 v105, s[28:31], s73 offen offset:0 lds
    v_mfma_f32_16x16x32_bf16 v[144:147], v[12:15], v[64:67], v[144:147]
    ds_read_b64_tr_b16 v[42:43], v101 offset:16896
    v_mfma_f32_16x16x32_bf16 v[160:163], v[16:19], v[64:67], v[160:163]
    ds_read_b64_tr_b16 v[44:45], v100 offset:20480
    v_mfma_f32_16x16x32_bf16 v[164:167], v[16:19], v[68:71], v[164:167]
    ds_read_b64_tr_b16 v[46:47], v100 offset:20992
    buffer_load_dwordx4 v106, s[28:31], s73 offen offset:1024 lds
    v_mfma_f32_16x16x32_bf16 v[168:171], v[16:19], v[72:75], v[168:171]
    ds_read_b64_tr_b16 v[48:49], v101 offset:20480
    v_mfma_f32_16x16x32_bf16 v[172:175], v[16:19], v[76:79], v[172:175]
    ds_read_b64_tr_b16 v[50:51], v101 offset:20992
    v_mfma_f32_16x16x32_bf16 v[188:191], v[20:23], v[76:79], v[188:191]
    ds_read_b64_tr_b16 v[52:53], v102 offset:16384
    s_sub_u32 s10, s10, 1
    s_cbranch_scc0 PFs9
    buffer_load_dword v3, v109, s[88:91], s84 offen
    s_mov_b32 s10, s3
    s_add_u32 s84, s84, 8192
    s_mov_b32 s3, 1000
PFs9:
    v_mfma_f32_16x16x32_bf16 v[184:187], v[20:23], v[72:75], v[184:187]
    ds_read_b64_tr_b16 v[54:55], v102 offset:17408
    v_mfma_f32_16x16x32_bf16 v[180:183], v[20:23], v[68:71], v[180:183]
    ds_read_b64_tr_b16 v[56:57], v103 offset:16384
    v_mfma_f32_16x16x32_bf16 v[176:179], v[20:23], v[64:67], v[176:179]
    ds_read_b64_tr_b16 v[58:59], v103 offset:17408
    v_mfma_f32_16x16x32_bf16 v[192:195], v[24:27], v[64:67], v[192:195]
    ds_read_b64_tr_b16 v[60:61], v104 offset:16384
    v_mfma_f32_16x16x32_bf16 v[196:199], v[24:27], v[68:71], v[196:199]
    ds_read_b64_tr_b16 v[62:63], v104 offset:17408
    v_mfma_f32_16x16x32_bf16 v[200:203], v[24:27], v[72:75], v[200:203]
    v_mfma_f32_16x16x32_bf16 v[204:207], v[24:27], v[76:79], v[204:207]
    v_mfma_f32_16x16x32_bf16 v[220:223], v[28:31], v[76:79], v[220:223]
    v_mfma_f32_16x16x32_bf16 v[216:219], v[28:31], v[72:75], v[216:219]
    v_mfma_f32_16x16x32_bf16 v[212:215], v[28:31], v[68:71], v[212:215]
    v_mfma_f32_16x16x32_bf16 v[208:211], v[28:31], v[64:67], v[208:211]
    v_mfma_f32_16x16x32_bf16 v[224:227], v[32:35], v[64:67], v[224:227]
    v_mfma_f32_16x16x32_bf16 v[228:231], v[32:35], v[68:71], v[228:231]
    v_mfma_f32_16x16x32_bf16 v[232:235], v[32:35], v[72:75], v[232:235]
    v_mfma_f32_16x16x32_bf16 v[236:239], v[32:35], v[76:79], v[236:239]
    s_waitcnt vmcnt(8) lgkmcnt(0)
    s_barrier
    s_add_u32 s71, s71, 32768
    s_cmp_eq_u32 s71, 98304
    s_cselect_b32 s71, 0, s71
    v_add_u32 v98, s71, v96
    v_add_u32 v99, s71, v97
    v_mfma_f32_16x16x32_bf16 v[128:131], v[36:39], v[80:83], v[128:131]
    ds_read_b64_tr_b16 v[8:9], v100 offset:32768
    s_add_u32 m0, s77, 16384
    s_nop 0
    buffer_load_dwordx4 v107, s[32:35], s67 offen offset:0 lds
    v_mfma_f32_16x16x32_bf16 v[132:135], v[36:39], v[84:87], v[132:135]
    ds_read_b64_tr_b16 v[10:11], v100 offset:33280
    v_mfma_f32_16x16x32_bf16 v[136:139], v[36:39], v[88:91], v[136:139]
    ds_read_b128 v[64:67], v98 offset:0
    v_mfma_f32_16x16x32_bf16 v[140:143], v[36:39], v[92:95], v[140:143]
    ds_read_b128 v[68:71], v98 offset:2048
    buffer_load_dwordx4 v108, s[32:35], s67 offen offset:1024 lds
    v_mfma_f32_16x16x32_bf16 v[156:159], v[40:43], v[92:95], v[156:159]
    ds_read_b128 v[72:75], v98 offset:4096
    v_mfma_f32_16x16x32_bf16 v[152:155], v[40:43], v[88:91], v[152:155]
    ds_read_b128 v[76:79], v98 offset:6144
    v_mfma_f32_16x16x32_bf16 v[148:151], v[40:43], v[84:87], v[148:151]
    ds_read_b64_tr_b16 v[12:13], v101 offset:32768
    s_add_u32 s67, s67, s68
    s_add_u32 s69, s69, 128
    s_add_u32 s70, s70, 32768
    s_cmp_eq_u32 s70, 98304
    s_cselect_b32 s70, 0, s70
    s_add_u32 m0, s70, s78
    s_nop 0
    buffer_load_dwordx4 v105, s[28:31], s69 offen offset:0 lds
    v_mfma_f32_16x16x32_bf16 v[144:147], v[40:43], v[80:83], v[144:147]
    ds_read_b64_tr_b16 v[14:15], v101 offset:33280
    v_mfma_f32_16x16x32_bf16 v[160:163], v[44:47], v[80:83], v[160:163]
    ds_read_b64_tr_b16 v[16:17], v100 offset:36864
    v_mfma_f32_16x16x32_bf16 v[164:167], v[44:47], v[84:87], v[164:167]
    ds_read_b64_tr_b16 v[18:19], v100 offset:37376
    buffer_load_dwordx4 v106, s[28:31], s69 offen offset:1024 lds
    v_mfma_f32_16x16x32_bf16 v[168:171], v[44:47], v[88:91], v[168:171]
    ds_read_b64_tr_b16 v[20:21], v101 offset:36864
    v_mfma_f32_16x16x32_bf16 v[172:175], v[44:47], v[92:95], v[172:175]
    ds_read_b64_tr_b16 v[22:23], v101 offset:37376
    v_mfma_f32_16x16x32_bf16 v[188:191], v[48:51], v[92:95], v[188:191]
    ds_read_b64_tr_b16 v[24:25], v102 offset:32768
    s_sub_u32 s10, s10, 1
    s_cbranch_scc0 PFs10
    buffer_load_dword v3, v109, s[88:91], s84 offen
    s_mov_b32 s10, s3
    s_add_u32 s84, s84, 8192
    s_mov_b32 s3, 1000
PFs10:
    v_mfma_f32_16x16x32_bf16 v[184:187], v[48:51], v[88:91], v[184:187]
    ds_read_b64_tr_b16 v[26:27], v102 offset:33792
    v_mfma_f32_16x16x32_bf16 v[180:183], v[48:51], v[84:87], v[180:183]
    ds_read_b64_tr_b16 v[28:29], v103 offset:32768
    v_mfma_f32_16x16x32_bf16 v[176:179], v[48:51], v[80:83], v[176:179]
    ds_read_b64_tr_b16 v[30:31], v103 offset:33792
    v_mfma_f32_16x16x32_bf16 v[192:195], v[52:55], v[80:83], v[192:195]
    ds_read_b64_tr_b16 v[32:33], v104 offset:32768
    v_mfma_f32_16x16x32_bf16 v[196:199], v[52:55], v[84:87], v[196:199]
    ds_read_b64_tr_b16 v[34:35], v104 offset:33792
    v_mfma_f32_16x16x32_bf16 v[200:203], v[52:55], v[88:91], v[200:203]
    v_mfma_f32_16x16x32_bf16 v[204:207], v[52:55], v[92:95], v[204:207]
    v_mfma_f32_16x16x32_bf16 v[220:223], v[56:59], v[92:95], v[220:223]
    v_mfma_f32_16x16x32_bf16 v[216:219], v[56:59], v[88:91], v[216:219]
    v_mfma_f32_16x16x32_bf16 v[212:215], v[56:59], v[84:87], v[212:215]
    v_mfma_f32_16x16x32_bf16 v[208:211], v[56:59], v[80:83], v[208:211]
    v_mfma_f32_16x16x32_bf16 v[224:227], v[60:63], v[80:83], v[224:227]
    v_mfma_f32_16x16x32_bf16 v[228:231], v[60:63], v[84:87], v[228:231]
    v_mfma_f32_16x16x32_bf16 v[232:235], v[60:63], v[88:91], v[232:235]
    v_mfma_f32_16x16x32_bf16 v[236:239], v[60:63], v[92:95], v[236:239]
    s_waitcnt vmcnt(8) lgkmcnt(0)
    s_barrier
    v_mfma_f32_16x16x32_bf16 v[128:131], v[8:11], v[64:67], v[128:131]
    ds_read_b64_tr_b16 v[36:37], v100 offset:49152
    s_add_u32 m0, s77, 32768
    s_nop 0
    buffer_load_dwordx4 v107, s[32:35], s67 offen offset:0 lds
    v_mfma_f32_16x16x32_bf16 v[132:135], v[8:11], v[68:71], v[132:135]
    ds_read_b64_tr_b16 v[38:39], v100 offset:49664
    v_mfma_f32_16x16x32_bf16 v[136:139], v[8:11], v[72:75], v[136:139]
    ds_read_b128 v[80:83], v99 offset:0
    v_mfma_f32_16x16x32_bf16 v[140:143], v[8:11], v[76:79], v[140:143]
    ds_read_b128 v[84:87], v99 offset:2048
    buffer_load_dwordx4 v108, s[32:35], s67 offen offset:1024 lds
    v_mfma_f32_16x16x32_bf16 v[156:159], v[12:15], v[76:79], v[156:159]
    ds_read_b128 v[88:91], v99 offset:4096
    v_mfma_f32_16x16x32_bf16 v[152:155], v[12:15], v[72:75], v[152:155]
    ds_read_b128 v[92:95], v99 offset:6144
    v_mfma_f32_16x16x32_bf16 v[148:151], v[12:15], v[68:71], v[148:151]
    ds_read_b64_tr_b16 v[40:41], v101 offset:49152
    s_add_u32 s67, s67, s68
    s_add_u32 s73, s69, 262144
    s_add_u32 s74, s70, s78
    s_add_u32 m0, s74, 16384
    s_nop 0
    buffer_load_dwordx4 v105, s[28:31], s73 offen offset:0 lds
    v_mfma_f32_16x16x32_bf16 v[144:147], v[12:15], v[64:67], v[144:147]
    ds_read_b64_tr_b16 v[42:43], v101 offset:49664
    v_mfma_f32_16x16x32_bf16 v[160:163], v[16:19], v[64:67], v[160:163]
    ds_read_b64_tr_b16 v[44:45], v100 offset:53248
    v_mfma_f32_16x16x32_bf16 v[164:167], v[16:19], v[68:71], v[164:167]
    ds_read_b64_tr_b16 v[46:47], v100 offset:53760
    buffer_load_dwordx4 v106, s[28:31], s73 offen offset:1024 lds
    v_mfma_f32_16x16x32_bf16 v[168:171], v[16:19], v[72:75], v[168:171]
    ds_read_b64_tr_b16 v[48:49], v101 offset:53248
    v_mfma_f32_16x16x32_bf16 v[172:175], v[16:19], v[76:79], v[172:175]
    ds_read_b64_tr_b16 v[50:51], v101 offset:53760
    v_mfma_f32_16x16x32_bf16 v[188:191], v[20:23], v[76:79], v[188:191]
    ds_read_b64_tr_b16 v[52:53], v102 offset:49152
    s_sub_u32 s10, s10, 1
    s_cbranch_scc0 PFs11
    buffer_load_dword v3, v109, s[88:91], s84 offen
    s_mov_b32 s10, s3
    s_add_u32 s84, s84, 8192
    s_mov_b32 s3, 1000
PFs11:
    v_mfma_f32_16x16x32_bf16 v[184:187], v[20:23], v[72:75], v[184:187]
    ds_read_b64_tr_b16 v[54:55], v102 offset:50176
    v_mfma_f32_16x16x32_bf16 v[180:183], v[20:23], v[68:71], v[180:183]
    ds_read_b64_tr_b16 v[56:57], v103 offset:49152
    v_mfma_f32_16x16x32_bf16 v[176:179], v[20:23], v[64:67], v[176:179]
    ds_read_b64_tr_b16 v[58:59], v103 offset:50176
    v_mfma_f32_16x16x32_bf16 v[192:195], v[24:27], v[64:67], v[192:195]
    ds_read_b64_tr_b16 v[60:61], v104 offset:49152
    v_mfma_f32_16x16x32_bf16 v[196:199], v[24:27], v[68:71], v[196:199]
    ds_read_b64_tr_b16 v[62:63], v104 offset:50176
    v_mfma_f32_16x16x32_bf16 v[200:203], v[24:27], v[72:75], v[200:203]
    v_mfma_f32_16x16x32_bf16 v[204:207], v[24:27], v[76:79], v[204:207]
    v_mfma_f32_16x16x32_bf16 v[220:223], v[28:31], v[76:79], v[220:223]
    v_mfma_f32_16x16x32_bf16 v[216:219], v[28:31], v[72:75], v[216:219]
    v_mfma_f32_16x16x32_bf16 v[212:215], v[28:31], v[68:71], v[212:215]
    v_mfma_f32_16x16x32_bf16 v[208:211], v[28:31], v[64:67], v[208:211]
    v_mfma_f32_16x16x32_bf16 v[224:227], v[32:35], v[64:67], v[224:227]
    v_mfma_f32_16x16x32_bf16 v[228:231], v[32:35], v[68:71], v[228:231]
    v_mfma_f32_16x16x32_bf16 v[232:235], v[32:35], v[72:75], v[232:235]
    v_mfma_f32_16x16x32_bf16 v[236:239], v[32:35], v[76:79], v[236:239]
    s_waitcnt vmcnt(8) lgkmcnt(0)
    s_barrier
    s_add_u32 s71, s71, 32768
    s_cmp_eq_u32 s71, 98304
    s_cselect_b32 s71, 0, s71
    v_add_u32 v98, s71, v96
    v_add_u32 v99, s71, v97
    v_mfma_f32_16x16x32_bf16 v[128:131], v[36:39], v[80:83], v[128:131]
    ds_read_b64_tr_b16 v[8:9], v100 offset:0
    s_add_u32 m0, s77, 49152
    s_nop 0
    buffer_load_dwordx4 v107, s[32:35], s67 offen offset:0 lds
    v_mfma_f32_16x16x32_bf16 v[132:135], v[36:39], v[84:87], v[132:135]
    ds_read_b64_tr_b16 v[10:11], v100 offset:512
    v_mfma_f32_16x16x32_bf16 v[136:139], v[36:39], v[88:91], v[136:139]
    ds_read_b128 v[64:67], v98 offset:0
    v_mfma_f32_16x16x32_bf16 v[140:143], v[36:39], v[92:95], v[140:143]
    ds_read_b128 v[68:71], v98 offset:2048
    buffer_load_dwordx4 v108, s[32:35], s67 offen offset:1024 lds
    v_mfma_f32_16x16x32_bf16 v[156:159], v[40:43], v[92:95], v[156:159]
    ds_read_b128 v[72:75], v98 offset:4096
    v_mfma_f32_16x16x32_bf16 v[152:155], v[40:43], v[88:91], v[152:155]
    ds_read_b128 v[76:79], v98 offset:6144
    v_mfma_f32_16x16x32_bf16 v[148:151], v[40:43], v[84:87], v[148:151]
    ds_read_b64_tr_b16 v[12:13], v101 offset:0
    s_add_u32 s67, s67, s68
    s_add_u32 s69, s69, 128
    s_add_u32 s70, s70, 32768
    s_cmp_eq_u32 s70, 98304
    s_cselect_b32 s70, 0, s70
    s_add_u32 m0, s70, s78
    s_nop 0
    buffer_load_dwordx4 v105, s[28:31], s69 offen offset:0 lds
    v_mfma_f32_16x16x32_bf16 v[144:147], v[40:43], v[80:83], v[144:147]
    ds_read_b64_tr_b16 v[14:15], v101 offset:512
    v_mfma_f32_16x16x32_bf16 v[160:163], v[44:47], v[80:83], v[160:163]
    ds_read_b64_tr_b16 v[16:17], v100 offset:4096
    v_mfma_f32_16x16x32_bf16 v[164:167], v[44:47], v[84:87], v[164:167]
    ds_read_b64_tr_b16 v[18:19], v100 offset:4608
    buffer_load_dwordx4 v106, s[28:31], s69 offen offset:1024 lds
    v_mfma_f32_16x16x32_bf16 v[168:171], v[44:47], v[88:91], v[168:171]
    ds_read_b64_tr_b16 v[20:21], v101 offset:4096
    v_mfma_f32_16x16x32_bf16 v[172:175], v[44:47], v[92:95], v[172:175]
    ds_read_b64_tr_b16 v[22:23], v101 offset:4608
    v_mfma_f32_16x16x32_bf16 v[188:191], v[48:51], v[92:95], v[188:191]
    ds_read_b64_tr_b16 v[24:25], v102 offset:0
    s_sub_u32 s10, s10, 1
    s_cbranch_scc0 PFs12
    buffer_load_dword v3, v109, s[88:91], s84 offen
    s_mov_b32 s10, s3
    s_add_u32 s84, s84, 8192
    s_mov_b32 s3, 1000
PFs12:
    v_mfma_f32_16x16x32_bf16 v[184:187], v[48:51], v[88:91], v[184:187]
    ds_read_b64_tr_b16 v[26:27], v102 offset:1024
    v_mfma_f32_16x16x32_bf16 v[180:183], v[48:51], v[84:87], v[180:183]
    ds_read_b64_tr_b16 v[28:29], v103 offset:0
    v_mfma_f32_16x16x32_bf16 v[176:179], v[48:51], v[80:83], v[176:179]
    ds_read_b64_tr_b16 v[30:31], v103 offset:1024
    v_mfma_f32_16x16x32_bf16 v[192:195], v[52:55], v[80:83], v[192:195]
    ds_read_b64_tr_b16 v[32:33], v104 offset:0
    v_mfma_f32_16x16x32_bf16 v[196:199], v[52:55], v[84:87], v[196:199]
    ds_read_b64_tr_b16 v[34:35], v104 offset:1024
    v_mfma_f32_16x16x32_bf16 v[200:203], v[52:55], v[88:91], v[200:203]
    v_mfma_f32_16x16x32_bf16 v[204:207], v[52:55], v[92:95], v[204:207]
    v_mfma_f32_16x16x32_bf16 v[220:223], v[56:59], v[92:95], v[220:223]
    v_mfma_f32_16x16x32_bf16 v[216:219], v[56:59], v[88:91], v[216:219]
    v_mfma_f32_16x16x32_bf16 v[212:215], v[56:59], v[84:87], v[212:215]
    v_mfma_f32_16x16x32_bf16 v[208:211], v[56:59], v[80:83], v[208:211]
    v_mfma_f32_16x16x32_bf16 v[224:227], v[60:63], v[80:83], v[224:227]
    v_mfma_f32_16x16x32_bf16 v[228:231], v[60:63], v[84:87], v[228:231]
    v_mfma_f32_16x16x32_bf16 v[232:235], v[60:63], v[88:91], v[232:235]
    v_mfma_f32_16x16x32_bf16 v[236:239], v[60:63], v[92:95], v[236:239]
    s_waitcnt vmcnt(8) lgkmcnt(0)
    s_barrier
    s_add_u32 s72, s72, 1
    s_cmp_lt_u32 s72, 7
    s_cbranch_scc1 K1_v10_loop
    v_mfma_f32_16x16x32_bf16 v[128:131], v[8:11], v[64:67], v[128:131]
    ds_read_b64_tr_b16 v[36:37], v100 offset:16384
    buffer_load_dwordx4 v[240:243], v113, s[28:31], s98 offen
    v_mfma_f32_16x16x32_bf16 v[132:135], v[8:11], v[68:71], v[132:135]
    ds_read_b64_tr_b16 v[38:39], v100 offset:16896
    v_mfma_f32_16x16x32_bf16 v[136:139], v[8:11], v[72:75], v[136:139]
    ds_read_b128 v[80:83], v99 offset:0
    v_mfma_f32_16x16x32_bf16 v[140:143], v[8:11], v[76:79], v[140:143]
    ds_read_b128 v[84:87], v99 offset:2048
    buffer_load_dwordx4 v[244:247], v113, s[28:31], s98 offen offset:1024
    v_mfma_f32_16x16x32_bf16 v[156:159], v[12:15], v[76:79], v[156:159]
    ds_read_b128 v[88:91], v99 offset:4096
    v_mfma_f32_16x16x32_bf16 v[152:155], v[12:15], v[72:75], v[152:155]
    ds_read_b128 v[92:95], v99 offset:6144
    v_mfma_f32_16x16x32_bf16 v[148:151], v[12:15], v[68:71], v[148:151]
    ds_read_b64_tr_b16 v[40:41], v101 offset:16384
    buffer_load_dwordx4 v[248:251], v113, s[52:55], 0 offen
    v_mfma_f32_16x16x32_bf16 v[144:147], v[12:15], v[64:67], v[144:147]
    ds_read_b64_tr_b16 v[42:43], v101 offset:16896
    v_mfma_f32_16x16x32_bf16 v[160:163], v[16:19], v[64:67], v[160:163]
    ds_read_b64_tr_b16 v[44:45], v100 offset:20480
    v_mfma_f32_16x16x32_bf16 v[164:167], v[16:19], v[68:71], v[164:167]
    ds_read_b64_tr_b16 v[46:47], v100 offset:20992
    buffer_load_dwordx4 v[252:255], v113, s[52:55], 0 offen offset:1024
    v_mfma_f32_16x16x32_bf16 v[168:171], v[16:19], v[72:75], v[168:171]
    ds_read_b64_tr_b16 v[48:49], v101 offset:20480
    v_mfma_f32_16x16x32_bf16 v[172:175], v[16:19], v[76:79], v[172:175]
    ds_read_b64_tr_b16 v[50:51], v101 offset:20992
    v_mfma_f32_16x16x32_bf16 v[188:191], v[20:23], v[76:79], v[188:191]
    ds_read_b64_tr_b16 v[52:53], v102 offset:16384
    buffer_load_dword v110, off, s[40:43], 0 sc1
    v_mfma_f32_16x16x32_bf16 v[184:187], v[20:23], v[72:75], v[184:187]
    ds_read_b64_tr_b16 v[54:55], v102 offset:17408
    v_mfma_f32_16x16x32_bf16 v[180:183], v[20:23], v[68:71], v[180:183]
    ds_read_b64_tr_b16 v[56:57], v103 offset:16384
    v_mfma_f32_16x16x32_bf16 v[176:179], v[20:23], v[64:67], v[176:179]
    ds_read_b64_tr_b16 v[58:59], v103 offset:17408
    s_lshl_b32 s75, s93, 3
    s_add_u32 s75, s75, s59
    s_lshl_b32 s75, s75, 7
    s_add_u32 s75, s75, 38797312
    s_lshl_b32 s76, s57, 7
    s_add_u32 s76, s76, 19988480
    v_mov_b32 v6, s76
    v_writelane_b32 v6, s75, 0
    v_writelane_b32 v6, s100, 1
    v_writelane_b32 v6, s87, 2
    buffer_load_dword v3, v6, s[36:39], 0 offen sc1
    v_mfma_f32_16x16x32_bf16 v[192:195], v[24:27], v[64:67], v[192:195]
    ds_read_b64_tr_b16 v[60:61], v104 offset:16384
    v_mfma_f32_16x16x32_bf16 v[196:199], v[24:27], v[68:71], v[196:199]
    ds_read_b64_tr_b16 v[62:63], v104 offset:17408
    v_mfma_f32_16x16x32_bf16 v[200:203], v[24:27], v[72:75], v[200:203]
    v_mfma_f32_16x16x32_bf16 v[204:207], v[24:27], v[76:79], v[204:207]
    v_mfma_f32_16x16x32_bf16 v[220:223], v[28:31], v[76:79], v[220:223]
    v_mfma_f32_16x16x32_bf16 v[216:219], v[28:31], v[72:75], v[216:219]
    v_mfma_f32_16x16x32_bf16 v[212:215], v[28:31], v[68:71], v[212:215]
    v_mfma_f32_16x16x32_bf16 v[208:211], v[28:31], v[64:67], v[208:211]
    v_mfma_f32_16x16x32_bf16 v[224:227], v[32:35], v[64:67], v[224:227]
    v_mfma_f32_16x16x32_bf16 v[228:231], v[32:35], v[68:71], v[228:231]
    v_mfma_f32_16x16x32_bf16 v[232:235], v[32:35], v[72:75], v[232:235]
    v_mfma_f32_16x16x32_bf16 v[236:239], v[32:35], v[76:79], v[236:239]
    s_waitcnt vmcnt(10) lgkmcnt(0)
    s_barrier
    s_add_u32 s71, s71, 32768
    s_cmp_eq_u32 s71, 98304
    s_cselect_b32 s71, 0, s71
    v_add_u32 v98, s71, v96
    v_add_u32 v99, s71, v97
    v_mfma_f32_16x16x32_bf16 v[128:131], v[36:39], v[80:83], v[128:131]
    ds_read_b64_tr_b16 v[8:9], v100 offset:32768
    v_mfma_f32_16x16x32_bf16 v[132:135], v[36:39], v[84:87], v[132:135]
    ds_read_b64_tr_b16 v[10:11], v100 offset:33280
    v_mfma_f32_16x16x32_bf16 v[136:139], v[36:39], v[88:91], v[136:139]
    ds_read_b128 v[64:67], v98 offset:0
    v_mfma_f32_16x16x32_bf16 v[140:143], v[36:39], v[92:95], v[140:143]
    ds_read_b128 v[68:71], v98 offset:2048
    v_mfma_f32_16x16x32_bf16 v[156:159], v[40:43], v[92:95], v[156:159]
    ds_read_b128 v[72:75], v98 offset:4096
    v_mfma_f32_16x16x32_bf16 v[152:155], v[40:43], v[88:91], v[152:155]
    ds_read_b128 v[76:79], v98 offset:6144
    v_mfma_f32_16x16x32_bf16 v[148:151], v[40:43], v[84:87], v[148:151]
    ds_read_b64_tr_b16 v[12:13], v101 offset:32768
    v_mfma_f32_16x16x32_bf16 v[144:147], v[40:43], v[80:83], v[144:147]
    ds_read_b64_tr_b16 v[14:15], v101 offset:33280
    v_mfma_f32_16x16x32_bf16 v[160:163], v[44:47], v[80:83], v[160:163]
    ds_read_b64_tr_b16 v[16:17], v100 offset:36864
    v_mfma_f32_16x16x32_bf16 v[164:167], v[44:47], v[84:87], v[164:167]
    ds_read_b64_tr_b16 v[18:19], v100 offset:37376
    v_mfma_f32_16x16x32_bf16 v[168:171], v[44:47], v[88:91], v[168:171]
    ds_read_b64_tr_b16 v[20:21], v101 offset:36864
    v_mfma_f32_16x16x32_bf16 v[172:175], v[44:47], v[92:95], v[172:175]
    ds_read_b64_tr_b16 v[22:23], v101 offset:37376
    v_mfma_f32_16x16x32_bf16 v[188:191], v[48:51], v[92:95], v[188:191]
    ds_read_b64_tr_b16 v[24:25], v102 offset:32768
    v_mfma_f32_16x16x32_bf16 v[184:187], v[48:51], v[88:91], v[184:187]
    ds_read_b64_tr_b16 v[26:27], v102 offset:33792
    v_mfma_f32_16x16x32_bf16 v[180:183], v[48:51], v[84:87], v[180:183]
    ds_read_b64_tr_b16 v[28:29], v103 offset:32768
    v_mfma_f32_16x16x32_bf16 v[176:179], v[48:51], v[80:83], v[176:179]
    ds_read_b64_tr_b16 v[30:31], v103 offset:33792
    v_mfma_f32_16x16x32_bf16 v[192:195], v[52:55], v[80:83], v[192:195]
    ds_read_b64_tr_b16 v[32:33], v104 offset:32768
    v_mfma_f32_16x16x32_bf16 v[196:199], v[52:55], v[84:87], v[196:199]
    ds_read_b64_tr_b16 v[34:35], v104 offset:33792
    v_mfma_f32_16x16x32_bf16 v[200:203], v[52:55], v[88:91], v[200:203]
    v_mfma_f32_16x16x32_bf16 v[204:207], v[52:55], v[92:95], v[204:207]
    v_mfma_f32_16x16x32_bf16 v[220:223], v[56:59], v[92:95], v[220:223]
    v_mfma_f32_16x16x32_bf16 v[216:219], v[56:59], v[88:91], v[216:219]
    v_mfma_f32_16x16x32_bf16 v[212:215], v[56:59], v[84:87], v[212:215]
    v_mfma_f32_16x16x32_bf16 v[208:211], v[56:59], v[80:83], v[208:211]
    v_mfma_f32_16x16x32_bf16 v[224:227], v[60:63], v[80:83], v[224:227]
    v_mfma_f32_16x16x32_bf16 v[228:231], v[60:63], v[84:87], v[228:231]
    v_mfma_f32_16x16x32_bf16 v[232:235], v[60:63], v[88:91], v[232:235]
    v_mfma_f32_16x16x32_bf16 v[236:239], v[60:63], v[92:95], v[236:239]
    s_waitcnt vmcnt(0) lgkmcnt(0)
    s_barrier
    v_mfma_f32_16x16x32_bf16 v[128:131], v[8:11], v[64:67], v[128:131]
    ds_read_b64_tr_b16 v[36:37], v100 offset:49152
    v_mov_b32 v5, 0
    v_dot2_f32_bf16 v5, v240, v248, v5
    v_mfma_f32_16x16x32_bf16 v[132:135], v[8:11], v[68:71], v[132:135]
    ds_read_b64_tr_b16 v[38:39], v100 offset:49664
    v_dot2_f32_bf16 v5, v241, v249, v5
    v_dot2_f32_bf16 v5, v242, v250, v5
    v_mfma_f32_16x16x32_bf16 v[136:139], v[8:11], v[72:75], v[136:139]
    ds_read_b128 v[80:83], v99 offset:0
    v_dot2_f32_bf16 v5, v243, v251, v5
    v_dot2_f32_bf16 v5, v244, v252, v5
    v_mfma_f32_16x16x32_bf16 v[140:143], v[8:11], v[76:79], v[140:143]
    ds_read_b128 v[84:87], v99 offset:2048
    v_dot2_f32_bf16 v5, v245, v253, v5
    v_dot2_f32_bf16 v5, v246, v254, v5
    v_mfma_f32_16x16x32_bf16 v[156:159], v[12:15], v[76:79], v[156:159]
    ds_read_b128 v[88:91], v99 offset:4096
    v_dot2_f32_bf16 v5, v247, v255, v5
    s_nop 2
    v_mfma_f32_16x16x32_bf16 v[152:155], v[12:15], v[72:75], v[152:155]
    ds_read_b128 v[92:95], v99 offset:6144
    v_add_f32_dpp v5, v5, v5 row_shr:1 row_mask:0xf bank_mask:0xf bound_ctrl:0
    s_nop 1
    v_add_f32_dpp v5, v5, v5 row_shr:2 row_mask:0xf bank_mask:0xf bound_ctrl:0
    v_mfma_f32_16x16x32_bf16 v[148:151], v[12:15], v[68:71], v[148:151]
    ds_read_b64_tr_b16 v[40:41], v101 offset:49152
    v_add_f32_dpp v5, v5, v5 row_shr:4 row_mask:0xf bank_mask:0xf bound_ctrl:0
    s_nop 1
    v_add_f32_dpp v5, v5, v5 row_shr:8 row_mask:0xf bank_mask:0xf bound_ctrl:0
    v_mfma_f32_16x16x32_bf16 v[144:147], v[12:15], v[64:67], v[144:147]
    ds_read_b64_tr_b16 v[42:43], v101 offset:49664
    v_add_f32_dpp v5, v5, v5 row_bcast:15 row_mask:0xa bank_mask:0xf
    s_nop 1
    v_add_f32_dpp v5, v5, v5 row_bcast:31 row_mask:0xc bank_mask:0xf
    v_mfma_f32_16x16x32_bf16 v[160:163], v[16:19], v[64:67], v[160:163]
    ds_read_b64_tr_b16 v[44:45], v100 offset:53248
    v_mov_b32 v6, 0x42200000
    v_med3_f32 v5, v5, -v6, v6
    v_mfma_f32_16x16x32_bf16 v[164:167], v[16:19], v[68:71], v[164:167]
    ds_read_b64_tr_b16 v[46:47], v100 offset:53760
    v_mul_f32 v5, s80, v5
    v_exp_f32 v5, v5
    v_mfma_f32_16x16x32_bf16 v[168:171], v[16:19], v[72:75], v[168:171]
    ds_read_b64_tr_b16 v[48:49], v101 offset:53248
    v_readlane_b32 s76, v5, 63
    s_nop 1
    v_mov_b32 v5, s76
    v_mfma_f32_16x16x32_bf16 v[172:175], v[16:19], v[76:79], v[172:175]
    ds_read_b64_tr_b16 v[50:51], v101 offset:53760
    buffer_store_dword v5, off, s[36:39], s87 sc1
    v_mfma_f32_16x16x32_bf16 v[188:191], v[20:23], v[76:79], v[188:191]
    ds_read_b64_tr_b16 v[52:53], v102 offset:49152
    v_mfma_f32_16x16x32_bf16 v[184:187], v[20:23], v[72:75], v[184:187]
    ds_read_b64_tr_b16 v[54:55], v102 offset:50176
    v_mfma_f32_16x16x32_bf16 v[180:183], v[20:23], v[68:71], v[180:183]
    ds_read_b64_tr_b16 v[56:57], v103 offset:49152
    v_mfma_f32_16x16x32_bf16 v[176:179], v[20:23], v[64:67], v[176:179]
    ds_read_b64_tr_b16 v[58:59], v103 offset:50176
    v_mfma_f32_16x16x32_bf16 v[192:195], v[24:27], v[64:67], v[192:195]
    ds_read_b64_tr_b16 v[60:61], v104 offset:49152
    v_mfma_f32_16x16x32_bf16 v[196:199], v[24:27], v[68:71], v[196:199]
    ds_read_b64_tr_b16 v[62:63], v104 offset:50176
    v_mfma_f32_16x16x32_bf16 v[200:203], v[24:27], v[72:75], v[200:203]
    v_mfma_f32_16x16x32_bf16 v[204:207], v[24:27], v[76:79], v[204:207]
    v_mfma_f32_16x16x32_bf16 v[220:223], v[28:31], v[76:79], v[220:223]
    v_mfma_f32_16x16x32_bf16 v[216:219], v[28:31], v[72:75], v[216:219]
    v_mfma_f32_16x16x32_bf16 v[212:215], v[28:31], v[68:71], v[212:215]
    v_mfma_f32_16x16x32_bf16 v[208:211], v[28:31], v[64:67], v[208:211]
    v_mfma_f32_16x16x32_bf16 v[224:227], v[32:35], v[64:67], v[224:227]
    v_mfma_f32_16x16x32_bf16 v[228:231], v[32:35], v[68:71], v[228:231]
    v_mfma_f32_16x16x32_bf16 v[232:235], v[32:35], v[72:75], v[232:235]
    v_mfma_f32_16x16x32_bf16 v[236:239], v[32:35], v[76:79], v[236:239]
    s_waitcnt vmcnt(63) lgkmcnt(0)
    s_barrier
    v_mfma_f32_16x16x32_bf16 v[128:131], v[36:39], v[80:83], v[128:131]
    s_add_u32 m0, s101, 0
    s_add_u32 s73, s97, 262144
    buffer_load_dwordx4 v114, s[44:47], s73 offen lds
    s_add_u32 m0, s101, 8192
    s_add_u32 s73, s97, 327680
    buffer_load_dwordx4 v114, s[44:47], s73 offen lds
    v_mfma_f32_16x16x32_bf16 v[132:135], v[36:39], v[84:87], v[132:135]
    v_mfma_f32_16x16x32_bf16 v[136:139], v[36:39], v[88:91], v[136:139]
    v_mfma_f32_16x16x32_bf16 v[140:143], v[36:39], v[92:95], v[140:143]
    s_add_u32 m0, s101, 16384
    s_add_u32 s73, s97, 524288
    buffer_load_dwordx4 v114, s[44:47], s73 offen lds
    s_add_u32 m0, s101, 24576
    s_add_u32 s73, s97, 589824
    buffer_load_dwordx4 v114, s[44:47], s73 offen lds
    v_mfma_f32_16x16x32_bf16 v[156:159], v[40:43], v[92:95], v[156:159]
    v_mfma_f32_16x16x32_bf16 v[152:155], v[40:43], v[88:91], v[152:155]
    v_mfma_f32_16x16x32_bf16 v[148:151], v[40:43], v[84:87], v[148:151]
    s_add_u32 m0, s101, 32768
    s_add_u32 s73, s97, 1179648
    buffer_load_dwordx4 v114, s[44:47], s73 offen lds
    s_add_u32 m0, s101, 40960
    s_add_u32 s73, s97, 1245184
    buffer_load_dwordx4 v114, s[44:47], s73 offen lds
    v_mfma_f32_16x16x32_bf16 v[144:147], v[40:43], v[80:83], v[144:147]
    v_mfma_f32_16x16x32_bf16 v[160:163], v[44:47], v[80:83], v[160:163]
    v_mfma_f32_16x16x32_bf16 v[164:167], v[44:47], v[84:87], v[164:167]
    s_add_u32 m0, s101, 49152
    s_add_u32 s73, s97, 1441792
    buffer_load_dwordx4 v114, s[44:47], s73 offen lds
    s_add_u32 m0, s101, 57344
    s_add_u32 s73, s97, 1507328
    buffer_load_dwordx4 v114, s[44:47], s73 offen lds
    v_mfma_f32_16x16x32_bf16 v[168:171], v[44:47], v[88:91], v[168:171]
    v_mfma_f32_16x16x32_bf16 v[172:175], v[44:47], v[92:95], v[172:175]
    v_mfma_f32_16x16x32_bf16 v[188:191], v[48:51], v[92:95], v[188:191]
    s_add_u32 m0, s101, 65536
    s_add_u32 s73, s97, 196608
    buffer_load_dwordx4 v114, s[44:47], s73 offen lds
    s_add_u32 m0, s101, 73728
    s_add_u32 s73, s97, 393216
    buffer_load_dwordx4 v114, s[44:47], s73 offen lds
    v_mfma_f32_16x16x32_bf16 v[184:187], v[48:51], v[88:91], v[184:187]
    v_mfma_f32_16x16x32_bf16 v[180:183], v[48:51], v[84:87], v[180:183]
    v_mfma_f32_16x16x32_bf16 v[176:179], v[48:51], v[80:83], v[176:179]
    s_add_u32 m0, s101, 81920
    s_add_u32 s73, s97, 458752
    buffer_load_dwordx4 v114, s[44:47], s73 offen lds
    s_add_u32 m0, s101, 90112
    s_add_u32 s73, s97, 655360
    buffer_load_dwordx4 v114, s[44:47], s73 offen lds
    v_mfma_f32_16x16x32_bf16 v[192:195], v[52:55], v[80:83], v[192:195]
    v_mfma_f32_16x16x32_bf16 v[196:199], v[52:55], v[84:87], v[196:199]
    v_mfma_f32_16x16x32_bf16 v[200:203], v[52:55], v[88:91], v[200:203]
    s_add_u32 m0, s101, 98304
    s_add_u32 s73, s97, 1114112
    buffer_load_dwordx4 v114, s[44:47], s73 offen lds
    s_add_u32 m0, s101, 106496
    s_add_u32 s73, s97, 1310720
    buffer_load_dwordx4 v114, s[44:47], s73 offen lds
    v_mfma_f32_16x16x32_bf16 v[204:207], v[52:55], v[92:95], v[204:207]
    v_mfma_f32_16x16x32_bf16 v[220:223], v[56:59], v[92:95], v[220:223]
    v_mfma_f32_16x16x32_bf16 v[216:219], v[56:59], v[88:91], v[216:219]
    v_mfma_f32_16x16x32_bf16 v[212:215], v[56:59], v[84:87], v[212:215]
    v_mfma_f32_16x16x32_bf16 v[208:211], v[56:59], v[80:83], v[208:211]
    v_mfma_f32_16x16x32_bf16 v[224:227], v[60:63], v[80:83], v[224:227]
    v_mfma_f32_16x16x32_bf16 v[228:231], v[60:63], v[84:87], v[228:231]
    v_mfma_f32_16x16x32_bf16 v[232:235], v[60:63], v[88:91], v[232:235]
    v_mfma_f32_16x16x32_bf16 v[236:239], v[60:63], v[92:95], v[236:239]
    s_setprio 2
    s_setprio 3
    s_mov_b32 s79, 0
K1_v10b_nchk:
    v_readfirstlane_b32 s83, v110
    s_nop 1
    s_cmp_lg_u32 s83, 0
    s_cbranch_scc1 K1_v10b_nok
    s_sleep 8
    buffer_load_dword v110, off, s[40:43], 0 sc1
    s_add_u32 s79, s79, 1
    s_waitcnt vmcnt(0)
    s_cmp_lt_u32 s79, 100000
    s_cbranch_scc1 K1_v10b_nchk
K1_v10b_nok:
    s_nop 7
    s_add_u32 s75, s65, 0
    s_lshr_b32 s75, s75, 1
    s_lshl_b32 s75, s75, 10
    s_add_u32 s75, s75, s92
    v_pk_mul_f32 v[240:241], v[160:161], s[80:81] op_sel_hi:[1,0]
    v_pk_mul_f32 v[242:243], v[162:163], s[80:81] op_sel_hi:[1,0]
    v_exp_f32 v240, v240
    v_exp_f32 v241, v241
    v_exp_f32 v242, v242
    v_exp_f32 v243, v243
    v_pk_fma_f32 v[244:245], v[240:241], -0.5, -1.0 op_sel_hi:[1,0,0]
    v_pk_fma_f32 v[246:247], v[242:243], -0.5, -1.0 op_sel_hi:[1,0,0]
    v_pk_fma_f32 v[244:245], v[240:241], v[244:245], -1.0 op_sel_hi:[1,1,0]
    v_pk_fma_f32 v[246:247], v[242:243], v[246:247], -1.0 op_sel_hi:[1,1,0]
    v_rcp_f32 v244, v244
    v_rcp_f32 v245, v245
    v_rcp_f32 v246, v246
    v_rcp_f32 v247, v247
    v_pk_fma_f32 v[160:161], v[160:161], v[244:245], v[160:161]
    v_pk_fma_f32 v[162:163], v[162:163], v[246:247], v[162:163]
    v_pk_mul_f32 v[116:117], v[176:177], s[80:81] op_sel_hi:[1,0]
    v_pk_mul_f32 v[118:119], v[178:179], s[80:81] op_sel_hi:[1,0]
    v_exp_f32 v116, v116
    v_exp_f32 v117, v117
    v_exp_f32 v118, v118
    v_exp_f32 v119, v119
    v_pk_fma_f32 v[120:121], v[116:117], -0.5, -1.0 op_sel_hi:[1,0,0]
    v_pk_fma_f32 v[122:123], v[118:119], -0.5, -1.0 op_sel_hi:[1,0,0]
    v_pk_fma_f32 v[120:121], v[116:117], v[120:121], -1.0 op_sel_hi:[1,1,0]
    v_pk_fma_f32 v[122:123], v[118:119], v[122:123], -1.0 op_sel_hi:[1,1,0]
    v_rcp_f32 v120, v120
    v_rcp_f32 v121, v121
    v_rcp_f32 v122, v122
    v_rcp_f32 v123, v123
    v_pk_fma_f32 v[176:177], v[176:177], v[120:121], v[176:177]
    v_pk_fma_f32 v[178:179], v[178:179], v[122:123], v[178:179]
    v_cvt_pk_bf16_f32 v72, v160, v161
    v_cvt_pk_bf16_f32 v73, v162, v163
    v_cvt_pk_bf16_f32 v74, v176, v177
    v_cvt_pk_bf16_f32 v75, v178, v179
    buffer_store_dwordx4 v[72:75], v113, s[36:39], s75 offen sc1
    s_add_u32 s75, s75, 147456
    v_pk_mul_f32 v[240:241], v[164:165], s[80:81] op_sel_hi:[1,0]
    v_pk_mul_f32 v[242:243], v[166:167], s[80:81] op_sel_hi:[1,0]
    v_exp_f32 v240, v240
    v_exp_f32 v241, v241
    v_exp_f32 v242, v242
    v_exp_f32 v243, v243
    v_pk_fma_f32 v[244:245], v[240:241], -0.5, -1.0 op_sel_hi:[1,0,0]
    v_pk_fma_f32 v[246:247], v[242:243], -0.5, -1.0 op_sel_hi:[1,0,0]
    v_pk_fma_f32 v[244:245], v[240:241], v[244:245], -1.0 op_sel_hi:[1,1,0]
    v_pk_fma_f32 v[246:247], v[242:243], v[246:247], -1.0 op_sel_hi:[1,1,0]
    v_rcp_f32 v244, v244
    v_rcp_f32 v245, v245
    v_rcp_f32 v246, v246
    v_rcp_f32 v247, v247
    v_pk_fma_f32 v[164:165], v[164:165], v[244:245], v[164:165]
    v_pk_fma_f32 v[166:167], v[166:167], v[246:247], v[166:167]
    v_pk_mul_f32 v[116:117], v[180:181], s[80:81] op_sel_hi:[1,0]
    v_pk_mul_f32 v[118:119], v[182:183], s[80:81] op_sel_hi:[1,0]
    v_exp_f32 v116, v116
    v_exp_f32 v117, v117
    v_exp_f32 v118, v118
    v_exp_f32 v119, v119
    v_pk_fma_f32 v[120:121], v[116:117], -0.5, -1.0 op_sel_hi:[1,0,0]
    v_pk_fma_f32 v[122:123], v[118:119], -0.5, -1.0 op_sel_hi:[1,0,0]
    v_pk_fma_f32 v[120:121], v[116:117], v[120:121], -1.0 op_sel_hi:[1,1,0]
    v_pk_fma_f32 v[122:123], v[118:119], v[122:123], -1.0 op_sel_hi:[1,1,0]
    v_rcp_f32 v120, v120
    v_rcp_f32 v121, v121
    v_rcp_f32 v122, v122
    v_rcp_f32 v123, v123
    v_pk_fma_f32 v[180:181], v[180:181], v[120:121], v[180:181]
    v_pk_fma_f32 v[182:183], v[182:183], v[122:123], v[182:183]
    v_cvt_pk_bf16_f32 v76, v164, v165
    v_cvt_pk_bf16_f32 v77, v166, v167
    v_cvt_pk_bf16_f32 v78, v180, v181
    v_cvt_pk_bf16_f32 v79, v182, v183
    buffer_store_dwordx4 v[76:79], v113, s[36:39], s75 offen sc1
    s_add_u32 s75, s75, 147456
    v_pk_mul_f32 v[240:241], v[168:169], s[80:81] op_sel_hi:[1,0]
    v_pk_mul_f32 v[242:243], v[170:171], s[80:81] op_sel_hi:[1,0]
    v_exp_f32 v240, v240
    v_exp_f32 v241, v241
    v_exp_f32 v242, v242
    v_exp_f32 v243, v243
    v_pk_fma_f32 v[244:245], v[240:241], -0.5, -1.0 op_sel_hi:[1,0,0]
    v_pk_fma_f32 v[246:247], v[242:243], -0.5, -1.0 op_sel_hi:[1,0,0]
    v_pk_fma_f32 v[244:245], v[240:241], v[244:245], -1.0 op_sel_hi:[1,1,0]
    v_pk_fma_f32 v[246:247], v[242:243], v[246:247], -1.0 op_sel_hi:[1,1,0]
    v_rcp_f32 v244, v244
    v_rcp_f32 v245, v245
    v_rcp_f32 v246, v246
    v_rcp_f32 v247, v247
    v_pk_fma_f32 v[168:169], v[168:169], v[244:245], v[168:169]
    v_pk_fma_f32 v[170:171], v[170:171], v[246:247], v[170:171]
    v_pk_mul_f32 v[116:117], v[184:185], s[80:81] op_sel_hi:[1,0]
    v_pk_mul_f32 v[118:119], v[186:187], s[80:81] op_sel_hi:[1,0]
    v_exp_f32 v116, v116
    v_exp_f32 v117, v117
    v_exp_f32 v118, v118
    v_exp_f32 v119, v119
    v_pk_fma_f32 v[120:121], v[116:117], -0.5, -1.0 op_sel_hi:[1,0,0]
    v_pk_fma_f32 v[122:123], v[118:119], -0.5, -1.0 op_sel_hi:[1,0,0]
    v_pk_fma_f32 v[120:121], v[116:117], v[120:121], -1.0 op_sel_hi:[1,1,0]
    v_pk_fma_f32 v[122:123], v[118:119], v[122:123], -1.0 op_sel_hi:[1,1,0]
    v_rcp_f32 v120, v120
    v_rcp_f32 v121, v121
    v_rcp_f32 v122, v122
    v_rcp_f32 v123, v123
    v_pk_fma_f32 v[184:185], v[184:185], v[120:121], v[184:185]
    v_pk_fma_f32 v[186:187], v[186:187], v[122:123], v[186:187]
    v_cvt_pk_bf16_f32 v72, v168, v169
    v_cvt_pk_bf16_f32 v73, v170, v171
    v_cvt_pk_bf16_f32 v74, v184, v185
    v_cvt_pk_bf16_f32 v75, v186, v187
    buffer_store_dwordx4 v[72:75], v113, s[36:39], s75 offen sc1
    s_add_u32 s75, s75, 147456
    v_pk_mul_f32 v[240:241], v[172:173], s[80:81] op_sel_hi:[1,0]
    v_pk_mul_f32 v[242:243], v[174:175], s[80:81] op_sel_hi:[1,0]
    v_exp_f32 v240, v240
    v_exp_f32 v241, v241
    v_exp_f32 v242, v242
    v_exp_f32 v243, v243
    v_pk_fma_f32 v[244:245], v[240:241], -0.5, -1.0 op_sel_hi:[1,0,0]
    v_pk_fma_f32 v[246:247], v[242:243], -0.5, -1.0 op_sel_hi:[1,0,0]
    v_pk_fma_f32 v[244:245], v[240:241], v[244:245], -1.0 op_sel_hi:[1,1,0]
    v_pk_fma_f32 v[246:247], v[242:243], v[246:247], -1.0 op_sel_hi:[1,1,0]
    v_rcp_f32 v244, v244
    v_rcp_f32 v245, v245
    v_rcp_f32 v246, v246
    v_rcp_f32 v247, v247
    v_pk_fma_f32 v[172:173], v[172:173], v[244:245], v[172:173]
    v_pk_fma_f32 v[174:175], v[174:175], v[246:247], v[174:175]
    v_pk_mul_f32 v[116:117], v[188:189], s[80:81] op_sel_hi:[1,0]
    v_pk_mul_f32 v[118:119], v[190:191], s[80:81] op_sel_hi:[1,0]
    v_exp_f32 v116, v116
    v_exp_f32 v117, v117
    v_exp_f32 v118, v118
    v_exp_f32 v119, v119
    v_pk_fma_f32 v[120:121], v[116:117], -0.5, -1.0 op_sel_hi:[1,0,0]
    v_pk_fma_f32 v[122:123], v[118:119], -0.5, -1.0 op_sel_hi:[1,0,0]
    v_pk_fma_f32 v[120:121], v[116:117], v[120:121], -1.0 op_sel_hi:[1,1,0]
    v_pk_fma_f32 v[122:123], v[118:119], v[122:123], -1.0 op_sel_hi:[1,1,0]
    v_rcp_f32 v120, v120
    v_rcp_f32 v121, v121
    v_rcp_f32 v122, v122
    v_rcp_f32 v123, v123
    v_pk_fma_f32 v[188:189], v[188:189], v[120:121], v[188:189]
    v_pk_fma_f32 v[190:191], v[190:191], v[122:123], v[190:191]
    v_cvt_pk_bf16_f32 v76, v172, v173
    v_cvt_pk_bf16_f32 v77, v174, v175
    v_cvt_pk_bf16_f32 v78, v188, v189
    v_cvt_pk_bf16_f32 v79, v190, v191
    buffer_store_dwordx4 v[76:79], v113, s[36:39], s75 offen sc1
    s_setprio 2
    s_add_u32 s75, s62, 0
    s_lshr_b32 s75, s75, 1
    s_lshl_b32 s75, s75, 10
    s_add_u32 s75, s75, s92
    v_pk_mul_f32 v[240:241], v[192:193], s[80:81] op_sel_hi:[1,0]
    v_pk_mul_f32 v[242:243], v[194:195], s[80:81] op_sel_hi:[1,0]
    v_exp_f32 v240, v240
    v_exp_f32 v241, v241
    v_exp_f32 v242, v242
    v_exp_f32 v243, v243
    v_pk_fma_f32 v[244:245], v[240:241], -0.5, -1.0 op_sel_hi:[1,0,0]
    v_pk_fma_f32 v[246:247], v[242:243], -0.5, -1.0 op_sel_hi:[1,0,0]
    v_pk_fma_f32 v[244:245], v[240:241], v[244:245], -1.0 op_sel_hi:[1,1,0]
    v_pk_fma_f32 v[246:247], v[242:243], v[246:247], -1.0 op_sel_hi:[1,1,0]
    v_rcp_f32 v244, v244
    v_rcp_f32 v245, v245
    v_rcp_f32 v246, v246
    v_rcp_f32 v247, v247
    v_pk_fma_f32 v[192:193], v[192:193], v[244:245], v[192:193]
    v_pk_fma_f32 v[194:195], v[194:195], v[246:247], v[194:195]
    v_pk_mul_f32 v[116:117], v[208:209], s[80:81] op_sel_hi:[1,0]
    v_pk_mul_f32 v[118:119], v[210:211], s[80:81] op_sel_hi:[1,0]
    v_exp_f32 v116, v116
    v_exp_f32 v117, v117
    v_exp_f32 v118, v118
    v_exp_f32 v119, v119
    v_pk_fma_f32 v[120:121], v[116:117], -0.5, -1.0 op_sel_hi:[1,0,0]
    v_pk_fma_f32 v[122:123], v[118:119], -0.5, -1.0 op_sel_hi:[1,0,0]
    v_pk_fma_f32 v[120:121], v[116:117], v[120:121], -1.0 op_sel_hi:[1,1,0]
    v_pk_fma_f32 v[122:123], v[118:119], v[122:123], -1.0 op_sel_hi:[1,1,0]
    v_rcp_f32 v120, v120
    v_rcp_f32 v121, v121
    v_rcp_f32 v122, v122
    v_rcp_f32 v123, v123
    v_pk_fma_f32 v[208:209], v[208:209], v[120:121], v[208:209]
    v_pk_fma_f32 v[210:211], v[210:211], v[122:123], v[210:211]
    v_cvt_pk_bf16_f32 v72, v192, v193
    v_cvt_pk_bf16_f32 v73, v194, v195
    v_cvt_pk_bf16_f32 v74, v208, v209
    v_cvt_pk_bf16_f32 v75, v210, v211
    buffer_store_dwordx4 v[72:75], v113, s[36:39], s75 offen sc1
    s_add_u32 s75, s75, 147456
    v_pk_mul_f32 v[240:241], v[196:197], s[80:81] op_sel_hi:[1,0]
    v_pk_mul_f32 v[242:243], v[198:199], s[80:81] op_sel_hi:[1,0]
    v_exp_f32 v240, v240
    v_exp_f32 v241, v241
    v_exp_f32 v242, v242
    v_exp_f32 v243, v243
    v_pk_fma_f32 v[244:245], v[240:241], -0.5, -1.0 op_sel_hi:[1,0,0]
    v_pk_fma_f32 v[246:247], v[242:243], -0.5, -1.0 op_sel_hi:[1,0,0]
    v_pk_fma_f32 v[244:245], v[240:241], v[244:245], -1.0 op_sel_hi:[1,1,0]
    v_pk_fma_f32 v[246:247], v[242:243], v[246:247], -1.0 op_sel_hi:[1,1,0]
    v_rcp_f32 v244, v244
    v_rcp_f32 v245, v245
    v_rcp_f32 v246, v246
    v_rcp_f32 v247, v247
    v_pk_fma_f32 v[196:197], v[196:197], v[244:245], v[196:197]
    v_pk_fma_f32 v[198:199], v[198:199], v[246:247], v[198:199]
    v_pk_mul_f32 v[116:117], v[212:213], s[80:81] op_sel_hi:[1,0]
    v_pk_mul_f32 v[118:119], v[214:215], s[80:81] op_sel_hi:[1,0]
    v_exp_f32 v116, v116
    v_exp_f32 v117, v117
    v_exp_f32 v118, v118
    v_exp_f32 v119, v119
    v_pk_fma_f32 v[120:121], v[116:117], -0.5, -1.0 op_sel_hi:[1,0,0]
    v_pk_fma_f32 v[122:123], v[118:119], -0.5, -1.0 op_sel_hi:[1,0,0]
    v_pk_fma_f32 v[120:121], v[116:117], v[120:121], -1.0 op_sel_hi:[1,1,0]
    v_pk_fma_f32 v[122:123], v[118:119], v[122:123], -1.0 op_sel_hi:[1,1,0]
    v_rcp_f32 v120, v120
    v_rcp_f32 v121, v121
    v_rcp_f32 v122, v122
    v_rcp_f32 v123, v123
    v_pk_fma_f32 v[212:213], v[212:213], v[120:121], v[212:213]
    v_pk_fma_f32 v[214:215], v[214:215], v[122:123], v[214:215]
    v_cvt_pk_bf16_f32 v76, v196, v197
    v_cvt_pk_bf16_f32 v77, v198, v199
    v_cvt_pk_bf16_f32 v78, v212, v213
    v_cvt_pk_bf16_f32 v79, v214, v215
    buffer_store_dwordx4 v[76:79], v113, s[36:39], s75 offen sc1
    s_add_u32 s75, s75, 147456
    v_pk_mul_f32 v[240:241], v[200:201], s[80:81] op_sel_hi:[1,0]
    v_pk_mul_f32 v[242:243], v[202:203], s[80:81] op_sel_hi:[1,0]
    v_exp_f32 v240, v240
    v_exp_f32 v241, v241
    v_exp_f32 v242, v242
    v_exp_f32 v243, v243
    v_pk_fma_f32 v[244:245], v[240:241], -0.5, -1.0 op_sel_hi:[1,0,0]
    v_pk_fma_f32 v[246:247], v[242:243], -0.5, -1.0 op_sel_hi:[1,0,0]
    v_pk_fma_f32 v[244:245], v[240:241], v[244:245], -1.0 op_sel_hi:[1,1,0]
    v_pk_fma_f32 v[246:247], v[242:243], v[246:247], -1.0 op_sel_hi:[1,1,0]
    v_rcp_f32 v244, v244
    v_rcp_f32 v245, v245
    v_rcp_f32 v246, v246
    v_rcp_f32 v247, v247
    v_pk_fma_f32 v[200:201], v[200:201], v[244:245], v[200:201]
    v_pk_fma_f32 v[202:203], v[202:203], v[246:247], v[202:203]
    v_pk_mul_f32 v[116:117], v[216:217], s[80:81] op_sel_hi:[1,0]
    v_pk_mul_f32 v[118:119], v[218:219], s[80:81] op_sel_hi:[1,0]
    v_exp_f32 v116, v116
    v_exp_f32 v117, v117
    v_exp_f32 v118, v118
    v_exp_f32 v119, v119
    v_pk_fma_f32 v[120:121], v[116:117], -0.5, -1.0 op_sel_hi:[1,0,0]
    v_pk_fma_f32 v[122:123], v[118:119], -0.5, -1.0 op_sel_hi:[1,0,0]
    v_pk_fma_f32 v[120:121], v[116:117], v[120:121], -1.0 op_sel_hi:[1,1,0]
    v_pk_fma_f32 v[122:123], v[118:119], v[122:123], -1.0 op_sel_hi:[1,1,0]
    v_rcp_f32 v120, v120
    v_rcp_f32 v121, v121
    v_rcp_f32 v122, v122
    v_rcp_f32 v123, v123
    v_pk_fma_f32 v[216:217], v[216:217], v[120:121], v[216:217]
    v_pk_fma_f32 v[218:219], v[218:219], v[122:123], v[218:219]
    v_cvt_pk_bf16_f32 v72, v200, v201
    v_cvt_pk_bf16_f32 v73, v202, v203
    v_cvt_pk_bf16_f32 v74, v216, v217
    v_cvt_pk_bf16_f32 v75, v218, v219
    buffer_store_dwordx4 v[72:75], v113, s[36:39], s75 offen sc1
    s_add_u32 s75, s75, 147456
    v_pk_mul_f32 v[240:241], v[204:205], s[80:81] op_sel_hi:[1,0]
    v_pk_mul_f32 v[242:243], v[206:207], s[80:81] op_sel_hi:[1,0]
    v_exp_f32 v240, v240
    v_exp_f32 v241, v241
    v_exp_f32 v242, v242
    v_exp_f32 v243, v243
    v_pk_fma_f32 v[244:245], v[240:241], -0.5, -1.0 op_sel_hi:[1,0,0]
    v_pk_fma_f32 v[246:247], v[242:243], -0.5, -1.0 op_sel_hi:[1,0,0]
    v_pk_fma_f32 v[244:245], v[240:241], v[244:245], -1.0 op_sel_hi:[1,1,0]
    v_pk_fma_f32 v[246:247], v[242:243], v[246:247], -1.0 op_sel_hi:[1,1,0]
    v_rcp_f32 v244, v244
    v_rcp_f32 v245, v245
    v_rcp_f32 v246, v246
    v_rcp_f32 v247, v247
    v_pk_fma_f32 v[204:205], v[204:205], v[244:245], v[204:205]
    v_pk_fma_f32 v[206:207], v[206:207], v[246:247], v[206:207]
    v_pk_mul_f32 v[116:117], v[220:221], s[80:81] op_sel_hi:[1,0]
    v_pk_mul_f32 v[118:119], v[222:223], s[80:81] op_sel_hi:[1,0]
    v_exp_f32 v116, v116
    v_exp_f32 v117, v117
    v_exp_f32 v118, v118
    v_exp_f32 v119, v119
    v_pk_fma_f32 v[120:121], v[116:117], -0.5, -1.0 op_sel_hi:[1,0,0]
    v_pk_fma_f32 v[122:123], v[118:119], -0.5, -1.0 op_sel_hi:[1,0,0]
    v_pk_fma_f32 v[120:121], v[116:117], v[120:121], -1.0 op_sel_hi:[1,1,0]
    v_pk_fma_f32 v[122:123], v[118:119], v[122:123], -1.0 op_sel_hi:[1,1,0]
    v_rcp_f32 v120, v120
    v_rcp_f32 v121, v121
    v_rcp_f32 v122, v122
    v_rcp_f32 v123, v123
    v_pk_fma_f32 v[220:221], v[220:221], v[120:121], v[220:221]
    v_pk_fma_f32 v[222:223], v[222:223], v[122:123], v[222:223]
    v_cvt_pk_bf16_f32 v76, v204, v205
    v_cvt_pk_bf16_f32 v77, v206, v207
    v_cvt_pk_bf16_f32 v78, v220, v221
    v_cvt_pk_bf16_f32 v79, v222, v223
    buffer_store_dwordx4 v[76:79], v113, s[36:39], s75 offen sc1
    s_lshr_b32 s75, s64, 1
    s_lshl_b32 s75, s75, 10
    s_add_u32 s75, s75, s92
    s_and_b32 s76, s64, 1
    s_mul_i32 s76, s76, 147456
    s_add_u32 s75, s75, s76
    v_pk_mul_f32 v[240:241], v[224:225], s[80:81] op_sel_hi:[1,0]
    v_pk_mul_f32 v[242:243], v[226:227], s[80:81] op_sel_hi:[1,0]
    v_exp_f32 v240, v240
    v_exp_f32 v241, v241
    v_exp_f32 v242, v242
    v_exp_f32 v243, v243
    v_pk_fma_f32 v[244:245], v[240:241], -0.5, -1.0 op_sel_hi:[1,0,0]
    v_pk_fma_f32 v[246:247], v[242:243], -0.5, -1.0 op_sel_hi:[1,0,0]
    v_pk_fma_f32 v[244:245], v[240:241], v[244:245], -1.0 op_sel_hi:[1,1,0]
    v_pk_fma_f32 v[246:247], v[242:243], v[246:247], -1.0 op_sel_hi:[1,1,0]
    v_rcp_f32 v244, v244
    v_rcp_f32 v245, v245
    v_rcp_f32 v246, v246
    v_rcp_f32 v247, v247
    v_pk_fma_f32 v[224:225], v[224:225], v[244:245], v[224:225]
    v_pk_fma_f32 v[226:227], v[226:227], v[246:247], v[226:227]
    v_pk_mul_f32 v[116:117], v[228:229], s[80:81] op_sel_hi:[1,0]
    v_pk_mul_f32 v[118:119], v[230:231], s[80:81] op_sel_hi:[1,0]
    v_exp_f32 v116, v116
    v_exp_f32 v117, v117
    v_exp_f32 v118, v118
    v_exp_f32 v119, v119
    v_pk_fma_f32 v[120:121], v[116:117], -0.5, -1.0 op_sel_hi:[1,0,0]
    v_pk_fma_f32 v[122:123], v[118:119], -0.5, -1.0 op_sel_hi:[1,0,0]
    v_pk_fma_f32 v[120:121], v[116:117], v[120:121], -1.0 op_sel_hi:[1,1,0]
    v_pk_fma_f32 v[122:123], v[118:119], v[122:123], -1.0 op_sel_hi:[1,1,0]
    v_rcp_f32 v120, v120
    v_rcp_f32 v121, v121
    v_rcp_f32 v122, v122
    v_rcp_f32 v123, v123
    v_pk_fma_f32 v[228:229], v[228:229], v[120:121], v[228:229]
    v_pk_fma_f32 v[230:231], v[230:231], v[122:123], v[230:231]
    v_cvt_pk_bf16_f32 v72, v224, v225
    v_cvt_pk_bf16_f32 v73, v226, v227
    v_cvt_pk_bf16_f32 v74, v228, v229
    v_cvt_pk_bf16_f32 v75, v230, v231
    buffer_store_dwordx4 v[72:75], v113, s[36:39], s75 offen sc1
    s_add_u32 s75, s75, 294912
    v_pk_mul_f32 v[240:241], v[232:233], s[80:81] op_sel_hi:[1,0]
    v_pk_mul_f32 v[242:243], v[234:235], s[80:81] op_sel_hi:[1,0]
    v_exp_f32 v240, v240
    v_exp_f32 v241, v241
    v_exp_f32 v242, v242
    v_exp_f32 v243, v243
    v_pk_fma_f32 v[244:245], v[240:241], -0.5, -1.0 op_sel_hi:[1,0,0]
    v_pk_fma_f32 v[246:247], v[242:243], -0.5, -1.0 op_sel_hi:[1,0,0]
    v_pk_fma_f32 v[244:245], v[240:241], v[244:245], -1.0 op_sel_hi:[1,1,0]
    v_pk_fma_f32 v[246:247], v[242:243], v[246:247], -1.0 op_sel_hi:[1,1,0]
    v_rcp_f32 v244, v244
    v_rcp_f32 v245, v245
    v_rcp_f32 v246, v246
    v_rcp_f32 v247, v247
    v_pk_fma_f32 v[232:233], v[232:233], v[244:245], v[232:233]
    v_pk_fma_f32 v[234:235], v[234:235], v[246:247], v[234:235]
    v_pk_mul_f32 v[116:117], v[236:237], s[80:81] op_sel_hi:[1,0]
    v_pk_mul_f32 v[118:119], v[238:239], s[80:81] op_sel_hi:[1,0]
    v_exp_f32 v116, v116
    v_exp_f32 v117, v117
    v_exp_f32 v118, v118
    v_exp_f32 v119, v119
    v_pk_fma_f32 v[120:121], v[116:117], -0.5, -1.0 op_sel_hi:[1,0,0]
    v_pk_fma_f32 v[122:123], v[118:119], -0.5, -1.0 op_sel_hi:[1,0,0]
    v_pk_fma_f32 v[120:121], v[116:117], v[120:121], -1.0 op_sel_hi:[1,1,0]
    v_pk_fma_f32 v[122:123], v[118:119], v[122:123], -1.0 op_sel_hi:[1,1,0]
    v_rcp_f32 v120, v120
    v_rcp_f32 v121, v121
    v_rcp_f32 v122, v122
    v_rcp_f32 v123, v123
    v_pk_fma_f32 v[236:237], v[236:237], v[120:121], v[236:237]
    v_pk_fma_f32 v[238:239], v[238:239], v[122:123], v[238:239]
    v_cvt_pk_bf16_f32 v76, v232, v233
    v_cvt_pk_bf16_f32 v77, v234, v235
    v_cvt_pk_bf16_f32 v78, v236, v237
    v_cvt_pk_bf16_f32 v79, v238, v239
    buffer_store_dwordx4 v[76:79], v113, s[36:39], s75 offen sc1
    s_branch P2_start
K1_v11:
    s_barrier
    ds_read_b64_tr_b16 v[8:9], v100 offset:0
    ds_read_b64_tr_b16 v[10:11], v100 offset:512
    ds_read_b128 v[64:67], v98 offset:0
    ds_read_b128 v[68:71], v98 offset:2048
    ds_read_b128 v[72:75], v98 offset:4096
    ds_read_b128 v[76:79], v98 offset:6144
    ds_read_b64_tr_b16 v[12:13], v101 offset:0
    ds_read_b64_tr_b16 v[14:15], v101 offset:512
    ds_read_b64_tr_b16 v[16:17], v100 offset:4096
    ds_read_b64_tr_b16 v[18:19], v100 offset:4608
    ds_read_b64_tr_b16 v[20:21], v101 offset:4096
    ds_read_b64_tr_b16 v[22:23], v101 offset:4608
    ds_read_b64_tr_b16 v[24:25], v102 offset:0
    ds_read_b64_tr_b16 v[26:27], v102 offset:1024
    ds_read_b64_tr_b16 v[28:29], v103 offset:0
    ds_read_b64_tr_b16 v[30:31], v103 offset:1024
    s_mov_b32 s72, 1
    s_waitcnt vmcnt(6) lgkmcnt(0)
    s_barrier
    v_mfma_f32_16x16x32_bf16 v[128:131], v[8:11], v[64:67], v[128:131]
    ds_read_b64_tr_b16 v[36:37], v100 offset:16384
    v_mfma_f32_16x16x32_bf16 v[132:135], v[8:11], v[68:71], v[132:135]
    ds_read_b64_tr_b16 v[38:39], v100 offset:16896
    s_add_u32 m0, s77, 49152
    s_nop 0
    buffer_load_dwordx4 v107, s[32:35], s67 offen offset:0 lds
    v_mfma_f32_16x16x32_bf16 v[136:139], v[8:11], v[72:75], v[136:139]
    ds_read_b128 v[80:83], v99 offset:0
    v_mfma_f32_16x16x32_bf16 v[140:143], v[8:11], v[76:79], v[140:143]
    ds_read_b128 v[84:87], v99 offset:2048
    v_mfma_f32_16x16x32_bf16 v[156:159], v[12:15], v[76:79], v[156:159]
    ds_read_b128 v[88:91], v99 offset:4096
    buffer_load_dwordx4 v108, s[32:35], s67 offen offset:1024 lds
    v_mfma_f32_16x16x32_bf16 v[152:155], v[12:15], v[72:75], v[152:155]
    ds_read_b128 v[92:95], v99 offset:6144
    v_mfma_f32_16x16x32_bf16 v[148:151], v[12:15], v[68:71], v[148:151]
    ds_read_b64_tr_b16 v[40:41], v101 offset:16384
    v_mfma_f32_16x16x32_bf16 v[144:147], v[12:15], v[64:67], v[144:147]
    ds_read_b64_tr_b16 v[42:43], v101 offset:16896
    s_add_u32 s67, s67, s68
    s_add_u32 s69, s69, 128
    s_add_u32 s70, s70, 32768
    s_cmp_eq_u32 s70, 98304
    s_cselect_b32 s70, 0, s70
    s_add_u32 m0, s70, s78
    s_nop 0
    buffer_load_dwordx4 v105, s[28:31], s69 offen offset:0 lds
    v_mfma_f32_16x16x32_bf16 v[160:163], v[16:19], v[64:67], v[160:163]
    ds_read_b64_tr_b16 v[44:45], v100 offset:20480
    v_mfma_f32_16x16x32_bf16 v[164:167], v[16:19], v[68:71], v[164:167]
    ds_read_b64_tr_b16 v[46:47], v100 offset:20992
    v_mfma_f32_16x16x32_bf16 v[168:171], v[16:19], v[72:75], v[168:171]
    ds_read_b64_tr_b16 v[48:49], v101 offset:20480
    buffer_load_dwordx4 v106, s[28:31], s69 offen offset:1024 lds
    v_mfma_f32_16x16x32_bf16 v[172:175], v[16:19], v[76:79], v[172:175]
    ds_read_b64_tr_b16 v[50:51], v101 offset:20992
    v_mfma_f32_16x16x32_bf16 v[188:191], v[20:23], v[76:79], v[188:191]
    ds_read_b64_tr_b16 v[52:53], v102 offset:16384
    v_mfma_f32_16x16x32_bf16 v[184:187], v[20:23], v[72:75], v[184:187]
    ds_read_b64_tr_b16 v[54:55], v102 offset:17408
    s_add_u32 m0, s77, 0
    s_nop 0
    buffer_load_dwordx4 v107, s[32:35], s67 offen offset:0 lds
    v_mfma_f32_16x16x32_bf16 v[180:183], v[20:23], v[68:71], v[180:183]
    ds_read_b64_tr_b16 v[56:57], v103 offset:16384
    v_mfma_f32_16x16x32_bf16 v[176:179], v[20:23], v[64:67], v[176:179]
    ds_read_b64_tr_b16 v[58:59], v103 offset:17408
    v_mfma_f32_16x16x32_bf16 v[192:195], v[24:27], v[64:67], v[192:195]
    buffer_load_dwordx4 v108, s[32:35], s67 offen offset:1024 lds
    v_mfma_f32_16x16x32_bf16 v[196:199], v[24:27], v[68:71], v[196:199]
    v_mfma_f32_16x16x32_bf16 v[200:203], v[24:27], v[72:75], v[200:203]
    v_mfma_f32_16x16x32_bf16 v[204:207], v[24:27], v[76:79], v[204:207]
    s_add_u32 s67, s67, s68
    s_add_u32 s73, s69, 262144
    s_add_u32 s74, s70, s78
    s_add_u32 m0, s74, 16384
    s_nop 0
    buffer_load_dwordx4 v105, s[28:31], s73 offen offset:0 lds
    v_mfma_f32_16x16x32_bf16 v[220:223], v[28:31], v[76:79], v[220:223]
    v_mfma_f32_16x16x32_bf16 v[216:219], v[28:31], v[72:75], v[216:219]
    v_mfma_f32_16x16x32_bf16 v[212:215], v[28:31], v[68:71], v[212:215]
    buffer_load_dwordx4 v106, s[28:31], s73 offen offset:1024 lds
    v_mfma_f32_16x16x32_bf16 v[208:211], v[28:31], v[64:67], v[208:211]
    s_waitcnt vmcnt(8) lgkmcnt(0)
    s_barrier
    s_add_u32 s71, s71, 32768
    s_cmp_eq_u32 s71, 98304
    s_cselect_b32 s71, 0, s71
    v_add_u32 v98, s71, v96
    v_add_u32 v99, s71, v97
    v_mfma_f32_16x16x32_bf16 v[128:131], v[36:39], v[80:83], v[128:131]
    ds_read_b64_tr_b16 v[8:9], v100 offset:32768
    v_mfma_f32_16x16x32_bf16 v[132:135], v[36:39], v[84:87], v[132:135]
    ds_read_b64_tr_b16 v[10:11], v100 offset:33280
    s_add_u32 m0, s77, 16384
    s_nop 0
    buffer_load_dwordx4 v107, s[32:35], s67 offen offset:0 lds
    v_mfma_f32_16x16x32_bf16 v[136:139], v[36:39], v[88:91], v[136:139]
    ds_read_b128 v[64:67], v98 offset:0
    v_mfma_f32_16x16x32_bf16 v[140:143], v[36:39], v[92:95], v[140:143]
    ds_read_b128 v[68:71], v98 offset:2048
    v_mfma_f32_16x16x32_bf16 v[156:159], v[40:43], v[92:95], v[156:159]
    ds_read_b128 v[72:75], v98 offset:4096
    buffer_load_dwordx4 v108, s[32:35], s67 offen offset:1024 lds
    v_mfma_f32_16x16x32_bf16 v[152:155], v[40:43], v[88:91], v[152:155]
    ds_read_b128 v[76:79], v98 offset:6144
    v_mfma_f32_16x16x32_bf16 v[148:151], v[40:43], v[84:87], v[148:151]
    ds_read_b64_tr_b16 v[12:13], v101 offset:32768
    v_mfma_f32_16x16x32_bf16 v[144:147], v[40:43], v[80:83], v[144:147]
    ds_read_b64_tr_b16 v[14:15], v101 offset:33280
    s_add_u32 s67, s67, s68
    s_add_u32 s69, s69, 128
    s_add_u32 s70, s70, 32768
    s_cmp_eq_u32 s70, 98304
    s_cselect_b32 s70, 0, s70
    s_add_u32 m0, s70, s78
    s_nop 0
    buffer_load_dwordx4 v105, s[28:31], s69 offen offset:0 lds
    v_mfma_f32_16x16x32_bf16 v[160:163], v[44:47], v[80:83], v[160:163]
    ds_read_b64_tr_b16 v[16:17], v100 offset:36864
    v_mfma_f32_16x16x32_bf16 v[164:167], v[44:47], v[84:87], v[164:167]
    ds_read_b64_tr_b16 v[18:19], v100 offset:37376
    v_mfma_f32_16x16x32_bf16 v[168:171], v[44:47], v[88:91], v[168:171]
    ds_read_b64_tr_b16 v[20:21], v101 offset:36864
    buffer_load_dwordx4 v106, s[28:31], s69 offen offset:1024 lds
    v_mfma_f32_16x16x32_bf16 v[172:175], v[44:47], v[92:95], v[172:175]
    ds_read_b64_tr_b16 v[22:23], v101 offset:37376
    v_mfma_f32_16x16x32_bf16 v[188:191], v[48:51], v[92:95], v[188:191]
    ds_read_b64_tr_b16 v[24:25], v102 offset:32768
    v_mfma_f32_16x16x32_bf16 v[184:187], v[48:51], v[88:91], v[184:187]
    ds_read_b64_tr_b16 v[26:27], v102 offset:33792
    v_mfma_f32_16x16x32_bf16 v[180:183], v[48:51], v[84:87], v[180:183]
    ds_read_b64_tr_b16 v[28:29], v103 offset:32768
    v_mfma_f32_16x16x32_bf16 v[176:179], v[48:51], v[80:83], v[176:179]
    ds_read_b64_tr_b16 v[30:31], v103 offset:33792
    v_mfma_f32_16x16x32_bf16 v[192:195], v[52:55], v[80:83], v[192:195]
    v_mfma_f32_16x16x32_bf16 v[196:199], v[52:55], v[84:87], v[196:199]
    v_mfma_f32_16x16x32_bf16 v[200:203], v[52:55], v[88:91], v[200:203]
    v_mfma_f32_16x16x32_bf16 v[204:207], v[52:55], v[92:95], v[204:207]
    v_mfma_f32_16x16x32_bf16 v[220:223], v[56:59], v[92:95], v[220:223]
    v_mfma_f32_16x16x32_bf16 v[216:219], v[56:59], v[88:91], v[216:219]
    v_mfma_f32_16x16x32_bf16 v[212:215], v[56:59], v[84:87], v[212:215]
    v_mfma_f32_16x16x32_bf16 v[208:211], v[56:59], v[80:83], v[208:211]
    s_waitcnt vmcnt(8) lgkmcnt(0)
    s_barrier
    v_mfma_f32_16x16x32_bf16 v[128:131], v[8:11], v[64:67], v[128:131]
    ds_read_b64_tr_b16 v[36:37], v100 offset:49152
    v_mfma_f32_16x16x32_bf16 v[132:135], v[8:11], v[68:71], v[132:135]
    ds_read_b64_tr_b16 v[38:39], v100 offset:49664
    s_add_u32 m0, s77, 32768
    s_nop 0
    buffer_load_dwordx4 v107, s[32:35], s67 offen offset:0 lds
    v_mfma_f32_16x16x32_bf16 v[136:139], v[8:11], v[72:75], v[136:139]
    ds_read_b128 v[80:83], v99 offset:0
    v_mfma_f32_16x16x32_bf16 v[140:143], v[8:11], v[76:79], v[140:143]
    ds_read_b128 v[84:87], v99 offset:2048
    v_mfma_f32_16x16x32_bf16 v[156:159], v[12:15], v[76:79], v[156:159]
    ds_read_b128 v[88:91], v99 offset:4096
    buffer_load_dwordx4 v108, s[32:35], s67 offen offset:1024 lds
    v_mfma_f32_16x16x32_bf16 v[152:155], v[12:15], v[72:75], v[152:155]
    ds_read_b128 v[92:95], v99 offset:6144
    v_mfma_f32_16x16x32_bf16 v[148:151], v[12:15], v[68:71], v[148:151]
    ds_read_b64_tr_b16 v[40:41], v101 offset:49152
    v_mfma_f32_16x16x32_bf16 v[144:147], v[12:15], v[64:67], v[144:147]
    ds_read_b64_tr_b16 v[42:43], v101 offset:49664
    s_add_u32 s67, s67, s68
    s_add_u32 s73, s69, 262144
    s_add_u32 s74, s70, s78
    s_add_u32 m0, s74, 16384
    s_nop 0
    buffer_load_dwordx4 v105, s[28:31], s73 offen offset:0 lds
    v_mfma_f32_16x16x32_bf16 v[160:163], v[16:19], v[64:67], v[160:163]
    ds_read_b64_tr_b16 v[44:45], v100 offset:53248
    v_mfma_f32_16x16x32_bf16 v[164:167], v[16:19], v[68:71], v[164:167]
    ds_read_b64_tr_b16 v[46:47], v100 offset:53760
    v_mfma_f32_16x16x32_bf16 v[168:171], v[16:19], v[72:75], v[168:171]
    ds_read_b64_tr_b16 v[48:49], v101 offset:53248
    buffer_load_dwordx4 v106, s[28:31], s73 offen offset:1024 lds
    v_mfma_f32_16x16x32_bf16 v[172:175], v[16:19], v[76:79], v[172:175]
    ds_read_b64_tr_b16 v[50:51], v101 offset:53760
    v_mfma_f32_16x16x32_bf16 v[188:191], v[20:23], v[76:79], v[188:191]
    ds_read_b64_tr_b16 v[52:53], v102 offset:49152
    v_mfma_f32_16x16x32_bf16 v[184:187], v[20:23], v[72:75], v[184:187]
    ds_read_b64_tr_b16 v[54:55], v102 offset:50176
    v_mfma_f32_16x16x32_bf16 v[180:183], v[20:23], v[68:71], v[180:183]
    ds_read_b64_tr_b16 v[56:57], v103 offset:49152
    v_mfma_f32_16x16x32_bf16 v[176:179], v[20:23], v[64:67], v[176:179]
    ds_read_b64_tr_b16 v[58:59], v103 offset:50176
    v_mfma_f32_16x16x32_bf16 v[192:195], v[24:27], v[64:67], v[192:195]
    v_mfma_f32_16x16x32_bf16 v[196:199], v[24:27], v[68:71], v[196:199]
    v_mfma_f32_16x16x32_bf16 v[200:203], v[24:27], v[72:75], v[200:203]
    v_mfma_f32_16x16x32_bf16 v[204:207], v[24:27], v[76:79], v[204:207]
    v_mfma_f32_16x16x32_bf16 v[220:223], v[28:31], v[76:79], v[220:223]
    v_mfma_f32_16x16x32_bf16 v[216:219], v[28:31], v[72:75], v[216:219]
    v_mfma_f32_16x16x32_bf16 v[212:215], v[28:31], v[68:71], v[212:215]
    v_mfma_f32_16x16x32_bf16 v[208:211], v[28:31], v[64:67], v[208:211]
    s_waitcnt vmcnt(8) lgkmcnt(0)
    s_barrier
    s_add_u32 s71, s71, 32768
    s_cmp_eq_u32 s71, 98304
    s_cselect_b32 s71, 0, s71
    v_add_u32 v98, s71, v96
    v_add_u32 v99, s71, v97
    v_mfma_f32_16x16x32_bf16 v[128:131], v[36:39], v[80:83], v[128:131]
    ds_read_b64_tr_b16 v[8:9], v100 offset:0
    v_mfma_f32_16x16x32_bf16 v[132:135], v[36:39], v[84:87], v[132:135]
    ds_read_b64_tr_b16 v[10:11], v100 offset:512
    s_add_u32 m0, s77, 49152
    s_nop 0
    buffer_load_dwordx4 v107, s[32:35], s67 offen offset:0 lds
    v_mfma_f32_16x16x32_bf16 v[136:139], v[36:39], v[88:91], v[136:139]
    ds_read_b128 v[64:67], v98 offset:0
    v_mfma_f32_16x16x32_bf16 v[140:143], v[36:39], v[92:95], v[140:143]
    ds_read_b128 v[68:71], v98 offset:2048
    v_mfma_f32_16x16x32_bf16 v[156:159], v[40:43], v[92:95], v[156:159]
    ds_read_b128 v[72:75], v98 offset:4096
    buffer_load_dwordx4 v108, s[32:35], s67 offen offset:1024 lds
    v_mfma_f32_16x16x32_bf16 v[152:155], v[40:43], v[88:91], v[152:155]
    ds_read_b128 v[76:79], v98 offset:6144
    v_mfma_f32_16x16x32_bf16 v[148:151], v[40:43], v[84:87], v[148:151]
    ds_read_b64_tr_b16 v[12:13], v101 offset:0
    v_mfma_f32_16x16x32_bf16 v[144:147], v[40:43], v[80:83], v[144:147]
    ds_read_b64_tr_b16 v[14:15], v101 offset:512
    s_add_u32 s67, s67, s68
    s_add_u32 s69, s69, 128
    s_add_u32 s70, s70, 32768
    s_cmp_eq_u32 s70, 98304
    s_cselect_b32 s70, 0, s70
    s_add_u32 m0, s70, s78
    s_nop 0
    buffer_load_dwordx4 v105, s[28:31], s69 offen offset:0 lds
    v_mfma_f32_16x16x32_bf16 v[160:163], v[44:47], v[80:83], v[160:163]
    ds_read_b64_tr_b16 v[16:17], v100 offset:4096
    v_mfma_f32_16x16x32_bf16 v[164:167], v[44:47], v[84:87], v[164:167]
    ds_read_b64_tr_b16 v[18:19], v100 offset:4608
    v_mfma_f32_16x16x32_bf16 v[168:171], v[44:47], v[88:91], v[168:171]
    ds_read_b64_tr_b16 v[20:21], v101 offset:4096
    buffer_load_dwordx4 v106, s[28:31], s69 offen offset:1024 lds
    v_mfma_f32_16x16x32_bf16 v[172:175], v[44:47], v[92:95], v[172:175]
    ds_read_b64_tr_b16 v[22:23], v101 offset:4608
    v_mfma_f32_16x16x32_bf16 v[188:191], v[48:51], v[92:95], v[188:191]
    ds_read_b64_tr_b16 v[24:25], v102 offset:0
    v_mfma_f32_16x16x32_bf16 v[184:187], v[48:51], v[88:91], v[184:187]
    ds_read_b64_tr_b16 v[26:27], v102 offset:1024
    v_mfma_f32_16x16x32_bf16 v[180:183], v[48:51], v[84:87], v[180:183]
    ds_read_b64_tr_b16 v[28:29], v103 offset:0
    v_mfma_f32_16x16x32_bf16 v[176:179], v[48:51], v[80:83], v[176:179]
    ds_read_b64_tr_b16 v[30:31], v103 offset:1024
    v_mfma_f32_16x16x32_bf16 v[192:195], v[52:55], v[80:83], v[192:195]
    v_mfma_f32_16x16x32_bf16 v[196:199], v[52:55], v[84:87], v[196:199]
    v_mfma_f32_16x16x32_bf16 v[200:203], v[52:55], v[88:91], v[200:203]
    v_mfma_f32_16x16x32_bf16 v[204:207], v[52:55], v[92:95], v[204:207]
    v_mfma_f32_16x16x32_bf16 v[220:223], v[56:59], v[92:95], v[220:223]
    v_mfma_f32_16x16x32_bf16 v[216:219], v[56:59], v[88:91], v[216:219]
    v_mfma_f32_16x16x32_bf16 v[212:215], v[56:59], v[84:87], v[212:215]
    v_mfma_f32_16x16x32_bf16 v[208:211], v[56:59], v[80:83], v[208:211]
    s_waitcnt vmcnt(8) lgkmcnt(0)
    s_barrier
K1_v11_loop:
    v_mfma_f32_16x16x32_bf16 v[128:131], v[8:11], v[64:67], v[128:131]
    ds_read_b64_tr_b16 v[36:37], v100 offset:16384
    v_mfma_f32_16x16x32_bf16 v[132:135], v[8:11], v[68:71], v[132:135]
    ds_read_b64_tr_b16 v[38:39], v100 offset:16896
    s_add_u32 m0, s77, 0
    s_nop 0
    buffer_load_dwordx4 v107, s[32:35], s67 offen offset:0 lds
    v_mfma_f32_16x16x32_bf16 v[136:139], v[8:11], v[72:75], v[136:139]
    ds_read_b128 v[80:83], v99 offset:0
    v_mfma_f32_16x16x32_bf16 v[140:143], v[8:11], v[76:79], v[140:143]
    ds_read_b128 v[84:87], v99 offset:2048
    v_mfma_f32_16x16x32_bf16 v[156:159], v[12:15], v[76:79], v[156:159]
    ds_read_b128 v[88:91], v99 offset:4096
    buffer_load_dwordx4 v108, s[32:35], s67 offen offset:1024 lds
    v_mfma_f32_16x16x32_bf16 v[152:155], v[12:15], v[72:75], v[152:155]
    ds_read_b128 v[92:95], v99 offset:6144
    v_mfma_f32_16x16x32_bf16 v[148:151], v[12:15], v[68:71], v[148:151]
    ds_read_b64_tr_b16 v[40:41], v101 offset:16384
    v_mfma_f32_16x16x32_bf16 v[144:147], v[12:15], v[64:67], v[144:147]
    ds_read_b64_tr_b16 v[42:43], v101 offset:16896
    s_add_u32 s67, s67, s68
    s_add_u32 s73, s69, 262144
    s_add_u32 s74, s70, s78
    s_add_u32 m0, s74, 16384
    s_nop 0
    buffer_load_dwordx4 v105, s[28:31], s73 offen offset:0 lds
    v_mfma_f32_16x16x32_bf16 v[160:163], v[16:19], v[64:67], v[160:163]
    ds_read_b64_tr_b16 v[44:45], v100 offset:20480
    v_mfma_f32_16x16x32_bf16 v[164:167], v[16:19], v[68:71], v[164:167]
    ds_read_b64_tr_b16 v[46:47], v100 offset:20992
    v_mfma_f32_16x16x32_bf16 v[168:171], v[16:19], v[72:75], v[168:171]
    ds_read_b64_tr_b16 v[48:49], v101 offset:20480
    buffer_load_dwordx4 v106, s[28:31], s73 offen offset:1024 lds
    v_mfma_f32_16x16x32_bf16 v[172:175], v[16:19], v[76:79], v[172:175]
    ds_read_b64_tr_b16 v[50:51], v101 offset:20992
    v_mfma_f32_16x16x32_bf16 v[188:191], v[20:23], v[76:79], v[188:191]
    ds_read_b64_tr_b16 v[52:53], v102 offset:16384
    v_mfma_f32_16x16x32_bf16 v[184:187], v[20:23], v[72:75], v[184:187]
    ds_read_b64_tr_b16 v[54:55], v102 offset:17408
    s_sub_u32 s10, s10, 1
    s_cbranch_scc0 PFs13
    buffer_load_dword v3, v109, s[88:91], s84 offen
    s_mov_b32 s10, s3
    s_add_u32 s84, s84, 8192
    s_mov_b32 s3, 1000
PFs13:
    v_mfma_f32_16x16x32_bf16 v[180:183], v[20:23], v[68:71], v[180:183]
    ds_read_b64_tr_b16 v[56:57], v103 offset:16384
    v_mfma_f32_16x16x32_bf16 v[176:179], v[20:23], v[64:67], v[176:179]
    ds_read_b64_tr_b16 v[58:59], v103 offset:17408
    v_mfma_f32_16x16x32_bf16 v[192:195], v[24:27], v[64:67], v[192:195]
    v_mfma_f32_16x16x32_bf16 v[196:199], v[24:27], v[68:71], v[196:199]
    v_mfma_f32_16x16x32_bf16 v[200:203], v[24:27], v[72:75], v[200:203]
    v_mfma_f32_16x16x32_bf16 v[204:207], v[24:27], v[76:79], v[204:207]
    v_mfma_f32_16x16x32_bf16 v[220:223], v[28:31], v[76:79], v[220:223]
    v_mfma_f32_16x16x32_bf16 v[216:219], v[28:31], v[72:75], v[216:219]
    v_mfma_f32_16x16x32_bf16 v[212:215], v[28:31], v[68:71], v[212:215]
    v_mfma_f32_16x16x32_bf16 v[208:211], v[28:31], v[64:67], v[208:211]
    s_waitcnt vmcnt(8) lgkmcnt(0)
    s_barrier
    s_add_u32 s71, s71, 32768
    s_cmp_eq_u32 s71, 98304
    s_cselect_b32 s71, 0, s71
    v_add_u32 v98, s71, v96
    v_add_u32 v99, s71, v97
    v_mfma_f32_16x16x32_bf16 v[128:131], v[36:39], v[80:83], v[128:131]
    ds_read_b64_tr_b16 v[8:9], v100 offset:32768
    v_mfma_f32_16x16x32_bf16 v[132:135], v[36:39], v[84:87], v[132:135]
    ds_read_b64_tr_b16 v[10:11], v100 offset:33280
    s_add_u32 m0, s77, 16384
    s_nop 0
    buffer_load_dwordx4 v107, s[32:35], s67 offen offset:0 lds
    v_mfma_f32_16x16x32_bf16 v[136:139], v[36:39], v[88:91], v[136:139]
    ds_read_b128 v[64:67], v98 offset:0
    v_mfma_f32_16x16x32_bf16 v[140:143], v[36:39], v[92:95], v[140:143]
    ds_read_b128 v[68:71], v98 offset:2048
    v_mfma_f32_16x16x32_bf16 v[156:159], v[40:43], v[92:95], v[156:159]
    ds_read_b128 v[72:75], v98 offset:4096
    buffer_load_dwordx4 v108, s[32:35], s67 offen offset:1024 lds
    v_mfma_f32_16x16x32_bf16 v[152:155], v[40:43], v[88:91], v[152:155]
    ds_read_b128 v[76:79], v98 offset:6144
    v_mfma_f32_16x16x32_bf16 v[148:151], v[40:43], v[84:87], v[148:151]
    ds_read_b64_tr_b16 v[12:13], v101 offset:32768
    v_mfma_f32_16x16x32_bf16 v[144:147], v[40:43], v[80:83], v[144:147]
    ds_read_b64_tr_b16 v[14:15], v101 offset:33280
    s_add_u32 s67, s67, s68
    s_add_u32 s69, s69, 128
    s_add_u32 s70, s70, 32768
    s_cmp_eq_u32 s70, 98304
    s_cselect_b32 s70, 0, s70
    s_add_u32 m0, s70, s78
    s_nop 0
    buffer_load_dwordx4 v105, s[28:31], s69 offen offset:0 lds
    v_mfma_f32_16x16x32_bf16 v[160:163], v[44:47], v[80:83], v[160:163]
    ds_read_b64_tr_b16 v[16:17], v100 offset:36864
    v_mfma_f32_16x16x32_bf16 v[164:167], v[44:47], v[84:87], v[164:167]
    ds_read_b64_tr_b16 v[18:19], v100 offset:37376
    v_mfma_f32_16x16x32_bf16 v[168:171], v[44:47], v[88:91], v[168:171]
    ds_read_b64_tr_b16 v[20:21], v101 offset:36864
    buffer_load_dwordx4 v106, s[28:31], s69 offen offset:1024 lds
    v_mfma_f32_16x16x32_bf16 v[172:175], v[44:47], v[92:95], v[172:175]
    ds_read_b64_tr_b16 v[22:23], v101 offset:37376
    v_mfma_f32_16x16x32_bf16 v[188:191], v[48:51], v[92:95], v[188:191]
    ds_read_b64_tr_b16 v[24:25], v102 offset:32768
    v_mfma_f32_16x16x32_bf16 v[184:187], v[48:51], v[88:91], v[184:187]
    ds_read_b64_tr_b16 v[26:27], v102 offset:33792
    s_sub_u32 s10, s10, 1
    s_cbranch_scc0 PFs14
    buffer_load_dword v3, v109, s[88:91], s84 offen
    s_mov_b32 s10, s3
    s_add_u32 s84, s84, 8192
    s_mov_b32 s3, 1000
PFs14:
    v_mfma_f32_16x16x32_bf16 v[180:183], v[48:51], v[84:87], v[180:183]
    ds_read_b64_tr_b16 v[28:29], v103 offset:32768
    v_mfma_f32_16x16x32_bf16 v[176:179], v[48:51], v[80:83], v[176:179]
    ds_read_b64_tr_b16 v[30:31], v103 offset:33792
    v_mfma_f32_16x16x32_bf16 v[192:195], v[52:55], v[80:83], v[192:195]
    v_mfma_f32_16x16x32_bf16 v[196:199], v[52:55], v[84:87], v[196:199]
    v_mfma_f32_16x16x32_bf16 v[200:203], v[52:55], v[88:91], v[200:203]
    v_mfma_f32_16x16x32_bf16 v[204:207], v[52:55], v[92:95], v[204:207]
    v_mfma_f32_16x16x32_bf16 v[220:223], v[56:59], v[92:95], v[220:223]
    v_mfma_f32_16x16x32_bf16 v[216:219], v[56:59], v[88:91], v[216:219]
    v_mfma_f32_16x16x32_bf16 v[212:215], v[56:59], v[84:87], v[212:215]
    v_mfma_f32_16x16x32_bf16 v[208:211], v[56:59], v[80:83], v[208:211]
    s_waitcnt vmcnt(8) lgkmcnt(0)
    s_barrier
    v_mfma_f32_16x16x32_bf16 v[128:131], v[8:11], v[64:67], v[128:131]
    ds_read_b64_tr_b16 v[36:37], v100 offset:49152
    v_mfma_f32_16x16x32_bf16 v[132:135], v[8:11], v[68:71], v[132:135]
    ds_read_b64_tr_b16 v[38:39], v100 offset:49664
    s_add_u32 m0, s77, 32768
    s_nop 0
    buffer_load_dwordx4 v107, s[32:35], s67 offen offset:0 lds
    v_mfma_f32_16x16x32_bf16 v[136:139], v[8:11], v[72:75], v[136:139]
    ds_read_b128 v[80:83], v99 offset:0
    v_mfma_f32_16x16x32_bf16 v[140:143], v[8:11], v[76:79], v[140:143]
    ds_read_b128 v[84:87], v99 offset:2048
    v_mfma_f32_16x16x32_bf16 v[156:159], v[12:15], v[76:79], v[156:159]
    ds_read_b128 v[88:91], v99 offset:4096
    buffer_load_dwordx4 v108, s[32:35], s67 offen offset:1024 lds
    v_mfma_f32_16x16x32_bf16 v[152:155], v[12:15], v[72:75], v[152:155]
    ds_read_b128 v[92:95], v99 offset:6144
    v_mfma_f32_16x16x32_bf16 v[148:151], v[12:15], v[68:71], v[148:151]
    ds_read_b64_tr_b16 v[40:41], v101 offset:49152
    v_mfma_f32_16x16x32_bf16 v[144:147], v[12:15], v[64:67], v[144:147]
    ds_read_b64_tr_b16 v[42:43], v101 offset:49664
    s_add_u32 s67, s67, s68
    s_add_u32 s73, s69, 262144
    s_add_u32 s74, s70, s78
    s_add_u32 m0, s74, 16384
    s_nop 0
    buffer_load_dwordx4 v105, s[28:31], s73 offen offset:0 lds
    v_mfma_f32_16x16x32_bf16 v[160:163], v[16:19], v[64:67], v[160:163]
    ds_read_b64_tr_b16 v[44:45], v100 offset:53248
    v_mfma_f32_16x16x32_bf16 v[164:167], v[16:19], v[68:71], v[164:167]
    ds_read_b64_tr_b16 v[46:47], v100 offset:53760
    v_mfma_f32_16x16x32_bf16 v[168:171], v[16:19], v[72:75], v[168:171]
    ds_read_b64_tr_b16 v[48:49], v101 offset:53248
    buffer_load_dwordx4 v106, s[28:31], s73 offen offset:1024 lds
    v_mfma_f32_16x16x32_bf16 v[172:175], v[16:19], v[76:79], v[172:175]
    ds_read_b64_tr_b16 v[50:51], v101 offset:53760
    v_mfma_f32_16x16x32_bf16 v[188:191], v[20:23], v[76:79], v[188:191]
    ds_read_b64_tr_b16 v[52:53], v102 offset:49152
    v_mfma_f32_16x16x32_bf16 v[184:187], v[20:23], v[72:75], v[184:187]
    ds_read_b64_tr_b16 v[54:55], v102 offset:50176
    s_sub_u32 s10, s10, 1
    s_cbranch_scc0 PFs15
    buffer_load_dword v3, v109, s[88:91], s84 offen
    s_mov_b32 s10, s3
    s_add_u32 s84, s84, 8192
    s_mov_b32 s3, 1000
PFs15:
    v_mfma_f32_16x16x32_bf16 v[180:183], v[20:23], v[68:71], v[180:183]
    ds_read_b64_tr_b16 v[56:57], v103 offset:49152
    v_mfma_f32_16x16x32_bf16 v[176:179], v[20:23], v[64:67], v[176:179]
    ds_read_b64_tr_b16 v[58:59], v103 offset:50176
    v_mfma_f32_16x16x32_bf16 v[192:195], v[24:27], v[64:67], v[192:195]
    v_mfma_f32_16x16x32_bf16 v[196:199], v[24:27], v[68:71], v[196:199]
    v_mfma_f32_16x16x32_bf16 v[200:203], v[24:27], v[72:75], v[200:203]
    v_mfma_f32_16x16x32_bf16 v[204:207], v[24:27], v[76:79], v[204:207]
    v_mfma_f32_16x16x32_bf16 v[220:223], v[28:31], v[76:79], v[220:223]
    v_mfma_f32_16x16x32_bf16 v[216:219], v[28:31], v[72:75], v[216:219]
    v_mfma_f32_16x16x32_bf16 v[212:215], v[28:31], v[68:71], v[212:215]
    v_mfma_f32_16x16x32_bf16 v[208:211], v[28:31], v[64:67], v[208:211]
    s_waitcnt vmcnt(8) lgkmcnt(0)
    s_barrier
    s_add_u32 s71, s71, 32768
    s_cmp_eq_u32 s71, 98304
    s_cselect_b32 s71, 0, s71
    v_add_u32 v98, s71, v96
    v_add_u32 v99, s71, v97
    v_mfma_f32_16x16x32_bf16 v[128:131], v[36:39], v[80:83], v[128:131]
    ds_read_b64_tr_b16 v[8:9], v100 offset:0
    v_mfma_f32_16x16x32_bf16 v[132:135], v[36:39], v[84:87], v[132:135]
    ds_read_b64_tr_b16 v[10:11], v100 offset:512
    s_add_u32 m0, s77, 49152
    s_nop 0
    buffer_load_dwordx4 v107, s[32:35], s67 offen offset:0 lds
    v_mfma_f32_16x16x32_bf16 v[136:139], v[36:39], v[88:91], v[136:139]
    ds_read_b128 v[64:67], v98 offset:0
    v_mfma_f32_16x16x32_bf16 v[140:143], v[36:39], v[92:95], v[140:143]
    ds_read_b128 v[68:71], v98 offset:2048
    v_mfma_f32_16x16x32_bf16 v[156:159], v[40:43], v[92:95], v[156:159]
    ds_read_b128 v[72:75], v98 offset:4096
    buffer_load_dwordx4 v108, s[32:35], s67 offen offset:1024 lds
    v_mfma_f32_16x16x32_bf16 v[152:155], v[40:43], v[88:91], v[152:155]
    ds_read_b128 v[76:79], v98 offset:6144
    v_mfma_f32_16x16x32_bf16 v[148:151], v[40:43], v[84:87], v[148:151]
    ds_read_b64_tr_b16 v[12:13], v101 offset:0
    v_mfma_f32_16x16x32_bf16 v[144:147], v[40:43], v[80:83], v[144:147]
    ds_read_b64_tr_b16 v[14:15], v101 offset:512
    s_add_u32 s67, s67, s68
    s_add_u32 s69, s69, 128
    s_add_u32 s70, s70, 32768
    s_cmp_eq_u32 s70, 98304
    s_cselect_b32 s70, 0, s70
    s_add_u32 m0, s70, s78
    s_nop 0
    buffer_load_dwordx4 v105, s[28:31], s69 offen offset:0 lds
    v_mfma_f32_16x16x32_bf16 v[160:163], v[44:47], v[80:83], v[160:163]
    ds_read_b64_tr_b16 v[16:17], v100 offset:4096
    v_mfma_f32_16x16x32_bf16 v[164:167], v[44:47], v[84:87], v[164:167]
    ds_read_b64_tr_b16 v[18:19], v100 offset:4608
    v_mfma_f32_16x16x32_bf16 v[168:171], v[44:47], v[88:91], v[168:171]
    ds_read_b64_tr_b16 v[20:21], v101 offset:4096
    buffer_load_dwordx4 v106, s[28:31], s69 offen offset:1024 lds
    v_mfma_f32_16x16x32_bf16 v[172:175], v[44:47], v[92:95], v[172:175]
    ds_read_b64_tr_b16 v[22:23], v101 offset:4608
    v_mfma_f32_16x16x32_bf16 v[188:191], v[48:51], v[92:95], v[188:191]
    ds_read_b64_tr_b16 v[24:25], v102 offset:0
    v_mfma_f32_16x16x32_bf16 v[184:187], v[48:51], v[88:91], v[184:187]
    ds_read_b64_tr_b16 v[26:27], v102 offset:1024
    s_sub_u32 s10, s10, 1
    s_cbranch_scc0 PFs16
    buffer_load_dword v3, v109, s[88:91], s84 offen
    s_mov_b32 s10, s3
    s_add_u32 s84, s84, 8192
    s_mov_b32 s3, 1000
PFs16:
    v_mfma_f32_16x16x32_bf16 v[180:183], v[48:51], v[84:87], v[180:183]
    ds_read_b64_tr_b16 v[28:29], v103 offset:0
    v_mfma_f32_16x16x32_bf16 v[176:179], v[48:51], v[80:83], v[176:179]
    ds_read_b64_tr_b16 v[30:31], v103 offset:1024
    v_mfma_f32_16x16x32_bf16 v[192:195], v[52:55], v[80:83], v[192:195]
    v_mfma_f32_16x16x32_bf16 v[196:199], v[52:55], v[84:87], v[196:199]
    v_mfma_f32_16x16x32_bf16 v[200:203], v[52:55], v[88:91], v[200:203]
    v_mfma_f32_16x16x32_bf16 v[204:207], v[52:55], v[92:95], v[204:207]
    v_mfma_f32_16x16x32_bf16 v[220:223], v[56:59], v[92:95], v[220:223]
    v_mfma_f32_16x16x32_bf16 v[216:219], v[56:59], v[88:91], v[216:219]
    v_mfma_f32_16x16x32_bf16 v[212:215], v[56:59], v[84:87], v[212:215]
    v_mfma_f32_16x16x32_bf16 v[208:211], v[56:59], v[80:83], v[208:211]
    s_waitcnt vmcnt(8) lgkmcnt(0)
    s_barrier
    s_add_u32 s72, s72, 1
    s_cmp_lt_u32 s72, 7
    s_cbranch_scc1 K1_v11_loop
    v_mfma_f32_16x16x32_bf16 v[128:131], v[8:11], v[64:67], v[128:131]
    ds_read_b64_tr_b16 v[36:37], v100 offset:16384
    v_mfma_f32_16x16x32_bf16 v[132:135], v[8:11], v[68:71], v[132:135]
    ds_read_b64_tr_b16 v[38:39], v100 offset:16896
    buffer_load_dwordx4 v[240:243], v113, s[28:31], s98 offen
    v_mfma_f32_16x16x32_bf16 v[136:139], v[8:11], v[72:75], v[136:139]
    ds_read_b128 v[80:83], v99 offset:0
    v_mfma_f32_16x16x32_bf16 v[140:143], v[8:11], v[76:79], v[140:143]
    ds_read_b128 v[84:87], v99 offset:2048
    v_mfma_f32_16x16x32_bf16 v[156:159], v[12:15], v[76:79], v[156:159]
    ds_read_b128 v[88:91], v99 offset:4096
    buffer_load_dwordx4 v[244:247], v113, s[28:31], s98 offen offset:1024
    v_mfma_f32_16x16x32_bf16 v[152:155], v[12:15], v[72:75], v[152:155]
    ds_read_b128 v[92:95], v99 offset:6144
    v_mfma_f32_16x16x32_bf16 v[148:151], v[12:15], v[68:71], v[148:151]
    ds_read_b64_tr_b16 v[40:41], v101 offset:16384
    v_mfma_f32_16x16x32_bf16 v[144:147], v[12:15], v[64:67], v[144:147]
    ds_read_b64_tr_b16 v[42:43], v101 offset:16896
    buffer_load_dwordx4 v[248:251], v113, s[52:55], 0 offen
    v_mfma_f32_16x16x32_bf16 v[160:163], v[16:19], v[64:67], v[160:163]
    ds_read_b64_tr_b16 v[44:45], v100 offset:20480
    v_mfma_f32_16x16x32_bf16 v[164:167], v[16:19], v[68:71], v[164:167]
    ds_read_b64_tr_b16 v[46:47], v100 offset:20992
    v_mfma_f32_16x16x32_bf16 v[168:171], v[16:19], v[72:75], v[168:171]
    ds_read_b64_tr_b16 v[48:49], v101 offset:20480
    buffer_load_dwordx4 v[252:255], v113, s[52:55], 0 offen offset:1024
    v_mfma_f32_16x16x32_bf16 v[172:175], v[16:19], v[76:79], v[172:175]
    ds_read_b64_tr_b16 v[50:51], v101 offset:20992
    v_mfma_f32_16x16x32_bf16 v[188:191], v[20:23], v[76:79], v[188:191]
    ds_read_b64_tr_b16 v[52:53], v102 offset:16384
    v_mfma_f32_16x16x32_bf16 v[184:187], v[20:23], v[72:75], v[184:187]
    ds_read_b64_tr_b16 v[54:55], v102 offset:17408
    buffer_load_dword v110, off, s[40:43], 0 sc1
    v_mfma_f32_16x16x32_bf16 v[180:183], v[20:23], v[68:71], v[180:183]
    ds_read_b64_tr_b16 v[56:57], v103 offset:16384
    v_mfma_f32_16x16x32_bf16 v[176:179], v[20:23], v[64:67], v[176:179]
    ds_read_b64_tr_b16 v[58:59], v103 offset:17408
    v_mfma_f32_16x16x32_bf16 v[192:195], v[24:27], v[64:67], v[192:195]
    s_lshl_b32 s75, s93, 3
    s_add_u32 s75, s75, s59
    s_lshl_b32 s75, s75, 7
    s_add_u32 s75, s75, 38797312
    s_lshl_b32 s76, s57, 7
    s_add_u32 s76, s76, 19988480
    v_mov_b32 v6, s76
    v_writelane_b32 v6, s75, 0
    v_writelane_b32 v6, s100, 1
    v_writelane_b32 v6, s87, 2
    buffer_load_dword v3, v6, s[36:39], 0 offen sc1
    v_mfma_f32_16x16x32_bf16 v[196:199], v[24:27], v[68:71], v[196:199]
    v_mfma_f32_16x16x32_bf16 v[200:203], v[24:27], v[72:75], v[200:203]
    v_mfma_f32_16x16x32_bf16 v[204:207], v[24:27], v[76:79], v[204:207]
    v_mfma_f32_16x16x32_bf16 v[220:223], v[28:31], v[76:79], v[220:223]
    v_mfma_f32_16x16x32_bf16 v[216:219], v[28:31], v[72:75], v[216:219]
    v_mfma_f32_16x16x32_bf16 v[212:215], v[28:31], v[68:71], v[212:215]
    v_mfma_f32_16x16x32_bf16 v[208:211], v[28:31], v[64:67], v[208:211]
    s_waitcnt vmcnt(10) lgkmcnt(0)
    s_barrier
    s_add_u32 s71, s71, 32768
    s_cmp_eq_u32 s71, 98304
    s_cselect_b32 s71, 0, s71
    v_add_u32 v98, s71, v96
    v_add_u32 v99, s71, v97
    v_mfma_f32_16x16x32_bf16 v[128:131], v[36:39], v[80:83], v[128:131]
    ds_read_b64_tr_b16 v[8:9], v100 offset:32768
    v_mfma_f32_16x16x32_bf16 v[132:135], v[36:39], v[84:87], v[132:135]
    ds_read_b64_tr_b16 v[10:11], v100 offset:33280
    v_mfma_f32_16x16x32_bf16 v[136:139], v[36:39], v[88:91], v[136:139]
    ds_read_b128 v[64:67], v98 offset:0
    v_mfma_f32_16x16x32_bf16 v[140:143], v[36:39], v[92:95], v[140:143]
    ds_read_b128 v[68:71], v98 offset:2048
    v_mfma_f32_16x16x32_bf16 v[156:159], v[40:43], v[92:95], v[156:159]
    ds_read_b128 v[72:75], v98 offset:4096
    v_mfma_f32_16x16x32_bf16 v[152:155], v[40:43], v[88:91], v[152:155]
    ds_read_b128 v[76:79], v98 offset:6144
    v_mfma_f32_16x16x32_bf16 v[148:151], v[40:43], v[84:87], v[148:151]
    ds_read_b64_tr_b16 v[12:13], v101 offset:32768
    v_mfma_f32_16x16x32_bf16 v[144:147], v[40:43], v[80:83], v[144:147]
    ds_read_b64_tr_b16 v[14:15], v101 offset:33280
    v_mfma_f32_16x16x32_bf16 v[160:163], v[44:47], v[80:83], v[160:163]
    ds_read_b64_tr_b16 v[16:17], v100 offset:36864
    v_mfma_f32_16x16x32_bf16 v[164:167], v[44:47], v[84:87], v[164:167]
    ds_read_b64_tr_b16 v[18:19], v100 offset:37376
    v_mfma_f32_16x16x32_bf16 v[168:171], v[44:47], v[88:91], v[168:171]
    ds_read_b64_tr_b16 v[20:21], v101 offset:36864
    v_mfma_f32_16x16x32_bf16 v[172:175], v[44:47], v[92:95], v[172:175]
    ds_read_b64_tr_b16 v[22:23], v101 offset:37376
    v_mfma_f32_16x16x32_bf16 v[188:191], v[48:51], v[92:95], v[188:191]
    ds_read_b64_tr_b16 v[24:25], v102 offset:32768
    v_mfma_f32_16x16x32_bf16 v[184:187], v[48:51], v[88:91], v[184:187]
    ds_read_b64_tr_b16 v[26:27], v102 offset:33792
    v_mfma_f32_16x16x32_bf16 v[180:183], v[48:51], v[84:87], v[180:183]
    ds_read_b64_tr_b16 v[28:29], v103 offset:32768
    v_mfma_f32_16x16x32_bf16 v[176:179], v[48:51], v[80:83], v[176:179]
    ds_read_b64_tr_b16 v[30:31], v103 offset:33792
    v_mfma_f32_16x16x32_bf16 v[192:195], v[52:55], v[80:83], v[192:195]
    v_mfma_f32_16x16x32_bf16 v[196:199], v[52:55], v[84:87], v[196:199]
    v_mfma_f32_16x16x32_bf16 v[200:203], v[52:55], v[88:91], v[200:203]
    v_mfma_f32_16x16x32_bf16 v[204:207], v[52:55], v[92:95], v[204:207]
    v_mfma_f32_16x16x32_bf16 v[220:223], v[56:59], v[92:95], v[220:223]
    v_mfma_f32_16x16x32_bf16 v[216:219], v[56:59], v[88:91], v[216:219]
    v_mfma_f32_16x16x32_bf16 v[212:215], v[56:59], v[84:87], v[212:215]
    v_mfma_f32_16x16x32_bf16 v[208:211], v[56:59], v[80:83], v[208:211]
    s_waitcnt vmcnt(0) lgkmcnt(0)
    s_barrier
    v_mfma_f32_16x16x32_bf16 v[128:131], v[8:11], v[64:67], v[128:131]
    ds_read_b64_tr_b16 v[36:37], v100 offset:49152
    v_mov_b32 v5, 0
    v_dot2_f32_bf16 v5, v240, v248, v5
    v_mfma_f32_16x16x32_bf16 v[132:135], v[8:11], v[68:71], v[132:135]
    ds_read_b64_tr_b16 v[38:39], v100 offset:49664
    v_dot2_f32_bf16 v5, v241, v249, v5
    v_dot2_f32_bf16 v5, v242, v250, v5
    v_mfma_f32_16x16x32_bf16 v[136:139], v[8:11], v[72:75], v[136:139]
    ds_read_b128 v[80:83], v99 offset:0
    v_dot2_f32_bf16 v5, v243, v251, v5
    v_dot2_f32_bf16 v5, v244, v252, v5
    v_mfma_f32_16x16x32_bf16 v[140:143], v[8:11], v[76:79], v[140:143]
    ds_read_b128 v[84:87], v99 offset:2048
    v_dot2_f32_bf16 v5, v245, v253, v5
    v_dot2_f32_bf16 v5, v246, v254, v5
    v_mfma_f32_16x16x32_bf16 v[156:159], v[12:15], v[76:79], v[156:159]
    ds_read_b128 v[88:91], v99 offset:4096
    v_dot2_f32_bf16 v5, v247, v255, v5
    s_nop 2
    v_mfma_f32_16x16x32_bf16 v[152:155], v[12:15], v[72:75], v[152:155]
    ds_read_b128 v[92:95], v99 offset:6144
    v_add_f32_dpp v5, v5, v5 row_shr:1 row_mask:0xf bank_mask:0xf bound_ctrl:0
    s_nop 1
    v_add_f32_dpp v5, v5, v5 row_shr:2 row_mask:0xf bank_mask:0xf bound_ctrl:0
    v_mfma_f32_16x16x32_bf16 v[148:151], v[12:15], v[68:71], v[148:151]
    ds_read_b64_tr_b16 v[40:41], v101 offset:49152
    v_add_f32_dpp v5, v5, v5 row_shr:4 row_mask:0xf bank_mask:0xf bound_ctrl:0
    s_nop 1
    v_add_f32_dpp v5, v5, v5 row_shr:8 row_mask:0xf bank_mask:0xf bound_ctrl:0
    v_mfma_f32_16x16x32_bf16 v[144:147], v[12:15], v[64:67], v[144:147]
    ds_read_b64_tr_b16 v[42:43], v101 offset:49664
    v_add_f32_dpp v5, v5, v5 row_bcast:15 row_mask:0xa bank_mask:0xf
    s_nop 1
    v_add_f32_dpp v5, v5, v5 row_bcast:31 row_mask:0xc bank_mask:0xf
    v_mfma_f32_16x16x32_bf16 v[160:163], v[16:19], v[64:67], v[160:163]
    ds_read_b64_tr_b16 v[44:45], v100 offset:53248
    v_mov_b32 v6, 0x42200000
    v_med3_f32 v5, v5, -v6, v6
    v_mfma_f32_16x16x32_bf16 v[164:167], v[16:19], v[68:71], v[164:167]
    ds_read_b64_tr_b16 v[46:47], v100 offset:53760
    v_mul_f32 v5, s80, v5
    v_exp_f32 v5, v5
    v_mfma_f32_16x16x32_bf16 v[168:171], v[16:19], v[72:75], v[168:171]
    ds_read_b64_tr_b16 v[48:49], v101 offset:53248
    v_readlane_b32 s76, v5, 63
    s_nop 1
    v_mov_b32 v5, s76
    v_mfma_f32_16x16x32_bf16 v[172:175], v[16:19], v[76:79], v[172:175]
    ds_read_b64_tr_b16 v[50:51], v101 offset:53760
    buffer_store_dword v5, off, s[36:39], s87 sc1
    v_mfma_f32_16x16x32_bf16 v[188:191], v[20:23], v[76:79], v[188:191]
    ds_read_b64_tr_b16 v[52:53], v102 offset:49152
    v_mfma_f32_16x16x32_bf16 v[184:187], v[20:23], v[72:75], v[184:187]
    ds_read_b64_tr_b16 v[54:55], v102 offset:50176
    v_mfma_f32_16x16x32_bf16 v[180:183], v[20:23], v[68:71], v[180:183]
    ds_read_b64_tr_b16 v[56:57], v103 offset:49152
    v_mfma_f32_16x16x32_bf16 v[176:179], v[20:23], v[64:67], v[176:179]
    ds_read_b64_tr_b16 v[58:59], v103 offset:50176
    v_mfma_f32_16x16x32_bf16 v[192:195], v[24:27], v[64:67], v[192:195]
    v_mfma_f32_16x16x32_bf16 v[196:199], v[24:27], v[68:71], v[196:199]
    v_mfma_f32_16x16x32_bf16 v[200:203], v[24:27], v[72:75], v[200:203]
    v_mfma_f32_16x16x32_bf16 v[204:207], v[24:27], v[76:79], v[204:207]
    v_mfma_f32_16x16x32_bf16 v[220:223], v[28:31], v[76:79], v[220:223]
    v_mfma_f32_16x16x32_bf16 v[216:219], v[28:31], v[72:75], v[216:219]
    v_mfma_f32_16x16x32_bf16 v[212:215], v[28:31], v[68:71], v[212:215]
    v_mfma_f32_16x16x32_bf16 v[208:211], v[28:31], v[64:67], v[208:211]
    s_waitcnt vmcnt(63) lgkmcnt(0)
    s_barrier
    v_mfma_f32_16x16x32_bf16 v[128:131], v[36:39], v[80:83], v[128:131]
    v_mfma_f32_16x16x32_bf16 v[132:135], v[36:39], v[84:87], v[132:135]
    s_add_u32 m0, s101, 0
    s_add_u32 s73, s97, 262144
    buffer_load_dwordx4 v114, s[44:47], s73 offen lds
    s_add_u32 m0, s101, 8192
    s_add_u32 s73, s97, 327680
    buffer_load_dwordx4 v114, s[44:47], s73 offen lds
    v_mfma_f32_16x16x32_bf16 v[136:139], v[36:39], v[88:91], v[136:139]
    v_mfma_f32_16x16x32_bf16 v[140:143], v[36:39], v[92:95], v[140:143]
    v_mfma_f32_16x16x32_bf16 v[156:159], v[40:43], v[92:95], v[156:159]
    s_add_u32 m0, s101, 16384
    s_add_u32 s73, s97, 524288
    buffer_load_dwordx4 v114, s[44:47], s73 offen lds
    s_add_u32 m0, s101, 24576
    s_add_u32 s73, s97, 589824
    buffer_load_dwordx4 v114, s[44:47], s73 offen lds
    v_mfma_f32_16x16x32_bf16 v[152:155], v[40:43], v[88:91], v[152:155]
    v_mfma_f32_16x16x32_bf16 v[148:151], v[40:43], v[84:87], v[148:151]
    v_mfma_f32_16x16x32_bf16 v[144:147], v[40:43], v[80:83], v[144:147]
    s_add_u32 m0, s101, 32768
    s_add_u32 s73, s97, 1179648
    buffer_load_dwordx4 v114, s[44:47], s73 offen lds
    s_add_u32 m0, s101, 40960
    s_add_u32 s73, s97, 1245184
    buffer_load_dwordx4 v114, s[44:47], s73 offen lds
    v_mfma_f32_16x16x32_bf16 v[160:163], v[44:47], v[80:83], v[160:163]
    v_mfma_f32_16x16x32_bf16 v[164:167], v[44:47], v[84:87], v[164:167]
    v_mfma_f32_16x16x32_bf16 v[168:171], v[44:47], v[88:91], v[168:171]
    s_add_u32 m0, s101, 49152
    s_add_u32 s73, s97, 1441792
    buffer_load_dwordx4 v114, s[44:47], s73 offen lds
    s_add_u32 m0, s101, 57344
    s_add_u32 s73, s97, 1507328
    buffer_load_dwordx4 v114, s[44:47], s73 offen lds
    v_mfma_f32_16x16x32_bf16 v[172:175], v[44:47], v[92:95], v[172:175]
    v_mfma_f32_16x16x32_bf16 v[188:191], v[48:51], v[92:95], v[188:191]
    v_mfma_f32_16x16x32_bf16 v[184:187], v[48:51], v[88:91], v[184:187]
    s_add_u32 m0, s101, 65536
    s_add_u32 s73, s97, 196608
    buffer_load_dwordx4 v114, s[44:47], s73 offen lds
    s_add_u32 m0, s101, 73728
    s_add_u32 s73, s97, 393216
    buffer_load_dwordx4 v114, s[44:47], s73 offen lds
    v_mfma_f32_16x16x32_bf16 v[180:183], v[48:51], v[84:87], v[180:183]
    v_mfma_f32_16x16x32_bf16 v[176:179], v[48:51], v[80:83], v[176:179]
    v_mfma_f32_16x16x32_bf16 v[192:195], v[52:55], v[80:83], v[192:195]
    s_add_u32 m0, s101, 81920
    s_add_u32 s73, s97, 458752
    buffer_load_dwordx4 v114, s[44:47], s73 offen lds
    s_add_u32 m0, s101, 90112
    s_add_u32 s73, s97, 655360
    buffer_load_dwordx4 v114, s[44:47], s73 offen lds
    v_mfma_f32_16x16x32_bf16 v[196:199], v[52:55], v[84:87], v[196:199]
    v_mfma_f32_16x16x32_bf16 v[200:203], v[52:55], v[88:91], v[200:203]
    v_mfma_f32_16x16x32_bf16 v[204:207], v[52:55], v[92:95], v[204:207]
    s_add_u32 m0, s101, 98304
    s_add_u32 s73, s97, 1114112
    buffer_load_dwordx4 v114, s[44:47], s73 offen lds
    s_add_u32 m0, s101, 106496
    s_add_u32 s73, s97, 1310720
    buffer_load_dwordx4 v114, s[44:47], s73 offen lds
    v_mfma_f32_16x16x32_bf16 v[220:223], v[56:59], v[92:95], v[220:223]
    v_mfma_f32_16x16x32_bf16 v[216:219], v[56:59], v[88:91], v[216:219]
    v_mfma_f32_16x16x32_bf16 v[212:215], v[56:59], v[84:87], v[212:215]
    v_mfma_f32_16x16x32_bf16 v[208:211], v[56:59], v[80:83], v[208:211]
    s_setprio 2
    s_setprio 3
    s_mov_b32 s79, 0
K1_v11b_nchk:
    v_readfirstlane_b32 s83, v110
    s_nop 1
    s_cmp_lg_u32 s83, 0
    s_cbranch_scc1 K1_v11b_nok
    s_sleep 8
    buffer_load_dword v110, off, s[40:43], 0 sc1
    s_add_u32 s79, s79, 1
    s_waitcnt vmcnt(0)
    s_cmp_lt_u32 s79, 100000
    s_cbranch_scc1 K1_v11b_nchk
K1_v11b_nok:
    s_nop 7
    s_add_u32 s75, s65, 2
    s_lshr_b32 s75, s75, 1
    s_lshl_b32 s75, s75, 10
    s_add_u32 s75, s75, s92
    v_pk_mul_f32 v[240:241], v[160:161], s[80:81] op_sel_hi:[1,0]
    v_pk_mul_f32 v[242:243], v[162:163], s[80:81] op_sel_hi:[1,0]
    v_exp_f32 v240, v240
    v_exp_f32 v241, v241
    v_exp_f32 v242, v242
    v_exp_f32 v243, v243
    v_pk_fma_f32 v[244:245], v[240:241], -0.5, -1.0 op_sel_hi:[1,0,0]
    v_pk_fma_f32 v[246:247], v[242:243], -0.5, -1.0 op_sel_hi:[1,0,0]
    v_pk_fma_f32 v[244:245], v[240:241], v[244:245], -1.0 op_sel_hi:[1,1,0]
    v_pk_fma_f32 v[246:247], v[242:243], v[246:247], -1.0 op_sel_hi:[1,1,0]
    v_rcp_f32 v244, v244
    v_rcp_f32 v245, v245
    v_rcp_f32 v246, v246
    v_rcp_f32 v247, v247
    v_pk_fma_f32 v[160:161], v[160:161], v[244:245], v[160:161]
    v_pk_fma_f32 v[162:163], v[162:163], v[246:247], v[162:163]
    v_pk_mul_f32 v[116:117], v[176:177], s[80:81] op_sel_hi:[1,0]
    v_pk_mul_f32 v[118:119], v[178:179], s[80:81] op_sel_hi:[1,0]
    v_exp_f32 v116, v116
    v_exp_f32 v117, v117
    v_exp_f32 v118, v118
    v_exp_f32 v119, v119
    v_pk_fma_f32 v[120:121], v[116:117], -0.5, -1.0 op_sel_hi:[1,0,0]
    v_pk_fma_f32 v[122:123], v[118:119], -0.5, -1.0 op_sel_hi:[1,0,0]
    v_pk_fma_f32 v[120:121], v[116:117], v[120:121], -1.0 op_sel_hi:[1,1,0]
    v_pk_fma_f32 v[122:123], v[118:119], v[122:123], -1.0 op_sel_hi:[1,1,0]
    v_rcp_f32 v120, v120
    v_rcp_f32 v121, v121
    v_rcp_f32 v122, v122
    v_rcp_f32 v123, v123
    v_pk_fma_f32 v[176:177], v[176:177], v[120:121], v[176:177]
    v_pk_fma_f32 v[178:179], v[178:179], v[122:123], v[178:179]
    v_cvt_pk_bf16_f32 v72, v160, v161
    v_cvt_pk_bf16_f32 v73, v162, v163
    v_cvt_pk_bf16_f32 v74, v176, v177
    v_cvt_pk_bf16_f32 v75, v178, v179
    buffer_store_dwordx4 v[72:75], v113, s[36:39], s75 offen sc1
    s_add_u32 s75, s75, 147456
    v_pk_mul_f32 v[240:241], v[164:165], s[80:81] op_sel_hi:[1,0]
    v_pk_mul_f32 v[242:243], v[166:167], s[80:81] op_sel_hi:[1,0]
    v_exp_f32 v240, v240
    v_exp_f32 v241, v241
    v_exp_f32 v242, v242
    v_exp_f32 v243, v243
    v_pk_fma_f32 v[244:245], v[240:241], -0.5, -1.0 op_sel_hi:[1,0,0]
    v_pk_fma_f32 v[246:247], v[242:243], -0.5, -1.0 op_sel_hi:[1,0,0]
    v_pk_fma_f32 v[244:245], v[240:241], v[244:245], -1.0 op_sel_hi:[1,1,0]
    v_pk_fma_f32 v[246:247], v[242:243], v[246:247], -1.0 op_sel_hi:[1,1,0]
    v_rcp_f32 v244, v244
    v_rcp_f32 v245, v245
    v_rcp_f32 v246, v246
    v_rcp_f32 v247, v247
    v_pk_fma_f32 v[164:165], v[164:165], v[244:245], v[164:165]
    v_pk_fma_f32 v[166:167], v[166:167], v[246:247], v[166:167]
    v_pk_mul_f32 v[116:117], v[180:181], s[80:81] op_sel_hi:[1,0]
    v_pk_mul_f32 v[118:119], v[182:183], s[80:81] op_sel_hi:[1,0]
    v_exp_f32 v116, v116
    v_exp_f32 v117, v117
    v_exp_f32 v118, v118
    v_exp_f32 v119, v119
    v_pk_fma_f32 v[120:121], v[116:117], -0.5, -1.0 op_sel_hi:[1,0,0]
    v_pk_fma_f32 v[122:123], v[118:119], -0.5, -1.0 op_sel_hi:[1,0,0]
    v_pk_fma_f32 v[120:121], v[116:117], v[120:121], -1.0 op_sel_hi:[1,1,0]
    v_pk_fma_f32 v[122:123], v[118:119], v[122:123], -1.0 op_sel_hi:[1,1,0]
    v_rcp_f32 v120, v120
    v_rcp_f32 v121, v121
    v_rcp_f32 v122, v122
    v_rcp_f32 v123, v123
    v_pk_fma_f32 v[180:181], v[180:181], v[120:121], v[180:181]
    v_pk_fma_f32 v[182:183], v[182:183], v[122:123], v[182:183]
    v_cvt_pk_bf16_f32 v76, v164, v165
    v_cvt_pk_bf16_f32 v77, v166, v167
    v_cvt_pk_bf16_f32 v78, v180, v181
    v_cvt_pk_bf16_f32 v79, v182, v183
    buffer_store_dwordx4 v[76:79], v113, s[36:39], s75 offen sc1
    s_add_u32 s75, s75, 147456
    v_pk_mul_f32 v[240:241], v[168:169], s[80:81] op_sel_hi:[1,0]
    v_pk_mul_f32 v[242:243], v[170:171], s[80:81] op_sel_hi:[1,0]
    v_exp_f32 v240, v240
    v_exp_f32 v241, v241
    v_exp_f32 v242, v242
    v_exp_f32 v243, v243
    v_pk_fma_f32 v[244:245], v[240:241], -0.5, -1.0 op_sel_hi:[1,0,0]
    v_pk_fma_f32 v[246:247], v[242:243], -0.5, -1.0 op_sel_hi:[1,0,0]
    v_pk_fma_f32 v[244:245], v[240:241], v[244:245], -1.0 op_sel_hi:[1,1,0]
    v_pk_fma_f32 v[246:247], v[242:243], v[246:247], -1.0 op_sel_hi:[1,1,0]
    v_rcp_f32 v244, v244
    v_rcp_f32 v245, v245
    v_rcp_f32 v246, v246
    v_rcp_f32 v247, v247
    v_pk_fma_f32 v[168:169], v[168:169], v[244:245], v[168:169]
    v_pk_fma_f32 v[170:171], v[170:171], v[246:247], v[170:171]
    v_pk_mul_f32 v[116:117], v[184:185], s[80:81] op_sel_hi:[1,0]
    v_pk_mul_f32 v[118:119], v[186:187], s[80:81] op_sel_hi:[1,0]
    v_exp_f32 v116, v116
    v_exp_f32 v117, v117
    v_exp_f32 v118, v118
    v_exp_f32 v119, v119
    v_pk_fma_f32 v[120:121], v[116:117], -0.5, -1.0 op_sel_hi:[1,0,0]
    v_pk_fma_f32 v[122:123], v[118:119], -0.5, -1.0 op_sel_hi:[1,0,0]
    v_pk_fma_f32 v[120:121], v[116:117], v[120:121], -1.0 op_sel_hi:[1,1,0]
    v_pk_fma_f32 v[122:123], v[118:119], v[122:123], -1.0 op_sel_hi:[1,1,0]
    v_rcp_f32 v120, v120
    v_rcp_f32 v121, v121
    v_rcp_f32 v122, v122
    v_rcp_f32 v123, v123
    v_pk_fma_f32 v[184:185], v[184:185], v[120:121], v[184:185]
    v_pk_fma_f32 v[186:187], v[186:187], v[122:123], v[186:187]
    v_cvt_pk_bf16_f32 v72, v168, v169
    v_cvt_pk_bf16_f32 v73, v170, v171
    v_cvt_pk_bf16_f32 v74, v184, v185
    v_cvt_pk_bf16_f32 v75, v186, v187
    buffer_store_dwordx4 v[72:75], v113, s[36:39], s75 offen sc1
    s_add_u32 s75, s75, 147456
    v_pk_mul_f32 v[240:241], v[172:173], s[80:81] op_sel_hi:[1,0]
    v_pk_mul_f32 v[242:243], v[174:175], s[80:81] op_sel_hi:[1,0]
    v_exp_f32 v240, v240
    v_exp_f32 v241, v241
    v_exp_f32 v242, v242
    v_exp_f32 v243, v243
    v_pk_fma_f32 v[244:245], v[240:241], -0.5, -1.0 op_sel_hi:[1,0,0]
    v_pk_fma_f32 v[246:247], v[242:243], -0.5, -1.0 op_sel_hi:[1,0,0]
    v_pk_fma_f32 v[244:245], v[240:241], v[244:245], -1.0 op_sel_hi:[1,1,0]
    v_pk_fma_f32 v[246:247], v[242:243], v[246:247], -1.0 op_sel_hi:[1,1,0]
    v_rcp_f32 v244, v244
    v_rcp_f32 v245, v245
    v_rcp_f32 v246, v246
    v_rcp_f32 v247, v247
    v_pk_fma_f32 v[172:173], v[172:173], v[244:245], v[172:173]
    v_pk_fma_f32 v[174:175], v[174:175], v[246:247], v[174:175]
    v_pk_mul_f32 v[116:117], v[188:189], s[80:81] op_sel_hi:[1,0]
    v_pk_mul_f32 v[118:119], v[190:191], s[80:81] op_sel_hi:[1,0]
    v_exp_f32 v116, v116
    v_exp_f32 v117, v117
    v_exp_f32 v118, v118
    v_exp_f32 v119, v119
    v_pk_fma_f32 v[120:121], v[116:117], -0.5, -1.0 op_sel_hi:[1,0,0]
    v_pk_fma_f32 v[122:123], v[118:119], -0.5, -1.0 op_sel_hi:[1,0,0]
    v_pk_fma_f32 v[120:121], v[116:117], v[120:121], -1.0 op_sel_hi:[1,1,0]
    v_pk_fma_f32 v[122:123], v[118:119], v[122:123], -1.0 op_sel_hi:[1,1,0]
    v_rcp_f32 v120, v120
    v_rcp_f32 v121, v121
    v_rcp_f32 v122, v122
    v_rcp_f32 v123, v123
    v_pk_fma_f32 v[188:189], v[188:189], v[120:121], v[188:189]
    v_pk_fma_f32 v[190:191], v[190:191], v[122:123], v[190:191]
    v_cvt_pk_bf16_f32 v76, v172, v173
    v_cvt_pk_bf16_f32 v77, v174, v175
    v_cvt_pk_bf16_f32 v78, v188, v189
    v_cvt_pk_bf16_f32 v79, v190, v191
    buffer_store_dwordx4 v[76:79], v113, s[36:39], s75 offen sc1
    s_setprio 2
    s_add_u32 s75, s63, 0
    s_lshr_b32 s75, s75, 1
    s_lshl_b32 s75, s75, 10
    s_add_u32 s75, s75, s92
    v_pk_mul_f32 v[240:241], v[192:193], s[80:81] op_sel_hi:[1,0]
    v_pk_mul_f32 v[242:243], v[194:195], s[80:81] op_sel_hi:[1,0]
    v_exp_f32 v240, v240
    v_exp_f32 v241, v241
    v_exp_f32 v242, v242
    v_exp_f32 v243, v243
    v_pk_fma_f32 v[244:245], v[240:241], -0.5, -1.0 op_sel_hi:[1,0,0]
    v_pk_fma_f32 v[246:247], v[242:243], -0.5, -1.0 op_sel_hi:[1,0,0]
    v_pk_fma_f32 v[244:245], v[240:241], v[244:245], -1.0 op_sel_hi:[1,1,0]
    v_pk_fma_f32 v[246:247], v[242:243], v[246:247], -1.0 op_sel_hi:[1,1,0]
    v_rcp_f32 v244, v244
    v_rcp_f32 v245, v245
    v_rcp_f32 v246, v246
    v_rcp_f32 v247, v247
    v_pk_fma_f32 v[192:193], v[192:193], v[244:245], v[192:193]
    v_pk_fma_f32 v[194:195], v[194:195], v[246:247], v[194:195]
    v_pk_mul_f32 v[116:117], v[208:209], s[80:81] op_sel_hi:[1,0]
    v_pk_mul_f32 v[118:119], v[210:211], s[80:81] op_sel_hi:[1,0]
    v_exp_f32 v116, v116
    v_exp_f32 v117, v117
    v_exp_f32 v118, v118
    v_exp_f32 v119, v119
    v_pk_fma_f32 v[120:121], v[116:117], -0.5, -1.0 op_sel_hi:[1,0,0]
    v_pk_fma_f32 v[122:123], v[118:119], -0.5, -1.0 op_sel_hi:[1,0,0]
    v_pk_fma_f32 v[120:121], v[116:117], v[120:121], -1.0 op_sel_hi:[1,1,0]
    v_pk_fma_f32 v[122:123], v[118:119], v[122:123], -1.0 op_sel_hi:[1,1,0]
    v_rcp_f32 v120, v120
    v_rcp_f32 v121, v121
    v_rcp_f32 v122, v122
    v_rcp_f32 v123, v123
    v_pk_fma_f32 v[208:209], v[208:209], v[120:121], v[208:209]
    v_pk_fma_f32 v[210:211], v[210:211], v[122:123], v[210:211]
    v_cvt_pk_bf16_f32 v72, v192, v193
    v_cvt_pk_bf16_f32 v73, v194, v195
    v_cvt_pk_bf16_f32 v74, v208, v209
    v_cvt_pk_bf16_f32 v75, v210, v211
    buffer_store_dwordx4 v[72:75], v113, s[36:39], s75 offen sc1
    s_add_u32 s75, s75, 147456
    v_pk_mul_f32 v[240:241], v[196:197], s[80:81] op_sel_hi:[1,0]
    v_pk_mul_f32 v[242:243], v[198:199], s[80:81] op_sel_hi:[1,0]
    v_exp_f32 v240, v240
    v_exp_f32 v241, v241
    v_exp_f32 v242, v242
    v_exp_f32 v243, v243
    v_pk_fma_f32 v[244:245], v[240:241], -0.5, -1.0 op_sel_hi:[1,0,0]
    v_pk_fma_f32 v[246:247], v[242:243], -0.5, -1.0 op_sel_hi:[1,0,0]
    v_pk_fma_f32 v[244:245], v[240:241], v[244:245], -1.0 op_sel_hi:[1,1,0]
    v_pk_fma_f32 v[246:247], v[242:243], v[246:247], -1.0 op_sel_hi:[1,1,0]
    v_rcp_f32 v244, v244
    v_rcp_f32 v245, v245
    v_rcp_f32 v246, v246
    v_rcp_f32 v247, v247
    v_pk_fma_f32 v[196:197], v[196:197], v[244:245], v[196:197]
    v_pk_fma_f32 v[198:199], v[198:199], v[246:247], v[198:199]
    v_pk_mul_f32 v[116:117], v[212:213], s[80:81] op_sel_hi:[1,0]
    v_pk_mul_f32 v[118:119], v[214:215], s[80:81] op_sel_hi:[1,0]
    v_exp_f32 v116, v116
    v_exp_f32 v117, v117
    v_exp_f32 v118, v118
    v_exp_f32 v119, v119
    v_pk_fma_f32 v[120:121], v[116:117], -0.5, -1.0 op_sel_hi:[1,0,0]
    v_pk_fma_f32 v[122:123], v[118:119], -0.5, -1.0 op_sel_hi:[1,0,0]
    v_pk_fma_f32 v[120:121], v[116:117], v[120:121], -1.0 op_sel_hi:[1,1,0]
    v_pk_fma_f32 v[122:123], v[118:119], v[122:123], -1.0 op_sel_hi:[1,1,0]
    v_rcp_f32 v120, v120
    v_rcp_f32 v121, v121
    v_rcp_f32 v122, v122
    v_rcp_f32 v123, v123
    v_pk_fma_f32 v[212:213], v[212:213], v[120:121], v[212:213]
    v_pk_fma_f32 v[214:215], v[214:215], v[122:123], v[214:215]
    v_cvt_pk_bf16_f32 v76, v196, v197
    v_cvt_pk_bf16_f32 v77, v198, v199
    v_cvt_pk_bf16_f32 v78, v212, v213
    v_cvt_pk_bf16_f32 v79, v214, v215
    buffer_store_dwordx4 v[76:79], v113, s[36:39], s75 offen sc1
    s_add_u32 s75, s75, 147456
    v_pk_mul_f32 v[240:241], v[200:201], s[80:81] op_sel_hi:[1,0]
    v_pk_mul_f32 v[242:243], v[202:203], s[80:81] op_sel_hi:[1,0]
    v_exp_f32 v240, v240
    v_exp_f32 v241, v241
    v_exp_f32 v242, v242
    v_exp_f32 v243, v243
    v_pk_fma_f32 v[244:245], v[240:241], -0.5, -1.0 op_sel_hi:[1,0,0]
    v_pk_fma_f32 v[246:247], v[242:243], -0.5, -1.0 op_sel_hi:[1,0,0]
    v_pk_fma_f32 v[244:245], v[240:241], v[244:245], -1.0 op_sel_hi:[1,1,0]
    v_pk_fma_f32 v[246:247], v[242:243], v[246:247], -1.0 op_sel_hi:[1,1,0]
    v_rcp_f32 v244, v244
    v_rcp_f32 v245, v245
    v_rcp_f32 v246, v246
    v_rcp_f32 v247, v247
    v_pk_fma_f32 v[200:201], v[200:201], v[244:245], v[200:201]
    v_pk_fma_f32 v[202:203], v[202:203], v[246:247], v[202:203]
    v_pk_mul_f32 v[116:117], v[216:217], s[80:81] op_sel_hi:[1,0]
    v_pk_mul_f32 v[118:119], v[218:219], s[80:81] op_sel_hi:[1,0]
    v_exp_f32 v116, v116
    v_exp_f32 v117, v117
    v_exp_f32 v118, v118
    v_exp_f32 v119, v119
    v_pk_fma_f32 v[120:121], v[116:117], -0.5, -1.0 op_sel_hi:[1,0,0]
    v_pk_fma_f32 v[122:123], v[118:119], -0.5, -1.0 op_sel_hi:[1,0,0]
    v_pk_fma_f32 v[120:121], v[116:117], v[120:121], -1.0 op_sel_hi:[1,1,0]
    v_pk_fma_f32 v[122:123], v[118:119], v[122:123], -1.0 op_sel_hi:[1,1,0]
    v_rcp_f32 v120, v120
    v_rcp_f32 v121, v121
    v_rcp_f32 v122, v122
    v_rcp_f32 v123, v123
    v_pk_fma_f32 v[216:217], v[216:217], v[120:121], v[216:217]
    v_pk_fma_f32 v[218:219], v[218:219], v[122:123], v[218:219]
    v_cvt_pk_bf16_f32 v72, v200, v201
    v_cvt_pk_bf16_f32 v73, v202, v203
    v_cvt_pk_bf16_f32 v74, v216, v217
    v_cvt_pk_bf16_f32 v75, v218, v219
    buffer_store_dwordx4 v[72:75], v113, s[36:39], s75 offen sc1
    s_add_u32 s75, s75, 147456
    v_pk_mul_f32 v[240:241], v[204:205], s[80:81] op_sel_hi:[1,0]
    v_pk_mul_f32 v[242:243], v[206:207], s[80:81] op_sel_hi:[1,0]
    v_exp_f32 v240, v240
    v_exp_f32 v241, v241
    v_exp_f32 v242, v242
    v_exp_f32 v243, v243
    v_pk_fma_f32 v[244:245], v[240:241], -0.5, -1.0 op_sel_hi:[1,0,0]
    v_pk_fma_f32 v[246:247], v[242:243], -0.5, -1.0 op_sel_hi:[1,0,0]
    v_pk_fma_f32 v[244:245], v[240:241], v[244:245], -1.0 op_sel_hi:[1,1,0]
    v_pk_fma_f32 v[246:247], v[242:243], v[246:247], -1.0 op_sel_hi:[1,1,0]
    v_rcp_f32 v244, v244
    v_rcp_f32 v245, v245
    v_rcp_f32 v246, v246
    v_rcp_f32 v247, v247
    v_pk_fma_f32 v[204:205], v[204:205], v[244:245], v[204:205]
    v_pk_fma_f32 v[206:207], v[206:207], v[246:247], v[206:207]
    v_pk_mul_f32 v[116:117], v[220:221], s[80:81] op_sel_hi:[1,0]
    v_pk_mul_f32 v[118:119], v[222:223], s[80:81] op_sel_hi:[1,0]
    v_exp_f32 v116, v116
    v_exp_f32 v117, v117
    v_exp_f32 v118, v118
    v_exp_f32 v119, v119
    v_pk_fma_f32 v[120:121], v[116:117], -0.5, -1.0 op_sel_hi:[1,0,0]
    v_pk_fma_f32 v[122:123], v[118:119], -0.5, -1.0 op_sel_hi:[1,0,0]
    v_pk_fma_f32 v[120:121], v[116:117], v[120:121], -1.0 op_sel_hi:[1,1,0]
    v_pk_fma_f32 v[122:123], v[118:119], v[122:123], -1.0 op_sel_hi:[1,1,0]
    v_rcp_f32 v120, v120
    v_rcp_f32 v121, v121
    v_rcp_f32 v122, v122
    v_rcp_f32 v123, v123
    v_pk_fma_f32 v[220:221], v[220:221], v[120:121], v[220:221]
    v_pk_fma_f32 v[222:223], v[222:223], v[122:123], v[222:223]
    v_cvt_pk_bf16_f32 v76, v204, v205
    v_cvt_pk_bf16_f32 v77, v206, v207
    v_cvt_pk_bf16_f32 v78, v220, v221
    v_cvt_pk_bf16_f32 v79, v222, v223
    buffer_store_dwordx4 v[76:79], v113, s[36:39], s75 offen sc1
    s_waitcnt vmcnt(4)
    s_barrier
    s_branch P2_start
P2_start:
    s_setprio 0
    s_mov_b32 s79, 0
P2n_nchk:
    v_readfirstlane_b32 s83, v110
    s_nop 1
    s_cmp_lg_u32 s83, 0
    s_cbranch_scc1 P2n_nok
    s_sleep 8
    buffer_load_dword v110, off, s[40:43], 0 sc1
    s_add_u32 s79, s79, 1
    s_waitcnt vmcnt(0)
    s_cmp_lt_u32 s79, 100000
    s_cbranch_scc1 P2n_nchk
P2n_nok:
    s_and_b32 s73, s93, 0xf8
    s_lshl_b32 s73, s73, 7
    s_add_u32 s73, s73, 19996672
    v_and_b32 v5, 3, v1
    v_lshlrev_b32 v5, 8, v5
    v_add_u32 v123, s73, v5
    v_add_u32 v120, 128, v123
    v_add_u32 v112, 4, v120
    s_lshr_b32 s56, s93, 5
    s_lshl_b32 s73, s56, 12
    s_add_u32 s73, s73, 19996672
    v_lshlrev_b32 v5, 7, v1
    v_add_u32 v6, s73, v5
    v_cmp_gt_u32 vcc, 32, v1
    s_nop 1
    v_cndmask_b32 v112, v112, v6, vcc
    s_lshl_b32 s75, s56, 4
    s_lshl_b32 s76, s59, 1
    s_add_u32 s75, s75, s76
    s_and_b32 s76, s95, 1
    s_add_u32 s76, s75, s76
    s_mul_i32 s73, s76, 147456
    v_add_u32 v104, s73, v113
    s_xor_b32 s74, s76, 1
    s_mul_i32 s73, s74, 147456
    v_add_u32 v105, s73, v113
    v_and_b32 v5, 15, v1
    v_lshlrev_b32 v5, 2, v5
    s_lshl_b32 s73, s76, 6
    s_add_u32 s73, s73, 19922944
    v_add_u32 v106, s73, v5
    s_lshl_b32 s73, s74, 6
    s_add_u32 s73, s73, 19922944
    v_add_u32 v107, s73, v5
    s_lshl_b32 s87, s76, 4
    s_mul_i32 s96, s95, 28672
    s_add_u32 s96, s96, 32768
    s_lshl_b32 s18, s95, 13
    s_lshl_b32 s73, s57, 7
    s_add_u32 s73, s73, 19988480
    v_add_u32 v122, s73, v5
    s_cmp_eq_u32 s61, 1
    s_cbranch_scc1 P2_g1skip
    s_cmp_eq_u32 s58, 0
    s_cbranch_scc1 P2_nobA
    s_waitcnt vmcnt(6)
    s_barrier
    s_cmp_lg_u32 s59, 3
    s_cbranch_scc1 P2_nobA
    buffer_store_dword v110, off, s[36:39], s100 offset:8 sc1
P2_nobA:
    v_bfe_u32 v3, v1, 2, 2
    v_lshl_add_u32 v5, v2, 2, v3
    v_and_b32 v6, 7, v5
    s_lshr_b32 s75, s95, 1
    s_lshl_b32 s75, s75, 2
    v_xor_b32 v6, s75, v6
    v_lshlrev_b32 v5, 8, v5
    v_and_b32 v3, 3, v1
    v_lshl_add_u32 v5, v3, 3, v5
    v_xor_b32 v7, 0, v6
    v_lshl_add_u32 v80, v7, 5, v5
    v_add_u32 v88, 65536, v80
    v_add_u32 v96, 131072, v80
    v_xor_b32 v7, 1, v6
    v_lshl_add_u32 v81, v7, 5, v5
    v_add_u32 v89, 65536, v81
    v_add_u32 v97, 131072, v81
    v_xor_b32 v7, 2, v6
    v_lshl_add_u32 v82, v7, 5, v5
    v_add_u32 v90, 65536, v82
    v_add_u32 v98, 131072, v82
    v_xor_b32 v7, 3, v6
    v_lshl_add_u32 v83, v7, 5, v5
    v_add_u32 v91, 65536, v83
    v_add_u32 v99, 131072, v83
    v_xor_b32 v7, 4, v6
    v_lshl_add_u32 v84, v7, 5, v5
    v_add_u32 v92, 65536, v84
    v_add_u32 v100, 131072, v84
    v_xor_b32 v7, 5, v6
    v_lshl_add_u32 v85, v7, 5, v5
    v_add_u32 v93, 65536, v85
    v_add_u32 v101, 131072, v85
    v_xor_b32 v7, 6, v6
    v_lshl_add_u32 v86, v7, 5, v5
    v_add_u32 v94, 65536, v86
    v_add_u32 v102, 131072, v86
    v_xor_b32 v7, 7, v6
    v_lshl_add_u32 v87, v7, 5, v5
    v_add_u32 v95, 65536, v87
    v_add_u32 v103, 131072, v87
    s_mov_b32 s48, s20
    s_and_b32 s49, s21, 0xffff
    s_mov_b32 s50, 4194304
    s_mov_b32 s51, 0x00020000
    s_mov_b32 s88, s8
    s_and_b32 s89, s9, 0xffff
    s_mov_b32 s90, 2097152
    s_mov_b32 s91, 0x00020000
    s_mov_b32 s28, s24
    s_and_b32 s29, s25, 0xffff
    s_mov_b32 s30, 268435456
    s_mov_b32 s31, 0x00020000
    s_cmp_ge_u32 s59, 6
    s_cselect_b32 s30, 0, s30
    s_mul_i32 s99, s57, 98304
    s_add_u32 s99, s99, 20971520
    s_lshl_b32 s76, s59, 11
    s_add_u32 s99, s99, s76
    s_cmp_ge_u32 s59, 3
    s_cselect_b32 s76, 43008, 0
    s_add_u32 s99, s99, s76
    s_cmp_eq_u32 s58, 0
    s_cbranch_scc1 P2_noqa
    v_pk_mul_f32 v[56:57], v[128:129], s[80:81] op_sel_hi:[1,0]
    v_pk_mul_f32 v[58:59], v[130:131], s[80:81] op_sel_hi:[1,0]
    v_min_f32 v56, 0, v56
    v_min_f32 v57, 0, v57
    v_min_f32 v58, 0, v58
    v_min_f32 v59, 0, v59
    v_exp_f32 v56, v56
    v_exp_f32 v57, v57
    v_exp_f32 v58, v58
    v_exp_f32 v59, v59
    v_max_f32 v128, 0, v128
    v_max_f32 v129, 0, v129
    v_max_f32 v130, 0, v130
    v_max_f32 v131, 0, v131
    v_pk_add_f32 v[128:129], v[128:129], v[56:57]
    v_pk_add_f32 v[130:131], v[130:131], v[58:59]
    v_add_f32 v128, s86, v128
    v_add_f32 v129, s86, v129
    v_add_f32 v130, s86, v130
    v_add_f32 v131, s86, v131
    v_pk_mul_f32 v[60:61], v[132:133], s[80:81] op_sel_hi:[1,0]
    v_pk_mul_f32 v[62:63], v[134:135], s[80:81] op_sel_hi:[1,0]
    v_min_f32 v60, 0, v60
    v_min_f32 v61, 0, v61
    v_min_f32 v62, 0, v62
    v_min_f32 v63, 0, v63
    v_exp_f32 v60, v60
    v_exp_f32 v61, v61
    v_exp_f32 v62, v62
    v_exp_f32 v63, v63
    v_max_f32 v132, 0, v132
    v_max_f32 v133, 0, v133
    v_max_f32 v134, 0, v134
    v_max_f32 v135, 0, v135
    v_pk_add_f32 v[132:133], v[132:133], v[60:61]
    v_pk_add_f32 v[134:135], v[134:135], v[62:63]
    v_add_f32 v132, s86, v132
    v_add_f32 v133, s86, v133
    v_add_f32 v134, s86, v134
    v_add_f32 v135, s86, v135
    v_pk_mul_f32 v[56:57], v[136:137], s[80:81] op_sel_hi:[1,0]
    v_pk_mul_f32 v[58:59], v[138:139], s[80:81] op_sel_hi:[1,0]
    v_min_f32 v56, 0, v56
    v_min_f32 v57, 0, v57
    v_min_f32 v58, 0, v58
    v_min_f32 v59, 0, v59
    v_exp_f32 v56, v56
    v_exp_f32 v57, v57
    v_exp_f32 v58, v58
    v_exp_f32 v59, v59
    v_max_f32 v136, 0, v136
    v_max_f32 v137, 0, v137
    v_max_f32 v138, 0, v138
    v_max_f32 v139, 0, v139
    v_pk_add_f32 v[136:137], v[136:137], v[56:57]
    v_pk_add_f32 v[138:139], v[138:139], v[58:59]
    v_add_f32 v136, s86, v136
    v_add_f32 v137, s86, v137
    v_add_f32 v138, s86, v138
    v_add_f32 v139, s86, v139
    v_pk_mul_f32 v[60:61], v[140:141], s[80:81] op_sel_hi:[1,0]
    v_pk_mul_f32 v[62:63], v[142:143], s[80:81] op_sel_hi:[1,0]
    v_min_f32 v60, 0, v60
    v_min_f32 v61, 0, v61
    v_min_f32 v62, 0, v62
    v_min_f32 v63, 0, v63
    v_exp_f32 v60, v60
    v_exp_f32 v61, v61
    v_exp_f32 v62, v62
    v_exp_f32 v63, v63
    v_max_f32 v140, 0, v140
    v_max_f32 v141, 0, v141
    v_max_f32 v142, 0, v142
    v_max_f32 v143, 0, v143
    v_pk_add_f32 v[140:141], v[140:141], v[60:61]
    v_pk_add_f32 v[142:143], v[142:143], v[62:63]
    v_add_f32 v140, s86, v140
    v_add_f32 v141, s86, v141
    v_add_f32 v142, s86, v142
    v_add_f32 v143, s86, v143
    v_pk_mul_f32 v[56:57], v[144:145], s[80:81] op_sel_hi:[1,0]
    v_pk_mul_f32 v[58:59], v[146:147], s[80:81] op_sel_hi:[1,0]
    v_min_f32 v56, 0, v56
    v_min_f32 v57, 0, v57
    v_min_f32 v58, 0, v58
    v_min_f32 v59, 0, v59
    v_exp_f32 v56, v56
    v_exp_f32 v57, v57
    v_exp_f32 v58, v58
    v_exp_f32 v59, v59
    v_max_f32 v144, 0, v144
    v_max_f32 v145, 0, v145
    v_max_f32 v146, 0, v146
    v_max_f32 v147, 0, v147
    v_pk_add_f32 v[144:145], v[144:145], v[56:57]
    v_pk_add_f32 v[146:147], v[146:147], v[58:59]
    v_add_f32 v144, s86, v144
    v_add_f32 v145, s86, v145
    v_add_f32 v146, s86, v146
    v_add_f32 v147, s86, v147
    v_pk_mul_f32 v[60:61], v[148:149], s[80:81] op_sel_hi:[1,0]
    v_pk_mul_f32 v[62:63], v[150:151], s[80:81] op_sel_hi:[1,0]
    v_min_f32 v60, 0, v60
    v_min_f32 v61, 0, v61
    v_min_f32 v62, 0, v62
    v_min_f32 v63, 0, v63
    v_exp_f32 v60, v60
    v_exp_f32 v61, v61
    v_exp_f32 v62, v62
    v_exp_f32 v63, v63
    v_max_f32 v148, 0, v148
    v_max_f32 v149, 0, v149
    v_max_f32 v150, 0, v150
    v_max_f32 v151, 0, v151
    v_pk_add_f32 v[148:149], v[148:149], v[60:61]
    v_pk_add_f32 v[150:151], v[150:151], v[62:63]
    v_add_f32 v148, s86, v148
    v_add_f32 v149, s86, v149
    v_add_f32 v150, s86, v150
    v_add_f32 v151, s86, v151
    v_pk_mul_f32 v[56:57], v[152:153], s[80:81] op_sel_hi:[1,0]
    v_pk_mul_f32 v[58:59], v[154:155], s[80:81] op_sel_hi:[1,0]
    v_min_f32 v56, 0, v56
    v_min_f32 v57, 0, v57
    v_min_f32 v58, 0, v58
    v_min_f32 v59, 0, v59
    v_exp_f32 v56, v56
    v_exp_f32 v57, v57
    v_exp_f32 v58, v58
    v_exp_f32 v59, v59
    v_max_f32 v152, 0, v152
    v_max_f32 v153, 0, v153
    v_max_f32 v154, 0, v154
    v_max_f32 v155, 0, v155
    v_pk_add_f32 v[152:153], v[152:153], v[56:57]
    v_pk_add_f32 v[154:155], v[154:155], v[58:59]
    v_add_f32 v152, s86, v152
    v_add_f32 v153, s86, v153
    v_add_f32 v154, s86, v154
    v_add_f32 v155, s86, v155
    v_pk_mul_f32 v[60:61], v[156:157], s[80:81] op_sel_hi:[1,0]
    v_pk_mul_f32 v[62:63], v[158:159], s[80:81] op_sel_hi:[1,0]
    v_min_f32 v60, 0, v60
    v_min_f32 v61, 0, v61
    v_min_f32 v62, 0, v62
    v_min_f32 v63, 0, v63
    v_exp_f32 v60, v60
    v_exp_f32 v61, v61
    v_exp_f32 v62, v62
    v_exp_f32 v63, v63
    v_max_f32 v156, 0, v156
    v_max_f32 v157, 0, v157
    v_max_f32 v158, 0, v158
    v_max_f32 v159, 0, v159
    v_pk_add_f32 v[156:157], v[156:157], v[60:61]
    v_pk_add_f32 v[158:159], v[158:159], v[62:63]
    v_add_f32 v156, s86, v156
    v_add_f32 v157, s86, v157
    v_add_f32 v158, s86, v158
    v_add_f32 v159, s86, v159
    v_cvt_pk_bf16_f32 v40, v128, v129
    v_cvt_pk_bf16_f32 v41, v130, v131
    v_cvt_pk_bf16_f32 v42, v144, v145
    v_cvt_pk_bf16_f32 v43, v146, v147
    v_cvt_pk_bf16_f32 v44, v132, v133
    v_cvt_pk_bf16_f32 v45, v134, v135
    v_cvt_pk_bf16_f32 v46, v148, v149
    v_cvt_pk_bf16_f32 v47, v150, v151
    v_cvt_pk_bf16_f32 v48, v136, v137
    v_cvt_pk_bf16_f32 v49, v138, v139
    v_cvt_pk_bf16_f32 v50, v152, v153
    v_cvt_pk_bf16_f32 v51, v154, v155
    v_cvt_pk_bf16_f32 v52, v140, v141
    v_cvt_pk_bf16_f32 v53, v142, v143
    v_cvt_pk_bf16_f32 v54, v156, v157
    v_cvt_pk_bf16_f32 v55, v158, v159
P2_noqa:
    s_cmp_lg_u32 s59, 3
    s_cbranch_scc1 P2_g1skip
    v_add_u32 v124, 8, v120
    v_mov_b32 v121, 0
    s_mov_b32 s79, 0
P2c1_c:
    v_cmp_ne_u32 vcc, s83, v121
    s_nop 4
    s_cbranch_vccz P2c1_ok
    buffer_load_dword v121, v124, s[36:39], 0 offen sc1
    s_add_u32 s79, s79, 1
    s_waitcnt vmcnt(0)
    s_cmp_lt_u32 s79, 100000
    s_cbranch_scc1 P2c1_c
P2c1_ok:
P2_g1skip:
    s_waitcnt vmcnt(0)
    s_barrier
    s_cmp_lg_u32 s59, 3
    s_cbranch_scc1 P2_noflag
    buffer_store_dword v110, off, s[36:39], s100 sc1
P2_noflag:
    s_add_u32 s74, s96, 4096
    buffer_load_dwordx4 v[8:11], v104, s[36:39], s74 offen sc1
    buffer_load_dwordx4 v[12:15], v105, s[36:39], s74 offen sc1
    s_add_u32 s74, s96, 5120
    buffer_load_dwordx4 v[16:19], v104, s[36:39], s74 offen sc1
    buffer_load_dwordx4 v[20:23], v105, s[36:39], s74 offen sc1
    s_add_u32 s74, s96, 8192
    buffer_load_dwordx4 v[24:27], v104, s[36:39], s74 offen sc1
    buffer_load_dwordx4 v[28:31], v105, s[36:39], s74 offen sc1
    s_cmp_eq_u32 s61, 0
    s_cbranch_scc1 P2_g0skip2
    v_bfe_u32 v3, v1, 2, 2
    v_lshl_add_u32 v5, v2, 2, v3
    v_and_b32 v6, 7, v5
    s_lshr_b32 s75, s95, 1
    s_lshl_b32 s75, s75, 2
    v_xor_b32 v6, s75, v6
    v_lshlrev_b32 v5, 8, v5
    v_and_b32 v3, 3, v1
    v_lshl_add_u32 v5, v3, 3, v5
    v_xor_b32 v7, 0, v6
    v_lshl_add_u32 v80, v7, 5, v5
    v_add_u32 v88, 65536, v80
    v_add_u32 v96, 131072, v80
    v_xor_b32 v7, 1, v6
    v_lshl_add_u32 v81, v7, 5, v5
    v_add_u32 v89, 65536, v81
    v_add_u32 v97, 131072, v81
    v_xor_b32 v7, 2, v6
    v_lshl_add_u32 v82, v7, 5, v5
    v_add_u32 v90, 65536, v82
    v_add_u32 v98, 131072, v82
    v_xor_b32 v7, 3, v6
    v_lshl_add_u32 v83, v7, 5, v5
    v_add_u32 v91, 65536, v83
    v_add_u32 v99, 131072, v83
    v_xor_b32 v7, 4, v6
    v_lshl_add_u32 v84, v7, 5, v5
    v_add_u32 v92, 65536, v84
    v_add_u32 v100, 131072, v84
    v_xor_b32 v7, 5, v6
    v_lshl_add_u32 v85, v7, 5, v5
    v_add_u32 v93, 65536, v85
    v_add_u32 v101, 131072, v85
    v_xor_b32 v7, 6, v6
    v_lshl_add_u32 v86, v7, 5, v5
    v_add_u32 v94, 65536, v86
    v_add_u32 v102, 131072, v86
    v_xor_b32 v7, 7, v6
    v_lshl_add_u32 v87, v7, 5, v5
    v_add_u32 v95, 65536, v87
    v_add_u32 v103, 131072, v87
    s_mov_b32 s48, s20
    s_and_b32 s49, s21, 0xffff
    s_mov_b32 s50, 4194304
    s_mov_b32 s51, 0x00020000
    s_mov_b32 s88, s8
    s_and_b32 s89, s9, 0xffff
    s_mov_b32 s90, 2097152
    s_mov_b32 s91, 0x00020000
    s_mov_b32 s28, s24
    s_and_b32 s29, s25, 0xffff
    s_mov_b32 s30, 268435456
    s_mov_b32 s31, 0x00020000
    s_cmp_ge_u32 s59, 6
    s_cselect_b32 s30, 0, s30
    s_mul_i32 s99, s57, 98304
    s_add_u32 s99, s99, 20971520
    s_lshl_b32 s76, s59, 11
    s_add_u32 s99, s99, s76
    s_cmp_ge_u32 s59, 3
    s_cselect_b32 s76, 43008, 0
    s_add_u32 s99, s99, s76
    s_cmp_eq_u32 s58, 0
    s_cbranch_scc1 P2_noqb
    v_pk_mul_f32 v[56:57], v[128:129], s[80:81] op_sel_hi:[1,0]
    v_pk_mul_f32 v[58:59], v[130:131], s[80:81] op_sel_hi:[1,0]
    v_min_f32 v56, 0, v56
    v_min_f32 v57, 0, v57
    v_min_f32 v58, 0, v58
    v_min_f32 v59, 0, v59
    v_exp_f32 v56, v56
    v_exp_f32 v57, v57
    v_exp_f32 v58, v58
    v_exp_f32 v59, v59
    v_max_f32 v128, 0, v128
    v_max_f32 v129, 0, v129
    v_max_f32 v130, 0, v130
    v_max_f32 v131, 0, v131
    v_pk_add_f32 v[128:129], v[128:129], v[56:57]
    v_pk_add_f32 v[130:131], v[130:131], v[58:59]
    v_add_f32 v128, s86, v128
    v_add_f32 v129, s86, v129
    v_add_f32 v130, s86, v130
    v_add_f32 v131, s86, v131
    v_pk_mul_f32 v[60:61], v[132:133], s[80:81] op_sel_hi:[1,0]
    v_pk_mul_f32 v[62:63], v[134:135], s[80:81] op_sel_hi:[1,0]
    v_min_f32 v60, 0, v60
    v_min_f32 v61, 0, v61
    v_min_f32 v62, 0, v62
    v_min_f32 v63, 0, v63
    v_exp_f32 v60, v60
    v_exp_f32 v61, v61
    v_exp_f32 v62, v62
    v_exp_f32 v63, v63
    v_max_f32 v132, 0, v132
    v_max_f32 v133, 0, v133
    v_max_f32 v134, 0, v134
    v_max_f32 v135, 0, v135
    v_pk_add_f32 v[132:133], v[132:133], v[60:61]
    v_pk_add_f32 v[134:135], v[134:135], v[62:63]
    v_add_f32 v132, s86, v132
    v_add_f32 v133, s86, v133
    v_add_f32 v134, s86, v134
    v_add_f32 v135, s86, v135
    v_pk_mul_f32 v[56:57], v[136:137], s[80:81] op_sel_hi:[1,0]
    v_pk_mul_f32 v[58:59], v[138:139], s[80:81] op_sel_hi:[1,0]
    v_min_f32 v56, 0, v56
    v_min_f32 v57, 0, v57
    v_min_f32 v58, 0, v58
    v_min_f32 v59, 0, v59
    v_exp_f32 v56, v56
    v_exp_f32 v57, v57
    v_exp_f32 v58, v58
    v_exp_f32 v59, v59
    v_max_f32 v136, 0, v136
    v_max_f32 v137, 0, v137
    v_max_f32 v138, 0, v138
    v_max_f32 v139, 0, v139
    v_pk_add_f32 v[136:137], v[136:137], v[56:57]
    v_pk_add_f32 v[138:139], v[138:139], v[58:59]
    v_add_f32 v136, s86, v136
    v_add_f32 v137, s86, v137
    v_add_f32 v138, s86, v138
    v_add_f32 v139, s86, v139
    v_pk_mul_f32 v[60:61], v[140:141], s[80:81] op_sel_hi:[1,0]
    v_pk_mul_f32 v[62:63], v[142:143], s[80:81] op_sel_hi:[1,0]
    v_min_f32 v60, 0, v60
    v_min_f32 v61, 0, v61
    v_min_f32 v62, 0, v62
    v_min_f32 v63, 0, v63
    v_exp_f32 v60, v60
    v_exp_f32 v61, v61
    v_exp_f32 v62, v62
    v_exp_f32 v63, v63
    v_max_f32 v140, 0, v140
    v_max_f32 v141, 0, v141
    v_max_f32 v142, 0, v142
    v_max_f32 v143, 0, v143
    v_pk_add_f32 v[140:141], v[140:141], v[60:61]
    v_pk_add_f32 v[142:143], v[142:143], v[62:63]
    v_add_f32 v140, s86, v140
    v_add_f32 v141, s86, v141
    v_add_f32 v142, s86, v142
    v_add_f32 v143, s86, v143
    v_pk_mul_f32 v[56:57], v[144:145], s[80:81] op_sel_hi:[1,0]
    v_pk_mul_f32 v[58:59], v[146:147], s[80:81] op_sel_hi:[1,0]
    v_min_f32 v56, 0, v56
    v_min_f32 v57, 0, v57
    v_min_f32 v58, 0, v58
    v_min_f32 v59, 0, v59
    v_exp_f32 v56, v56
    v_exp_f32 v57, v57
    v_exp_f32 v58, v58
    v_exp_f32 v59, v59
    v_max_f32 v144, 0, v144
    v_max_f32 v145, 0, v145
    v_max_f32 v146, 0, v146
    v_max_f32 v147, 0, v147
    v_pk_add_f32 v[144:145], v[144:145], v[56:57]
    v_pk_add_f32 v[146:147], v[146:147], v[58:59]
    v_add_f32 v144, s86, v144
    v_add_f32 v145, s86, v145
    v_add_f32 v146, s86, v146
    v_add_f32 v147, s86, v147
    v_pk_mul_f32 v[60:61], v[148:149], s[80:81] op_sel_hi:[1,0]
    v_pk_mul_f32 v[62:63], v[150:151], s[80:81] op_sel_hi:[1,0]
    v_min_f32 v60, 0, v60
    v_min_f32 v61, 0, v61
    v_min_f32 v62, 0, v62
    v_min_f32 v63, 0, v63
    v_exp_f32 v60, v60
    v_exp_f32 v61, v61
    v_exp_f32 v62, v62
    v_exp_f32 v63, v63
    v_max_f32 v148, 0, v148
    v_max_f32 v149, 0, v149
    v_max_f32 v150, 0, v150
    v_max_f32 v151, 0, v151
    v_pk_add_f32 v[148:149], v[148:149], v[60:61]
    v_pk_add_f32 v[150:151], v[150:151], v[62:63]
    v_add_f32 v148, s86, v148
    v_add_f32 v149, s86, v149
    v_add_f32 v150, s86, v150
    v_add_f32 v151, s86, v151
    v_pk_mul_f32 v[56:57], v[152:153], s[80:81] op_sel_hi:[1,0]
    v_pk_mul_f32 v[58:59], v[154:155], s[80:81] op_sel_hi:[1,0]
    v_min_f32 v56, 0, v56
    v_min_f32 v57, 0, v57
    v_min_f32 v58, 0, v58
    v_min_f32 v59, 0, v59
    v_exp_f32 v56, v56
    v_exp_f32 v57, v57
    v_exp_f32 v58, v58
    v_exp_f32 v59, v59
    v_max_f32 v152, 0, v152
    v_max_f32 v153, 0, v153
    v_max_f32 v154, 0, v154
    v_max_f32 v155, 0, v155
    v_pk_add_f32 v[152:153], v[152:153], v[56:57]
    v_pk_add_f32 v[154:155], v[154:155], v[58:59]
    v_add_f32 v152, s86, v152
    v_add_f32 v153, s86, v153
    v_add_f32 v154, s86, v154
    v_add_f32 v155, s86, v155
    v_pk_mul_f32 v[60:61], v[156:157], s[80:81] op_sel_hi:[1,0]
    v_pk_mul_f32 v[62:63], v[158:159], s[80:81] op_sel_hi:[1,0]
    v_min_f32 v60, 0, v60
    v_min_f32 v61, 0, v61
    v_min_f32 v62, 0, v62
    v_min_f32 v63, 0, v63
    v_exp_f32 v60, v60
    v_exp_f32 v61, v61
    v_exp_f32 v62, v62
    v_exp_f32 v63, v63
    v_max_f32 v156, 0, v156
    v_max_f32 v157, 0, v157
    v_max_f32 v158, 0, v158
    v_max_f32 v159, 0, v159
    v_pk_add_f32 v[156:157], v[156:157], v[60:61]
    v_pk_add_f32 v[158:159], v[158:159], v[62:63]
    v_add_f32 v156, s86, v156
    v_add_f32 v157, s86, v157
    v_add_f32 v158, s86, v158
    v_add_f32 v159, s86, v159
    v_cvt_pk_bf16_f32 v40, v128, v129
    v_cvt_pk_bf16_f32 v41, v130, v131
    v_cvt_pk_bf16_f32 v42, v144, v145
    v_cvt_pk_bf16_f32 v43, v146, v147
    v_cvt_pk_bf16_f32 v44, v132, v133
    v_cvt_pk_bf16_f32 v45, v134, v135
    v_cvt_pk_bf16_f32 v46, v148, v149
    v_cvt_pk_bf16_f32 v47, v150, v151
    v_cvt_pk_bf16_f32 v48, v136, v137
    v_cvt_pk_bf16_f32 v49, v138, v139
    v_cvt_pk_bf16_f32 v50, v152, v153
    v_cvt_pk_bf16_f32 v51, v154, v155
    v_cvt_pk_bf16_f32 v52, v140, v141
    v_cvt_pk_bf16_f32 v53, v142, v143
    v_cvt_pk_bf16_f32 v54, v156, v157
    v_cvt_pk_bf16_f32 v55, v158, v159
P2_noqb:
P2_g0skip2:
    ds_read_b64_tr_b16 v[192:193], v80 offset:0
    ds_read_b64_tr_b16 v[194:195], v80 offset:4096
    ds_read_b64_tr_b16 v[196:197], v81 offset:0
    ds_read_b64_tr_b16 v[198:199], v81 offset:4096
    ds_read_b64_tr_b16 v[200:201], v82 offset:0
    ds_read_b64_tr_b16 v[202:203], v82 offset:4096
    ds_read_b64_tr_b16 v[204:205], v83 offset:0
    ds_read_b64_tr_b16 v[206:207], v83 offset:4096
    ds_read_b64_tr_b16 v[208:209], v84 offset:0
    ds_read_b64_tr_b16 v[210:211], v84 offset:4096
    ds_read_b64_tr_b16 v[212:213], v85 offset:0
    ds_read_b64_tr_b16 v[214:215], v85 offset:4096
    ds_read_b64_tr_b16 v[216:217], v86 offset:0
    ds_read_b64_tr_b16 v[218:219], v86 offset:4096
    ds_read_b64_tr_b16 v[220:221], v87 offset:0
    ds_read_b64_tr_b16 v[222:223], v87 offset:4096
    s_waitcnt vmcnt(4) lgkmcnt(0)
    s_cmp_eq_u32 s58, 0
    s_cbranch_scc1 P2b0
    buffer_load_dword v121, v122, s[36:39], 0 offen sc1
P2b0:
    v_mfma_f32_16x16x32_bf16 v[128:131], v[192:195], v[8:11], 0
    ds_read_b64_tr_b16 v[224:225], v80 offset:8192
    ds_read_b64_tr_b16 v[226:227], v80 offset:12288
    v_mfma_f32_16x16x32_bf16 v[132:135], v[192:195], v[12:15], 0
    ds_read_b64_tr_b16 v[228:229], v81 offset:8192
    ds_read_b64_tr_b16 v[230:231], v81 offset:12288
    v_mfma_f32_16x16x32_bf16 v[140:143], v[196:199], v[12:15], 0
    ds_read_b64_tr_b16 v[232:233], v82 offset:8192
    ds_read_b64_tr_b16 v[234:235], v82 offset:12288
    v_mfma_f32_16x16x32_bf16 v[136:139], v[196:199], v[8:11], 0
    ds_read_b64_tr_b16 v[236:237], v83 offset:8192
    ds_read_b64_tr_b16 v[238:239], v83 offset:12288
    s_add_u32 s74, s96, 9216
    buffer_load_dwordx4 v[32:35], v104, s[36:39], s74 offen sc1
    v_mfma_f32_16x16x32_bf16 v[144:147], v[200:203], v[8:11], 0
    ds_read_b64_tr_b16 v[240:241], v84 offset:8192
    ds_read_b64_tr_b16 v[242:243], v84 offset:12288
    v_mfma_f32_16x16x32_bf16 v[148:151], v[200:203], v[12:15], 0
    ds_read_b64_tr_b16 v[244:245], v85 offset:8192
    ds_read_b64_tr_b16 v[246:247], v85 offset:12288
    v_mfma_f32_16x16x32_bf16 v[156:159], v[204:207], v[12:15], 0
    ds_read_b64_tr_b16 v[248:249], v86 offset:8192
    ds_read_b64_tr_b16 v[250:251], v86 offset:12288
    v_mfma_f32_16x16x32_bf16 v[152:155], v[204:207], v[8:11], 0
    ds_read_b64_tr_b16 v[252:253], v87 offset:8192
    ds_read_b64_tr_b16 v[254:255], v87 offset:12288
    buffer_load_dwordx4 v[36:39], v105, s[36:39], s74 offen sc1
    v_mfma_f32_16x16x32_bf16 v[160:163], v[208:211], v[8:11], 0
    v_mfma_f32_16x16x32_bf16 v[164:167], v[208:211], v[12:15], 0
    v_mfma_f32_16x16x32_bf16 v[172:175], v[212:215], v[12:15], 0
    s_add_u32 m0, s101, 114688
    s_add_u32 s73, s97, 1376256
    buffer_load_dwordx4 v114, s[44:47], s73 offen lds
    v_mfma_f32_16x16x32_bf16 v[168:171], v[212:215], v[8:11], 0
    v_mfma_f32_16x16x32_bf16 v[176:179], v[216:219], v[8:11], 0
    v_mfma_f32_16x16x32_bf16 v[180:183], v[216:219], v[12:15], 0
    v_mfma_f32_16x16x32_bf16 v[188:191], v[220:223], v[12:15], 0
    v_mfma_f32_16x16x32_bf16 v[184:187], v[220:223], v[8:11], 0
    s_cmp_eq_u32 s58, 1
    s_cbranch_scc1 P2_w0
    s_waitcnt vmcnt(5)
P2_w0:
    s_waitcnt vmcnt(6) lgkmcnt(0)
    v_mfma_f32_16x16x32_bf16 v[128:131], v[224:227], v[16:19], v[128:131]
    ds_read_b64_tr_b16 v[192:193], v80 offset:16384
    ds_read_b64_tr_b16 v[194:195], v80 offset:20480
    v_mfma_f32_16x16x32_bf16 v[132:135], v[224:227], v[20:23], v[132:135]
    ds_read_b64_tr_b16 v[196:197], v81 offset:16384
    ds_read_b64_tr_b16 v[198:199], v81 offset:20480
    v_mfma_f32_16x16x32_bf16 v[140:143], v[228:231], v[20:23], v[140:143]
    ds_read_b64_tr_b16 v[200:201], v82 offset:16384
    ds_read_b64_tr_b16 v[202:203], v82 offset:20480
    v_mfma_f32_16x16x32_bf16 v[136:139], v[228:231], v[16:19], v[136:139]
    ds_read_b64_tr_b16 v[204:205], v83 offset:16384
    ds_read_b64_tr_b16 v[206:207], v83 offset:20480
    s_add_u32 s74, s96, 18432
    buffer_load_dwordx4 v[8:11], v104, s[36:39], s74 offen sc1
    v_mfma_f32_16x16x32_bf16 v[144:147], v[232:235], v[16:19], v[144:147]
    ds_read_b64_tr_b16 v[208:209], v84 offset:16384
    ds_read_b64_tr_b16 v[210:211], v84 offset:20480
    v_mfma_f32_16x16x32_bf16 v[148:151], v[232:235], v[20:23], v[148:151]
    ds_read_b64_tr_b16 v[212:213], v85 offset:16384
    ds_read_b64_tr_b16 v[214:215], v85 offset:20480
    v_mfma_f32_16x16x32_bf16 v[156:159], v[236:239], v[20:23], v[156:159]
    ds_read_b64_tr_b16 v[216:217], v86 offset:16384
    ds_read_b64_tr_b16 v[218:219], v86 offset:20480
    v_mfma_f32_16x16x32_bf16 v[152:155], v[236:239], v[16:19], v[152:155]
    ds_read_b64_tr_b16 v[220:221], v87 offset:16384
    ds_read_b64_tr_b16 v[222:223], v87 offset:20480
    buffer_load_dwordx4 v[12:15], v105, s[36:39], s74 offen sc1
    v_mfma_f32_16x16x32_bf16 v[160:163], v[240:243], v[16:19], v[160:163]
    v_mfma_f32_16x16x32_bf16 v[164:167], v[240:243], v[20:23], v[164:167]
    v_mfma_f32_16x16x32_bf16 v[172:175], v[244:247], v[20:23], v[172:175]
    s_add_u32 m0, s101, 122880
    s_add_u32 s73, s97, 1572864
    buffer_load_dwordx4 v114, s[44:47], s73 offen lds
    v_mfma_f32_16x16x32_bf16 v[168:171], v[244:247], v[16:19], v[168:171]
    v_mfma_f32_16x16x32_bf16 v[176:179], v[248:251], v[16:19], v[176:179]
    v_mfma_f32_16x16x32_bf16 v[180:183], v[248:251], v[20:23], v[180:183]
    v_mfma_f32_16x16x32_bf16 v[188:191], v[252:255], v[20:23], v[188:191]
    v_mfma_f32_16x16x32_bf16 v[184:187], v[252:255], v[16:19], v[184:187]
    s_cmp_eq_u32 s58, 1
    s_cbranch_scc1 P2_w1
    s_waitcnt vmcnt(6)
P2_w1:
    s_waitcnt vmcnt(7) lgkmcnt(0)
    s_cmp_eq_u32 s58, 0
    s_cbranch_scc1 P2b2
    s_waitcnt vmcnt(6)
    s_mov_b32 s79, 0
P2kv_c:
    v_cmp_ne_u32 vcc, s83, v121
    s_nop 4
    s_cbranch_vccz P2kv_ok
    s_sleep 4
    buffer_load_dword v121, v122, s[36:39], 0 offen sc1
    s_add_u32 s79, s79, 1
    s_waitcnt vmcnt(0)
    s_cmp_lt_u32 s79, 100000
    s_cbranch_scc1 P2kv_c
P2kv_ok:
    s_add_u32 s75, s99, 0
    buffer_load_dwordx4 v[56:59], v113, s[28:31], s75 offen offset:0 sc1
    buffer_load_dwordx4 v[60:63], v113, s[28:31], s75 offen offset:1024 sc1
    s_add_u32 s75, s99, 6144
    buffer_load_dwordx4 v[64:67], v113, s[28:31], s75 offen offset:0 sc1
    buffer_load_dwordx4 v[68:71], v113, s[28:31], s75 offen offset:1024 sc1
P2b2:
    v_mfma_f32_16x16x32_bf16 v[128:131], v[192:195], v[24:27], v[128:131]
    ds_read_b64_tr_b16 v[224:225], v80 offset:24576
    ds_read_b64_tr_b16 v[226:227], v80 offset:28672
    v_mfma_f32_16x16x32_bf16 v[132:135], v[192:195], v[28:31], v[132:135]
    ds_read_b64_tr_b16 v[228:229], v81 offset:24576
    ds_read_b64_tr_b16 v[230:231], v81 offset:28672
    v_mfma_f32_16x16x32_bf16 v[140:143], v[196:199], v[28:31], v[140:143]
    ds_read_b64_tr_b16 v[232:233], v82 offset:24576
    ds_read_b64_tr_b16 v[234:235], v82 offset:28672
    v_mfma_f32_16x16x32_bf16 v[136:139], v[196:199], v[24:27], v[136:139]
    ds_read_b64_tr_b16 v[236:237], v83 offset:24576
    ds_read_b64_tr_b16 v[238:239], v83 offset:28672
    s_add_u32 s74, s96, 19456
    buffer_load_dwordx4 v[16:19], v104, s[36:39], s74 offen sc1
    v_mfma_f32_16x16x32_bf16 v[144:147], v[200:203], v[24:27], v[144:147]
    ds_read_b64_tr_b16 v[240:241], v84 offset:24576
    ds_read_b64_tr_b16 v[242:243], v84 offset:28672
    v_mfma_f32_16x16x32_bf16 v[148:151], v[200:203], v[28:31], v[148:151]
    ds_read_b64_tr_b16 v[244:245], v85 offset:24576
    ds_read_b64_tr_b16 v[246:247], v85 offset:28672
    v_mfma_f32_16x16x32_bf16 v[156:159], v[204:207], v[28:31], v[156:159]
    ds_read_b64_tr_b16 v[248:249], v86 offset:24576
    ds_read_b64_tr_b16 v[250:251], v86 offset:28672
    v_mfma_f32_16x16x32_bf16 v[152:155], v[204:207], v[24:27], v[152:155]
    ds_read_b64_tr_b16 v[252:253], v87 offset:24576
    ds_read_b64_tr_b16 v[254:255], v87 offset:28672
    buffer_load_dwordx4 v[20:23], v105, s[36:39], s74 offen sc1
    v_mfma_f32_16x16x32_bf16 v[160:163], v[208:211], v[24:27], v[160:163]
    v_mfma_f32_16x16x32_bf16 v[164:167], v[208:211], v[28:31], v[164:167]
    v_mfma_f32_16x16x32_bf16 v[172:175], v[212:215], v[28:31], v[172:175]
    s_add_u32 m0, s101, 131072
    s_add_u32 s73, s97, 0
    buffer_load_dwordx4 v114, s[44:47], s73 offen lds
    v_mfma_f32_16x16x32_bf16 v[168:171], v[212:215], v[24:27], v[168:171]
    v_mfma_f32_16x16x32_bf16 v[176:179], v[216:219], v[24:27], v[176:179]
    v_mfma_f32_16x16x32_bf16 v[180:183], v[216:219], v[28:31], v[180:183]
    v_mfma_f32_16x16x32_bf16 v[188:191], v[220:223], v[28:31], v[188:191]
    v_mfma_f32_16x16x32_bf16 v[184:187], v[220:223], v[24:27], v[184:187]
    s_cmp_eq_u32 s58, 1
    s_cbranch_scc1 P2_w2
    s_waitcnt vmcnt(7)
P2_w2:
    s_waitcnt vmcnt(11) lgkmcnt(0)
    s_cmp_lg_u32 s59, 7
    s_cbranch_scc1 P2_nl3
    buffer_load_dword v111, v120, s[36:39], 0 offen sc1
P2_nl3:
    v_mfma_f32_16x16x32_bf16 v[128:131], v[224:227], v[32:35], v[128:131]
    ds_read_b64_tr_b16 v[192:193], v80 offset:32768
    ds_read_b64_tr_b16 v[194:195], v80 offset:36864
    v_mfma_f32_16x16x32_bf16 v[132:135], v[224:227], v[36:39], v[132:135]
    ds_read_b64_tr_b16 v[196:197], v81 offset:32768
    ds_read_b64_tr_b16 v[198:199], v81 offset:36864
    v_mfma_f32_16x16x32_bf16 v[140:143], v[228:231], v[36:39], v[140:143]
    ds_read_b64_tr_b16 v[200:201], v82 offset:32768
    ds_read_b64_tr_b16 v[202:203], v82 offset:36864
    v_mfma_f32_16x16x32_bf16 v[136:139], v[228:231], v[32:35], v[136:139]
    ds_read_b64_tr_b16 v[204:205], v83 offset:32768
    ds_read_b64_tr_b16 v[206:207], v83 offset:36864
    s_add_u32 s74, s96, 22528
    buffer_load_dwordx4 v[24:27], v104, s[36:39], s74 offen sc1
    v_mfma_f32_16x16x32_bf16 v[144:147], v[232:235], v[32:35], v[144:147]
    ds_read_b64_tr_b16 v[208:209], v84 offset:32768
    ds_read_b64_tr_b16 v[210:211], v84 offset:36864
    v_mfma_f32_16x16x32_bf16 v[148:151], v[232:235], v[36:39], v[148:151]
    ds_read_b64_tr_b16 v[212:213], v85 offset:32768
    ds_read_b64_tr_b16 v[214:215], v85 offset:36864
    v_mfma_f32_16x16x32_bf16 v[156:159], v[236:239], v[36:39], v[156:159]
    ds_read_b64_tr_b16 v[216:217], v86 offset:32768
    ds_read_b64_tr_b16 v[218:219], v86 offset:36864
    v_mfma_f32_16x16x32_bf16 v[152:155], v[236:239], v[32:35], v[152:155]
    ds_read_b64_tr_b16 v[220:221], v87 offset:32768
    ds_read_b64_tr_b16 v[222:223], v87 offset:36864
    buffer_load_dwordx4 v[28:31], v105, s[36:39], s74 offen sc1
    v_mfma_f32_16x16x32_bf16 v[160:163], v[240:243], v[32:35], v[160:163]
    v_mfma_f32_16x16x32_bf16 v[164:167], v[240:243], v[36:39], v[164:167]
    v_mfma_f32_16x16x32_bf16 v[172:175], v[244:247], v[36:39], v[172:175]
    s_add_u32 m0, s101, 139264
    s_add_u32 s73, s97, 65536
    buffer_load_dwordx4 v114, s[44:47], s73 offen lds
    v_mfma_f32_16x16x32_bf16 v[168:171], v[244:247], v[32:35], v[168:171]
    v_mfma_f32_16x16x32_bf16 v[176:179], v[248:251], v[32:35], v[176:179]
    v_mfma_f32_16x16x32_bf16 v[180:183], v[248:251], v[36:39], v[180:183]
    v_mfma_f32_16x16x32_bf16 v[188:191], v[252:255], v[36:39], v[188:191]
    v_mfma_f32_16x16x32_bf16 v[184:187], v[252:255], v[32:35], v[184:187]
    s_cmp_eq_u32 s58, 1
    s_cbranch_scc1 P2_w3
    s_waitcnt vmcnt(7)
P2_w3:
    s_waitcnt vmcnt(11) lgkmcnt(0)
    s_cmp_eq_u32 s58, 0
    s_cbranch_scc1 P2b4
    s_waitcnt vmcnt(6)
    v_pk_add_f32 v[72:73], v[56:57], v[64:65]
    v_pk_add_f32 v[74:75], v[58:59], v[66:67]
    v_pk_add_f32 v[76:77], v[60:61], v[68:69]
    v_pk_add_f32 v[78:79], v[62:63], v[70:71]
    s_add_u32 s75, s99, 12288
    buffer_load_dwordx4 v[56:59], v113, s[28:31], s75 offen offset:0 sc1
    buffer_load_dwordx4 v[60:63], v113, s[28:31], s75 offen offset:1024 sc1
    s_add_u32 s75, s99, 18432
    buffer_load_dwordx4 v[64:67], v113, s[28:31], s75 offen offset:0 sc1
    buffer_load_dwordx4 v[68:71], v113, s[28:31], s75 offen offset:1024 sc1
P2b4:
    v_mfma_f32_16x16x32_bf16 v[128:131], v[192:195], v[8:11], v[128:131]
    ds_read_b64_tr_b16 v[224:225], v80 offset:40960
    ds_read_b64_tr_b16 v[226:227], v80 offset:45056
    v_mfma_f32_16x16x32_bf16 v[132:135], v[192:195], v[12:15], v[132:135]
    ds_read_b64_tr_b16 v[228:229], v81 offset:40960
    ds_read_b64_tr_b16 v[230:231], v81 offset:45056
    v_mfma_f32_16x16x32_bf16 v[140:143], v[196:199], v[12:15], v[140:143]
    ds_read_b64_tr_b16 v[232:233], v82 offset:40960
    ds_read_b64_tr_b16 v[234:235], v82 offset:45056
    v_mfma_f32_16x16x32_bf16 v[136:139], v[196:199], v[8:11], v[136:139]
    ds_read_b64_tr_b16 v[236:237], v83 offset:40960
    ds_read_b64_tr_b16 v[238:239], v83 offset:45056
    s_add_u32 s74, s96, 23552
    buffer_load_dwordx4 v[32:35], v104, s[36:39], s74 offen sc1
    v_mfma_f32_16x16x32_bf16 v[144:147], v[200:203], v[8:11], v[144:147]
    ds_read_b64_tr_b16 v[240:241], v84 offset:40960
    ds_read_b64_tr_b16 v[242:243], v84 offset:45056
    v_mfma_f32_16x16x32_bf16 v[148:151], v[200:203], v[12:15], v[148:151]
    ds_read_b64_tr_b16 v[244:245], v85 offset:40960
    ds_read_b64_tr_b16 v[246:247], v85 offset:45056
    v_mfma_f32_16x16x32_bf16 v[156:159], v[204:207], v[12:15], v[156:159]
    ds_read_b64_tr_b16 v[248:249], v86 offset:40960
    ds_read_b64_tr_b16 v[250:251], v86 offset:45056
    v_mfma_f32_16x16x32_bf16 v[152:155], v[204:207], v[8:11], v[152:155]
    ds_read_b64_tr_b16 v[252:253], v87 offset:40960
    ds_read_b64_tr_b16 v[254:255], v87 offset:45056
    buffer_load_dwordx4 v[36:39], v105, s[36:39], s74 offen sc1
    v_mfma_f32_16x16x32_bf16 v[160:163], v[208:211], v[8:11], v[160:163]
    v_mfma_f32_16x16x32_bf16 v[164:167], v[208:211], v[12:15], v[164:167]
    v_mfma_f32_16x16x32_bf16 v[172:175], v[212:215], v[12:15], v[172:175]
    v_mfma_f32_16x16x32_bf16 v[168:171], v[212:215], v[8:11], v[168:171]
    v_mfma_f32_16x16x32_bf16 v[176:179], v[216:219], v[8:11], v[176:179]
    v_mfma_f32_16x16x32_bf16 v[180:183], v[216:219], v[12:15], v[180:183]
    v_mfma_f32_16x16x32_bf16 v[188:191], v[220:223], v[12:15], v[188:191]
    v_mfma_f32_16x16x32_bf16 v[184:187], v[220:223], v[8:11], v[184:187]
    s_cmp_eq_u32 s58, 1
    s_cbranch_scc1 P2_w4
    s_waitcnt vmcnt(6)
P2_w4:
    s_waitcnt vmcnt(10) lgkmcnt(0)
    v_mfma_f32_16x16x32_bf16 v[128:131], v[224:227], v[16:19], v[128:131]
    ds_read_b64_tr_b16 v[192:193], v80 offset:49152
    ds_read_b64_tr_b16 v[194:195], v80 offset:53248
    v_mfma_f32_16x16x32_bf16 v[132:135], v[224:227], v[20:23], v[132:135]
    ds_read_b64_tr_b16 v[196:197], v81 offset:49152
    ds_read_b64_tr_b16 v[198:199], v81 offset:53248
    v_mfma_f32_16x16x32_bf16 v[140:143], v[228:231], v[20:23], v[140:143]
    ds_read_b64_tr_b16 v[200:201], v82 offset:49152
    ds_read_b64_tr_b16 v[202:203], v82 offset:53248
    v_mfma_f32_16x16x32_bf16 v[136:139], v[228:231], v[16:19], v[136:139]
    ds_read_b64_tr_b16 v[204:205], v83 offset:49152
    ds_read_b64_tr_b16 v[206:207], v83 offset:53248
    v_mfma_f32_16x16x32_bf16 v[144:147], v[232:235], v[16:19], v[144:147]
    ds_read_b64_tr_b16 v[208:209], v84 offset:49152
    ds_read_b64_tr_b16 v[210:211], v84 offset:53248
    v_mfma_f32_16x16x32_bf16 v[148:151], v[232:235], v[20:23], v[148:151]
    ds_read_b64_tr_b16 v[212:213], v85 offset:49152
    ds_read_b64_tr_b16 v[214:215], v85 offset:53248
    v_mfma_f32_16x16x32_bf16 v[156:159], v[236:239], v[20:23], v[156:159]
    ds_read_b64_tr_b16 v[216:217], v86 offset:49152
    ds_read_b64_tr_b16 v[218:219], v86 offset:53248
    v_mfma_f32_16x16x32_bf16 v[152:155], v[236:239], v[16:19], v[152:155]
    ds_read_b64_tr_b16 v[220:221], v87 offset:49152
    ds_read_b64_tr_b16 v[222:223], v87 offset:53248
    v_mfma_f32_16x16x32_bf16 v[160:163], v[240:243], v[16:19], v[160:163]
    v_mfma_f32_16x16x32_bf16 v[164:167], v[240:243], v[20:23], v[164:167]
    v_mfma_f32_16x16x32_bf16 v[172:175], v[244:247], v[20:23], v[172:175]
    v_mfma_f32_16x16x32_bf16 v[168:171], v[244:247], v[16:19], v[168:171]
    v_mfma_f32_16x16x32_bf16 v[176:179], v[248:251], v[16:19], v[176:179]
    v_mfma_f32_16x16x32_bf16 v[180:183], v[248:251], v[20:23], v[180:183]
    v_mfma_f32_16x16x32_bf16 v[188:191], v[252:255], v[20:23], v[188:191]
    v_mfma_f32_16x16x32_bf16 v[184:187], v[252:255], v[16:19], v[184:187]
    s_cmp_lg_u32 s59, 7
    s_cbranch_scc1 P2_nc5
    s_waitcnt vmcnt(5)
    s_mov_b32 s79, 0
P2c1b_c:
    v_cmp_ne_u32 vcc, s83, v111
    s_nop 4
    s_cbranch_vccz P2c1b_ok
    s_sleep 4
    buffer_load_dword v111, v120, s[36:39], 0 offen sc1
    s_add_u32 s79, s79, 1
    s_waitcnt vmcnt(0)
    s_cmp_lt_u32 s79, 100000
    s_cbranch_scc1 P2c1b_c
P2c1b_ok:
P2_nc5:
    s_cmp_eq_u32 s58, 1
    s_cbranch_scc1 P2_w5
    s_waitcnt vmcnt(3)
P2_w5:
    s_waitcnt vmcnt(7) lgkmcnt(0)
    s_barrier
    s_cmp_eq_u32 s58, 0
    s_cbranch_scc1 P2b6
    s_waitcnt vmcnt(2)
    v_pk_add_f32 v[72:73], v[72:73], v[56:57]
    v_pk_add_f32 v[72:73], v[72:73], v[64:65]
    v_pk_add_f32 v[74:75], v[74:75], v[58:59]
    v_pk_add_f32 v[74:75], v[74:75], v[66:67]
    v_pk_add_f32 v[76:77], v[76:77], v[60:61]
    v_pk_add_f32 v[76:77], v[76:77], v[68:69]
    v_pk_add_f32 v[78:79], v[78:79], v[62:63]
    v_pk_add_f32 v[78:79], v[78:79], v[70:71]
    s_add_u32 s75, s99, 24576
    buffer_load_dwordx4 v[56:59], v113, s[28:31], s75 offen offset:0 sc1
    buffer_load_dwordx4 v[60:63], v113, s[28:31], s75 offen offset:1024 sc1
    s_add_u32 s75, s99, 30720
    buffer_load_dwordx4 v[64:67], v113, s[28:31], s75 offen offset:0 sc1
    buffer_load_dwordx4 v[68:71], v113, s[28:31], s75 offen offset:1024 sc1
P2b6:
    v_mfma_f32_16x16x32_bf16 v[128:131], v[192:195], v[24:27], v[128:131]
    ds_read_b64_tr_b16 v[224:225], v80 offset:57344
    ds_read_b64_tr_b16 v[226:227], v80 offset:61440
    v_mfma_f32_16x16x32_bf16 v[132:135], v[192:195], v[28:31], v[132:135]
    ds_read_b64_tr_b16 v[228:229], v81 offset:57344
    ds_read_b64_tr_b16 v[230:231], v81 offset:61440
    v_mfma_f32_16x16x32_bf16 v[140:143], v[196:199], v[28:31], v[140:143]
    ds_read_b64_tr_b16 v[232:233], v82 offset:57344
    ds_read_b64_tr_b16 v[234:235], v82 offset:61440
    v_mfma_f32_16x16x32_bf16 v[136:139], v[196:199], v[24:27], v[136:139]
    ds_read_b64_tr_b16 v[236:237], v83 offset:57344
    ds_read_b64_tr_b16 v[238:239], v83 offset:61440
    s_add_u32 s74, s96, 3072
    buffer_load_dwordx4 v[8:11], v104, s[36:39], s74 offen sc1
    v_mfma_f32_16x16x32_bf16 v[144:147], v[200:203], v[24:27], v[144:147]
    ds_read_b64_tr_b16 v[240:241], v84 offset:57344
    ds_read_b64_tr_b16 v[242:243], v84 offset:61440
    v_mfma_f32_16x16x32_bf16 v[148:151], v[200:203], v[28:31], v[148:151]
    ds_read_b64_tr_b16 v[244:245], v85 offset:57344
    ds_read_b64_tr_b16 v[246:247], v85 offset:61440
    v_mfma_f32_16x16x32_bf16 v[156:159], v[204:207], v[28:31], v[156:159]
    ds_read_b64_tr_b16 v[248:249], v86 offset:57344
    ds_read_b64_tr_b16 v[250:251], v86 offset:61440
    v_mfma_f32_16x16x32_bf16 v[152:155], v[204:207], v[24:27], v[152:155]
    ds_read_b64_tr_b16 v[252:253], v87 offset:57344
    ds_read_b64_tr_b16 v[254:255], v87 offset:61440
    buffer_load_dwordx4 v[12:15], v105, s[36:39], s74 offen sc1
    v_mfma_f32_16x16x32_bf16 v[160:163], v[208:211], v[24:27], v[160:163]
    v_mfma_f32_16x16x32_bf16 v[164:167], v[208:211], v[28:31], v[164:167]
    v_mfma_f32_16x16x32_bf16 v[172:175], v[212:215], v[28:31], v[172:175]
    s_add_u32 s74, s96, 6144
    buffer_load_dwordx4 v[16:19], v104, s[36:39], s74 offen sc1
    v_mfma_f32_16x16x32_bf16 v[168:171], v[212:215], v[24:27], v[168:171]
    v_mfma_f32_16x16x32_bf16 v[176:179], v[216:219], v[24:27], v[176:179]
    v_mfma_f32_16x16x32_bf16 v[180:183], v[216:219], v[28:31], v[180:183]
    buffer_load_dwordx4 v[20:23], v105, s[36:39], s74 offen sc1
    v_mfma_f32_16x16x32_bf16 v[188:191], v[220:223], v[28:31], v[188:191]
    v_mfma_f32_16x16x32_bf16 v[184:187], v[220:223], v[24:27], v[184:187]
    s_cmp_eq_u32 s58, 1
    s_cbranch_scc1 P2_w6
    s_waitcnt vmcnt(4)
P2_w6:
    s_waitcnt vmcnt(8) lgkmcnt(0)
    v_mfma_f32_16x16x32_bf16 v[128:131], v[224:227], v[32:35], v[128:131]
    ds_read_b64_tr_b16 v[192:193], v88 offset:0
    ds_read_b64_tr_b16 v[194:195], v88 offset:4096
    v_mfma_f32_16x16x32_bf16 v[132:135], v[224:227], v[36:39], v[132:135]
    ds_read_b64_tr_b16 v[196:197], v89 offset:0
    ds_read_b64_tr_b16 v[198:199], v89 offset:4096
    v_mfma_f32_16x16x32_bf16 v[140:143], v[228:231], v[36:39], v[140:143]
    ds_read_b64_tr_b16 v[200:201], v90 offset:0
    ds_read_b64_tr_b16 v[202:203], v90 offset:4096
    v_mfma_f32_16x16x32_bf16 v[136:139], v[228:231], v[32:35], v[136:139]
    ds_read_b64_tr_b16 v[204:205], v91 offset:0
    ds_read_b64_tr_b16 v[206:207], v91 offset:4096
    s_add_u32 s74, s96, 7168
    buffer_load_dwordx4 v[24:27], v104, s[36:39], s74 offen sc1
    v_mfma_f32_16x16x32_bf16 v[144:147], v[232:235], v[32:35], v[144:147]
    ds_read_b64_tr_b16 v[208:209], v92 offset:0
    ds_read_b64_tr_b16 v[210:211], v92 offset:4096
    v_mfma_f32_16x16x32_bf16 v[148:151], v[232:235], v[36:39], v[148:151]
    ds_read_b64_tr_b16 v[212:213], v93 offset:0
    ds_read_b64_tr_b16 v[214:215], v93 offset:4096
    v_mfma_f32_16x16x32_bf16 v[156:159], v[236:239], v[36:39], v[156:159]
    ds_read_b64_tr_b16 v[216:217], v94 offset:0
    ds_read_b64_tr_b16 v[218:219], v94 offset:4096
    v_mfma_f32_16x16x32_bf16 v[152:155], v[236:239], v[32:35], v[152:155]
    ds_read_b64_tr_b16 v[220:221], v95 offset:0
    ds_read_b64_tr_b16 v[222:223], v95 offset:4096
    buffer_load_dwordx4 v[28:31], v105, s[36:39], s74 offen sc1
    v_mfma_f32_16x16x32_bf16 v[160:163], v[240:243], v[32:35], v[160:163]
    v_mfma_f32_16x16x32_bf16 v[164:167], v[240:243], v[36:39], v[164:167]
    v_mfma_f32_16x16x32_bf16 v[172:175], v[244:247], v[36:39], v[172:175]
    s_add_u32 m0, s101, 0
    s_add_u32 s73, s97, 786432
    buffer_load_dwordx4 v114, s[44:47], s73 offen lds
    v_mfma_f32_16x16x32_bf16 v[168:171], v[244:247], v[32:35], v[168:171]
    v_mfma_f32_16x16x32_bf16 v[176:179], v[248:251], v[32:35], v[176:179]
    v_mfma_f32_16x16x32_bf16 v[180:183], v[248:251], v[36:39], v[180:183]
    s_add_u32 m0, s101, 8192
    s_add_u32 s73, s97, 851968
    buffer_load_dwordx4 v114, s[44:47], s73 offen lds
    v_mfma_f32_16x16x32_bf16 v[188:191], v[252:255], v[36:39], v[188:191]
    v_mfma_f32_16x16x32_bf16 v[184:187], v[252:255], v[32:35], v[184:187]
    s_waitcnt vmcnt(6) lgkmcnt(0)
    s_cmp_eq_u32 s58, 0
    s_cbranch_scc1 P2b8
    s_waitcnt vmcnt(8)
    v_pk_add_f32 v[72:73], v[72:73], v[56:57]
    v_pk_add_f32 v[72:73], v[72:73], v[64:65]
    v_pk_add_f32 v[74:75], v[74:75], v[58:59]
    v_pk_add_f32 v[74:75], v[74:75], v[66:67]
    v_pk_add_f32 v[76:77], v[76:77], v[60:61]
    v_pk_add_f32 v[76:77], v[76:77], v[68:69]
    v_pk_add_f32 v[78:79], v[78:79], v[62:63]
    v_pk_add_f32 v[78:79], v[78:79], v[70:71]
    s_add_u32 s75, s99, 36864
    buffer_load_dwordx4 v[56:59], v113, s[28:31], s75 offen offset:0 sc1
    buffer_load_dwordx4 v[60:63], v113, s[28:31], s75 offen offset:1024 sc1
    s_add_u32 s75, s99, 43008
    buffer_load_dwordx4 v[64:67], v113, s[28:31], s75 offen offset:0 sc1
    buffer_load_dwordx4 v[68:71], v113, s[28:31], s75 offen offset:1024 sc1
P2b8:
    s_cmp_lg_u32 s59, 7
    s_cbranch_scc1 P2_nl8
    buffer_load_dword v111, v123, s[36:39], 0 offen sc1
P2_nl8:
    v_mfma_f32_16x16x32_bf16 v[128:131], v[192:195], v[8:11], v[128:131]
    ds_read_b64_tr_b16 v[224:225], v88 offset:8192
    ds_read_b64_tr_b16 v[226:227], v88 offset:12288
    v_mfma_f32_16x16x32_bf16 v[132:135], v[192:195], v[12:15], v[132:135]
    ds_read_b64_tr_b16 v[228:229], v89 offset:8192
    ds_read_b64_tr_b16 v[230:231], v89 offset:12288
    v_mfma_f32_16x16x32_bf16 v[140:143], v[196:199], v[12:15], v[140:143]
    ds_read_b64_tr_b16 v[232:233], v90 offset:8192
    ds_read_b64_tr_b16 v[234:235], v90 offset:12288
    v_mfma_f32_16x16x32_bf16 v[136:139], v[196:199], v[8:11], v[136:139]
    ds_read_b64_tr_b16 v[236:237], v91 offset:8192
    ds_read_b64_tr_b16 v[238:239], v91 offset:12288
    s_add_u32 s74, s96, 10240
    buffer_load_dwordx4 v[32:35], v104, s[36:39], s74 offen sc1
    v_mfma_f32_16x16x32_bf16 v[144:147], v[200:203], v[8:11], v[144:147]
    ds_read_b64_tr_b16 v[240:241], v92 offset:8192
    ds_read_b64_tr_b16 v[242:243], v92 offset:12288
    v_mfma_f32_16x16x32_bf16 v[148:151], v[200:203], v[12:15], v[148:151]
    ds_read_b64_tr_b16 v[244:245], v93 offset:8192
    ds_read_b64_tr_b16 v[246:247], v93 offset:12288
    v_mfma_f32_16x16x32_bf16 v[156:159], v[204:207], v[12:15], v[156:159]
    ds_read_b64_tr_b16 v[248:249], v94 offset:8192
    ds_read_b64_tr_b16 v[250:251], v94 offset:12288
    v_mfma_f32_16x16x32_bf16 v[152:155], v[204:207], v[8:11], v[152:155]
    ds_read_b64_tr_b16 v[252:253], v95 offset:8192
    ds_read_b64_tr_b16 v[254:255], v95 offset:12288
    buffer_load_dwordx4 v[36:39], v105, s[36:39], s74 offen sc1
    v_mfma_f32_16x16x32_bf16 v[160:163], v[208:211], v[8:11], v[160:163]
    v_mfma_f32_16x16x32_bf16 v[164:167], v[208:211], v[12:15], v[164:167]
    v_mfma_f32_16x16x32_bf16 v[172:175], v[212:215], v[12:15], v[172:175]
    s_add_u32 m0, s101, 16384
    s_add_u32 s73, s97, 917504
    buffer_load_dwordx4 v114, s[44:47], s73 offen lds
    v_mfma_f32_16x16x32_bf16 v[168:171], v[212:215], v[8:11], v[168:171]
    v_mfma_f32_16x16x32_bf16 v[176:179], v[216:219], v[8:11], v[176:179]
    v_mfma_f32_16x16x32_bf16 v[180:183], v[216:219], v[12:15], v[180:183]
    s_add_u32 m0, s101, 24576
    s_add_u32 s73, s97, 983040
    buffer_load_dwordx4 v114, s[44:47], s73 offen lds
    v_mfma_f32_16x16x32_bf16 v[188:191], v[220:223], v[12:15], v[188:191]
    v_mfma_f32_16x16x32_bf16 v[184:187], v[220:223], v[8:11], v[184:187]
    s_cmp_eq_u32 s58, 1
    s_cbranch_scc1 P2_w8
    s_waitcnt vmcnt(8)
P2_w8:
    s_waitcnt vmcnt(12) lgkmcnt(0)
    v_mfma_f32_16x16x32_bf16 v[128:131], v[224:227], v[16:19], v[128:131]
    ds_read_b64_tr_b16 v[192:193], v88 offset:16384
    ds_read_b64_tr_b16 v[194:195], v88 offset:20480
    v_mfma_f32_16x16x32_bf16 v[132:135], v[224:227], v[20:23], v[132:135]
    ds_read_b64_tr_b16 v[196:197], v89 offset:16384
    ds_read_b64_tr_b16 v[198:199], v89 offset:20480
    v_mfma_f32_16x16x32_bf16 v[140:143], v[228:231], v[20:23], v[140:143]
    ds_read_b64_tr_b16 v[200:201], v90 offset:16384
    ds_read_b64_tr_b16 v[202:203], v90 offset:20480
    v_mfma_f32_16x16x32_bf16 v[136:139], v[228:231], v[16:19], v[136:139]
    ds_read_b64_tr_b16 v[204:205], v91 offset:16384
    ds_read_b64_tr_b16 v[206:207], v91 offset:20480
    s_add_u32 s74, s96, 17408
    buffer_load_dwordx4 v[8:11], v104, s[36:39], s74 offen sc1
    v_mfma_f32_16x16x32_bf16 v[144:147], v[232:235], v[16:19], v[144:147]
    ds_read_b64_tr_b16 v[208:209], v92 offset:16384
    ds_read_b64_tr_b16 v[210:211], v92 offset:20480
    v_mfma_f32_16x16x32_bf16 v[148:151], v[232:235], v[20:23], v[148:151]
    ds_read_b64_tr_b16 v[212:213], v93 offset:16384
    ds_read_b64_tr_b16 v[214:215], v93 offset:20480
    v_mfma_f32_16x16x32_bf16 v[156:159], v[236:239], v[20:23], v[156:159]
    ds_read_b64_tr_b16 v[216:217], v94 offset:16384
    ds_read_b64_tr_b16 v[218:219], v94 offset:20480
    v_mfma_f32_16x16x32_bf16 v[152:155], v[236:239], v[16:19], v[152:155]
    ds_read_b64_tr_b16 v[220:221], v95 offset:16384
    ds_read_b64_tr_b16 v[222:223], v95 offset:20480
    buffer_load_dwordx4 v[12:15], v105, s[36:39], s74 offen sc1
    v_mfma_f32_16x16x32_bf16 v[160:163], v[240:243], v[16:19], v[160:163]
    v_mfma_f32_16x16x32_bf16 v[164:167], v[240:243], v[20:23], v[164:167]
    v_mfma_f32_16x16x32_bf16 v[172:175], v[244:247], v[20:23], v[172:175]
    s_add_u32 m0, s101, 32768
    s_add_u32 s73, s97, 1703936
    buffer_load_dwordx4 v114, s[44:47], s73 offen lds
    v_mfma_f32_16x16x32_bf16 v[168:171], v[244:247], v[16:19], v[168:171]
    v_mfma_f32_16x16x32_bf16 v[176:179], v[248:251], v[16:19], v[176:179]
    v_mfma_f32_16x16x32_bf16 v[180:183], v[248:251], v[20:23], v[180:183]
    v_mfma_f32_16x16x32_bf16 v[188:191], v[252:255], v[20:23], v[188:191]
    v_mfma_f32_16x16x32_bf16 v[184:187], v[252:255], v[16:19], v[184:187]
    s_cmp_eq_u32 s58, 1
    s_cbranch_scc1 P2_w9
    s_waitcnt vmcnt(9)
P2_w9:
    s_waitcnt vmcnt(13) lgkmcnt(0)
    s_cmp_eq_u32 s58, 0
    s_cbranch_scc1 P2b10
    s_waitcnt vmcnt(7)
    v_pk_add_f32 v[72:73], v[72:73], v[56:57]
    v_pk_add_f32 v[72:73], v[72:73], v[64:65]
    v_pk_add_f32 v[74:75], v[74:75], v[58:59]
    v_pk_add_f32 v[74:75], v[74:75], v[66:67]
    v_pk_add_f32 v[76:77], v[76:77], v[60:61]
    v_pk_add_f32 v[76:77], v[76:77], v[68:69]
    v_pk_add_f32 v[78:79], v[78:79], v[62:63]
    v_pk_add_f32 v[78:79], v[78:79], v[70:71]
    v_cvt_pk_bf16_f32 v56, v72, v73
    v_cvt_pk_bf16_f32 v57, v74, v75
    v_cvt_pk_bf16_f32 v58, v76, v77
    v_cvt_pk_bf16_f32 v59, v78, v79
    s_lshl_b32 s76, s59, 10
    s_add_u32 s76, s76, 147456
    v_add_u32 v124, s76, v113
    ds_write_b128 v124, v[56:59]
P2b10:
    v_mfma_f32_16x16x32_bf16 v[128:131], v[192:195], v[24:27], v[128:131]
    ds_read_b64_tr_b16 v[224:225], v88 offset:24576
    ds_read_b64_tr_b16 v[226:227], v88 offset:28672
    v_mfma_f32_16x16x32_bf16 v[132:135], v[192:195], v[28:31], v[132:135]
    ds_read_b64_tr_b16 v[228:229], v89 offset:24576
    ds_read_b64_tr_b16 v[230:231], v89 offset:28672
    v_mfma_f32_16x16x32_bf16 v[140:143], v[196:199], v[28:31], v[140:143]
    ds_read_b64_tr_b16 v[232:233], v90 offset:24576
    ds_read_b64_tr_b16 v[234:235], v90 offset:28672
    v_mfma_f32_16x16x32_bf16 v[136:139], v[196:199], v[24:27], v[136:139]
    ds_read_b64_tr_b16 v[236:237], v91 offset:24576
    ds_read_b64_tr_b16 v[238:239], v91 offset:28672
    s_add_u32 s74, s96, 20480
    buffer_load_dwordx4 v[16:19], v104, s[36:39], s74 offen sc1
    v_mfma_f32_16x16x32_bf16 v[144:147], v[200:203], v[24:27], v[144:147]
    ds_read_b64_tr_b16 v[240:241], v92 offset:24576
    ds_read_b64_tr_b16 v[242:243], v92 offset:28672
    v_mfma_f32_16x16x32_bf16 v[148:151], v[200:203], v[28:31], v[148:151]
    ds_read_b64_tr_b16 v[244:245], v93 offset:24576
    ds_read_b64_tr_b16 v[246:247], v93 offset:28672
    v_mfma_f32_16x16x32_bf16 v[156:159], v[204:207], v[28:31], v[156:159]
    ds_read_b64_tr_b16 v[248:249], v94 offset:24576
    ds_read_b64_tr_b16 v[250:251], v94 offset:28672
    v_mfma_f32_16x16x32_bf16 v[152:155], v[204:207], v[24:27], v[152:155]
    ds_read_b64_tr_b16 v[252:253], v95 offset:24576
    ds_read_b64_tr_b16 v[254:255], v95 offset:28672
    buffer_load_dwordx4 v[20:23], v105, s[36:39], s74 offen sc1
    v_mfma_f32_16x16x32_bf16 v[160:163], v[208:211], v[24:27], v[160:163]
    v_mfma_f32_16x16x32_bf16 v[164:167], v[208:211], v[28:31], v[164:167]
    v_mfma_f32_16x16x32_bf16 v[172:175], v[212:215], v[28:31], v[172:175]
    s_add_u32 m0, s101, 40960
    s_add_u32 s73, s97, 1769472
    buffer_load_dwordx4 v114, s[44:47], s73 offen lds
    v_mfma_f32_16x16x32_bf16 v[168:171], v[212:215], v[24:27], v[168:171]
    v_mfma_f32_16x16x32_bf16 v[176:179], v[216:219], v[24:27], v[176:179]
    v_mfma_f32_16x16x32_bf16 v[180:183], v[216:219], v[28:31], v[180:183]
    v_mfma_f32_16x16x32_bf16 v[188:191], v[220:223], v[28:31], v[188:191]
    v_mfma_f32_16x16x32_bf16 v[184:187], v[220:223], v[24:27], v[184:187]
    s_waitcnt vmcnt(8) lgkmcnt(0)
    v_mfma_f32_16x16x32_bf16 v[128:131], v[224:227], v[32:35], v[128:131]
    ds_read_b64_tr_b16 v[192:193], v88 offset:32768
    ds_read_b64_tr_b16 v[194:195], v88 offset:36864
    v_mfma_f32_16x16x32_bf16 v[132:135], v[224:227], v[36:39], v[132:135]
    ds_read_b64_tr_b16 v[196:197], v89 offset:32768
    ds_read_b64_tr_b16 v[198:199], v89 offset:36864
    v_mfma_f32_16x16x32_bf16 v[140:143], v[228:231], v[36:39], v[140:143]
    ds_read_b64_tr_b16 v[200:201], v90 offset:32768
    ds_read_b64_tr_b16 v[202:203], v90 offset:36864
    v_mfma_f32_16x16x32_bf16 v[136:139], v[228:231], v[32:35], v[136:139]
    ds_read_b64_tr_b16 v[204:205], v91 offset:32768
    ds_read_b64_tr_b16 v[206:207], v91 offset:36864
    s_add_u32 s74, s96, 21504
    buffer_load_dwordx4 v[24:27], v104, s[36:39], s74 offen sc1
    v_mfma_f32_16x16x32_bf16 v[144:147], v[232:235], v[32:35], v[144:147]
    ds_read_b64_tr_b16 v[208:209], v92 offset:32768
    ds_read_b64_tr_b16 v[210:211], v92 offset:36864
    v_mfma_f32_16x16x32_bf16 v[148:151], v[232:235], v[36:39], v[148:151]
    ds_read_b64_tr_b16 v[212:213], v93 offset:32768
    ds_read_b64_tr_b16 v[214:215], v93 offset:36864
    v_mfma_f32_16x16x32_bf16 v[156:159], v[236:239], v[36:39], v[156:159]
    ds_read_b64_tr_b16 v[216:217], v94 offset:32768
    ds_read_b64_tr_b16 v[218:219], v94 offset:36864
    v_mfma_f32_16x16x32_bf16 v[152:155], v[236:239], v[32:35], v[152:155]
    ds_read_b64_tr_b16 v[220:221], v95 offset:32768
    ds_read_b64_tr_b16 v[222:223], v95 offset:36864
    buffer_load_dwordx4 v[28:31], v105, s[36:39], s74 offen sc1
    v_mfma_f32_16x16x32_bf16 v[160:163], v[240:243], v[32:35], v[160:163]
    v_mfma_f32_16x16x32_bf16 v[164:167], v[240:243], v[36:39], v[164:167]
    v_mfma_f32_16x16x32_bf16 v[172:175], v[244:247], v[36:39], v[172:175]
    s_add_u32 m0, s101, 49152
    s_add_u32 s73, s97, 131072
    buffer_load_dwordx4 v114, s[44:47], s73 offen lds
    v_mfma_f32_16x16x32_bf16 v[168:171], v[244:247], v[32:35], v[168:171]
    v_mfma_f32_16x16x32_bf16 v[176:179], v[248:251], v[32:35], v[176:179]
    v_mfma_f32_16x16x32_bf16 v[180:183], v[248:251], v[36:39], v[180:183]
    v_mfma_f32_16x16x32_bf16 v[188:191], v[252:255], v[36:39], v[188:191]
    v_mfma_f32_16x16x32_bf16 v[184:187], v[252:255], v[32:35], v[184:187]
    s_cmp_lg_u32 s59, 7
    s_cbranch_scc1 P2_nc11
    s_waitcnt vmcnt(13)
    s_mov_b32 s79, 0
P2c2_c:
    v_cmp_ne_u32 vcc, s83, v111
    s_nop 4
    s_cbranch_vccz P2c2_ok
    s_sleep 4
    buffer_load_dword v111, v123, s[36:39], 0 offen sc1
    s_add_u32 s79, s79, 1
    s_waitcnt vmcnt(0)
    s_cmp_lt_u32 s79, 100000
    s_cbranch_scc1 P2c2_c
P2c2_ok:
P2_nc11:
    s_waitcnt vmcnt(7) lgkmcnt(0)
    s_barrier
    s_cmp_eq_u32 s58, 0
    s_cbranch_scc1 P2b12
    s_mul_i32 s76, s61, 3072
    s_add_u32 s76, s76, 147456
    v_add_u32 v124, s76, v113
    ds_read_b128 v[56:59], v124 offset:0
    ds_read_b128 v[60:63], v124 offset:1024
    ds_read_b128 v[64:67], v124 offset:2048
    s_mul_i32 s99, s57, 7
    s_add_u32 s99, s99, 32
    s_sub_u32 s99, s82, s99
    s_lshl_b32 s99, s99, 10
    s_add_u32 s99, s99, s92
P2b12:
    v_mfma_f32_16x16x32_bf16 v[128:131], v[192:195], v[8:11], v[128:131]
    ds_read_b64_tr_b16 v[224:225], v88 offset:40960
    ds_read_b64_tr_b16 v[226:227], v88 offset:45056
    v_mfma_f32_16x16x32_bf16 v[132:135], v[192:195], v[12:15], v[132:135]
    ds_read_b64_tr_b16 v[228:229], v89 offset:40960
    ds_read_b64_tr_b16 v[230:231], v89 offset:45056
    v_mfma_f32_16x16x32_bf16 v[140:143], v[196:199], v[12:15], v[140:143]
    ds_read_b64_tr_b16 v[232:233], v90 offset:40960
    ds_read_b64_tr_b16 v[234:235], v90 offset:45056
    v_mfma_f32_16x16x32_bf16 v[136:139], v[196:199], v[8:11], v[136:139]
    ds_read_b64_tr_b16 v[236:237], v91 offset:40960
    ds_read_b64_tr_b16 v[238:239], v91 offset:45056
    s_add_u32 s74, s96, 24576
    buffer_load_dwordx4 v[32:35], v104, s[36:39], s74 offen sc1
    v_mfma_f32_16x16x32_bf16 v[144:147], v[200:203], v[8:11], v[144:147]
    ds_read_b64_tr_b16 v[240:241], v92 offset:40960
    ds_read_b64_tr_b16 v[242:243], v92 offset:45056
    v_mfma_f32_16x16x32_bf16 v[148:151], v[200:203], v[12:15], v[148:151]
    ds_read_b64_tr_b16 v[244:245], v93 offset:40960
    ds_read_b64_tr_b16 v[246:247], v93 offset:45056
    v_mfma_f32_16x16x32_bf16 v[156:159], v[204:207], v[12:15], v[156:159]
    ds_read_b64_tr_b16 v[248:249], v94 offset:40960
    ds_read_b64_tr_b16 v[250:251], v94 offset:45056
    v_mfma_f32_16x16x32_bf16 v[152:155], v[204:207], v[8:11], v[152:155]
    ds_read_b64_tr_b16 v[252:253], v95 offset:40960
    ds_read_b64_tr_b16 v[254:255], v95 offset:45056
    buffer_load_dwordx4 v[36:39], v105, s[36:39], s74 offen sc1
    v_mfma_f32_16x16x32_bf16 v[160:163], v[208:211], v[8:11], v[160:163]
    v_mfma_f32_16x16x32_bf16 v[164:167], v[208:211], v[12:15], v[164:167]
    v_mfma_f32_16x16x32_bf16 v[172:175], v[212:215], v[12:15], v[172:175]
    s_add_u32 m0, s101, 57344
    s_add_u32 s73, s97, 720896
    buffer_load_dwordx4 v114, s[44:47], s73 offen lds
    v_mfma_f32_16x16x32_bf16 v[168:171], v[212:215], v[8:11], v[168:171]
    v_mfma_f32_16x16x32_bf16 v[176:179], v[216:219], v[8:11], v[176:179]
    v_mfma_f32_16x16x32_bf16 v[180:183], v[216:219], v[12:15], v[180:183]
    v_mfma_f32_16x16x32_bf16 v[188:191], v[220:223], v[12:15], v[188:191]
    v_mfma_f32_16x16x32_bf16 v[184:187], v[220:223], v[8:11], v[184:187]
    s_waitcnt vmcnt(7) lgkmcnt(0)
    s_cmp_eq_u32 s58, 0
    s_cbranch_scc1 P2b13
    v_mfma_f32_16x16x32_bf16 v[76:79], v[64:67], v[40:43], 0
    v_mfma_f32_16x16x32_bf16 v[68:71], v[56:59], v[40:43], 0
    v_mfma_f32_16x16x32_bf16 v[72:75], v[60:63], v[40:43], 0
    s_nop 5
    v_add_f32 v76, s86, v76
    v_rcp_f32 v76, v76
    s_nop 0
    v_pk_mul_f32 v[68:69], v[68:69], v[76:77] op_sel_hi:[1,0]
    v_pk_mul_f32 v[70:71], v[70:71], v[76:77] op_sel_hi:[1,0]
    v_cvt_pk_bf16_f32 v116, v68, v69
    v_cvt_pk_bf16_f32 v117, v70, v71
    v_pk_mul_f32 v[72:73], v[72:73], v[76:77] op_sel_hi:[1,0]
    v_pk_mul_f32 v[74:75], v[74:75], v[76:77] op_sel_hi:[1,0]
    v_cvt_pk_bf16_f32 v118, v72, v73
    v_cvt_pk_bf16_f32 v119, v74, v75
    buffer_store_dwordx4 v[116:119], v113, s[36:39], s99 offen sc1
    s_add_u32 s99, s99, 147456
P2b13:
    v_mfma_f32_16x16x32_bf16 v[128:131], v[224:227], v[16:19], v[128:131]
    ds_read_b64_tr_b16 v[192:193], v88 offset:49152
    ds_read_b64_tr_b16 v[194:195], v88 offset:53248
    v_mfma_f32_16x16x32_bf16 v[132:135], v[224:227], v[20:23], v[132:135]
    ds_read_b64_tr_b16 v[196:197], v89 offset:49152
    ds_read_b64_tr_b16 v[198:199], v89 offset:53248
    v_mfma_f32_16x16x32_bf16 v[140:143], v[228:231], v[20:23], v[140:143]
    ds_read_b64_tr_b16 v[200:201], v90 offset:49152
    ds_read_b64_tr_b16 v[202:203], v90 offset:53248
    v_mfma_f32_16x16x32_bf16 v[136:139], v[228:231], v[16:19], v[136:139]
    ds_read_b64_tr_b16 v[204:205], v91 offset:49152
    ds_read_b64_tr_b16 v[206:207], v91 offset:53248
    s_add_u32 s74, s96, 0
    buffer_load_dwordx4 v[8:11], v104, s[36:39], s74 offen sc1
    v_mfma_f32_16x16x32_bf16 v[144:147], v[232:235], v[16:19], v[144:147]
    ds_read_b64_tr_b16 v[208:209], v92 offset:49152
    ds_read_b64_tr_b16 v[210:211], v92 offset:53248
    v_mfma_f32_16x16x32_bf16 v[148:151], v[232:235], v[20:23], v[148:151]
    ds_read_b64_tr_b16 v[212:213], v93 offset:49152
    ds_read_b64_tr_b16 v[214:215], v93 offset:53248
    v_mfma_f32_16x16x32_bf16 v[156:159], v[236:239], v[20:23], v[156:159]
    ds_read_b64_tr_b16 v[216:217], v94 offset:49152
    ds_read_b64_tr_b16 v[218:219], v94 offset:53248
    v_mfma_f32_16x16x32_bf16 v[152:155], v[236:239], v[16:19], v[152:155]
    ds_read_b64_tr_b16 v[220:221], v95 offset:49152
    ds_read_b64_tr_b16 v[222:223], v95 offset:53248
    buffer_load_dwordx4 v[12:15], v105, s[36:39], s74 offen sc1
    v_mfma_f32_16x16x32_bf16 v[160:163], v[240:243], v[16:19], v[160:163]
    v_mfma_f32_16x16x32_bf16 v[164:167], v[240:243], v[20:23], v[164:167]
    v_mfma_f32_16x16x32_bf16 v[172:175], v[244:247], v[20:23], v[172:175]
    s_add_u32 m0, s101, 65536
    s_add_u32 s73, s97, 1048576
    buffer_load_dwordx4 v114, s[44:47], s73 offen lds
    v_mfma_f32_16x16x32_bf16 v[168:171], v[244:247], v[16:19], v[168:171]
    v_mfma_f32_16x16x32_bf16 v[176:179], v[248:251], v[16:19], v[176:179]
    v_mfma_f32_16x16x32_bf16 v[180:183], v[248:251], v[20:23], v[180:183]
    v_mfma_f32_16x16x32_bf16 v[188:191], v[252:255], v[20:23], v[188:191]
    v_mfma_f32_16x16x32_bf16 v[184:187], v[252:255], v[16:19], v[184:187]
    s_cmp_eq_u32 s58, 1
    s_cbranch_scc1 P2_w13
    s_waitcnt vmcnt(7)
P2_w13:
    s_waitcnt vmcnt(8) lgkmcnt(0)
    s_cmp_eq_u32 s58, 0
    s_cbranch_scc1 P2b14
    v_mfma_f32_16x16x32_bf16 v[76:79], v[64:67], v[44:47], 0
    v_mfma_f32_16x16x32_bf16 v[68:71], v[56:59], v[44:47], 0
    v_mfma_f32_16x16x32_bf16 v[72:75], v[60:63], v[44:47], 0
    s_nop 5
    v_add_f32 v76, s86, v76
    v_rcp_f32 v76, v76
    s_nop 0
    v_pk_mul_f32 v[68:69], v[68:69], v[76:77] op_sel_hi:[1,0]
    v_pk_mul_f32 v[70:71], v[70:71], v[76:77] op_sel_hi:[1,0]
    v_cvt_pk_bf16_f32 v116, v68, v69
    v_cvt_pk_bf16_f32 v117, v70, v71
    v_pk_mul_f32 v[72:73], v[72:73], v[76:77] op_sel_hi:[1,0]
    v_pk_mul_f32 v[74:75], v[74:75], v[76:77] op_sel_hi:[1,0]
    v_cvt_pk_bf16_f32 v118, v72, v73
    v_cvt_pk_bf16_f32 v119, v74, v75
    buffer_store_dwordx4 v[116:119], v113, s[36:39], s99 offen sc1
    s_add_u32 s99, s99, 147456
P2b14:
    v_mfma_f32_16x16x32_bf16 v[128:131], v[192:195], v[24:27], v[128:131]
    ds_read_b64_tr_b16 v[224:225], v88 offset:57344
    ds_read_b64_tr_b16 v[226:227], v88 offset:61440
    v_mfma_f32_16x16x32_bf16 v[132:135], v[192:195], v[28:31], v[132:135]
    ds_read_b64_tr_b16 v[228:229], v89 offset:57344
    ds_read_b64_tr_b16 v[230:231], v89 offset:61440
    v_mfma_f32_16x16x32_bf16 v[140:143], v[196:199], v[28:31], v[140:143]
    ds_read_b64_tr_b16 v[232:233], v90 offset:57344
    ds_read_b64_tr_b16 v[234:235], v90 offset:61440
    v_mfma_f32_16x16x32_bf16 v[136:139], v[196:199], v[24:27], v[136:139]
    ds_read_b64_tr_b16 v[236:237], v91 offset:57344
    ds_read_b64_tr_b16 v[238:239], v91 offset:61440
    s_add_u32 s74, s96, 1024
    buffer_load_dwordx4 v[16:19], v104, s[36:39], s74 offen sc1
    v_mfma_f32_16x16x32_bf16 v[144:147], v[200:203], v[24:27], v[144:147]
    ds_read_b64_tr_b16 v[240:241], v92 offset:57344
    ds_read_b64_tr_b16 v[242:243], v92 offset:61440
    v_mfma_f32_16x16x32_bf16 v[148:151], v[200:203], v[28:31], v[148:151]
    ds_read_b64_tr_b16 v[244:245], v93 offset:57344
    ds_read_b64_tr_b16 v[246:247], v93 offset:61440
    v_mfma_f32_16x16x32_bf16 v[156:159], v[204:207], v[28:31], v[156:159]
    ds_read_b64_tr_b16 v[248:249], v94 offset:57344
    ds_read_b64_tr_b16 v[250:251], v94 offset:61440
    v_mfma_f32_16x16x32_bf16 v[152:155], v[204:207], v[24:27], v[152:155]
    ds_read_b64_tr_b16 v[252:253], v95 offset:57344
    ds_read_b64_tr_b16 v[254:255], v95 offset:61440
    buffer_load_dwordx4 v[20:23], v105, s[36:39], s74 offen sc1
    v_mfma_f32_16x16x32_bf16 v[160:163], v[208:211], v[24:27], v[160:163]
    v_mfma_f32_16x16x32_bf16 v[164:167], v[208:211], v[28:31], v[164:167]
    v_mfma_f32_16x16x32_bf16 v[172:175], v[212:215], v[28:31], v[172:175]
    s_add_u32 m0, s101, 73728
    s_add_u32 s73, s97, 1638400
    buffer_load_dwordx4 v114, s[44:47], s73 offen lds
    v_mfma_f32_16x16x32_bf16 v[168:171], v[212:215], v[24:27], v[168:171]
    v_mfma_f32_16x16x32_bf16 v[176:179], v[216:219], v[24:27], v[176:179]
    v_mfma_f32_16x16x32_bf16 v[180:183], v[216:219], v[28:31], v[180:183]
    v_mfma_f32_16x16x32_bf16 v[188:191], v[220:223], v[28:31], v[188:191]
    v_mfma_f32_16x16x32_bf16 v[184:187], v[220:223], v[24:27], v[184:187]
    s_cmp_eq_u32 s58, 1
    s_cbranch_scc1 P2_w14
    s_waitcnt vmcnt(7)
P2_w14:
    s_waitcnt vmcnt(9) lgkmcnt(0)
    s_cmp_eq_u32 s58, 0
    s_cbranch_scc1 P2b15
    v_mfma_f32_16x16x32_bf16 v[76:79], v[64:67], v[48:51], 0
    v_mfma_f32_16x16x32_bf16 v[68:71], v[56:59], v[48:51], 0
    v_mfma_f32_16x16x32_bf16 v[72:75], v[60:63], v[48:51], 0
    s_nop 5
    v_add_f32 v76, s86, v76
    v_rcp_f32 v76, v76
    s_nop 0
    v_pk_mul_f32 v[68:69], v[68:69], v[76:77] op_sel_hi:[1,0]
    v_pk_mul_f32 v[70:71], v[70:71], v[76:77] op_sel_hi:[1,0]
    v_cvt_pk_bf16_f32 v116, v68, v69
    v_cvt_pk_bf16_f32 v117, v70, v71
    v_pk_mul_f32 v[72:73], v[72:73], v[76:77] op_sel_hi:[1,0]
    v_pk_mul_f32 v[74:75], v[74:75], v[76:77] op_sel_hi:[1,0]
    v_cvt_pk_bf16_f32 v118, v72, v73
    v_cvt_pk_bf16_f32 v119, v74, v75
    buffer_store_dwordx4 v[116:119], v113, s[36:39], s99 offen sc1
    s_add_u32 s99, s99, 147456
P2b15:
    v_mfma_f32_16x16x32_bf16 v[128:131], v[224:227], v[32:35], v[128:131]
    ds_read_b64_tr_b16 v[192:193], v96 offset:0
    ds_read_b64_tr_b16 v[194:195], v96 offset:4096
    v_mfma_f32_16x16x32_bf16 v[132:135], v[224:227], v[36:39], v[132:135]
    ds_read_b64_tr_b16 v[196:197], v97 offset:0
    ds_read_b64_tr_b16 v[198:199], v97 offset:4096
    v_mfma_f32_16x16x32_bf16 v[140:143], v[228:231], v[36:39], v[140:143]
    ds_read_b64_tr_b16 v[200:201], v98 offset:0
    ds_read_b64_tr_b16 v[202:203], v98 offset:4096
    v_mfma_f32_16x16x32_bf16 v[136:139], v[228:231], v[32:35], v[136:139]
    ds_read_b64_tr_b16 v[204:205], v99 offset:0
    ds_read_b64_tr_b16 v[206:207], v99 offset:4096
    s_add_u32 s74, s96, 12288
    buffer_load_dwordx4 v[24:27], v104, s[36:39], s74 offen sc1
    v_mfma_f32_16x16x32_bf16 v[144:147], v[232:235], v[32:35], v[144:147]
    ds_read_b64_tr_b16 v[208:209], v100 offset:0
    ds_read_b64_tr_b16 v[210:211], v100 offset:4096
    v_mfma_f32_16x16x32_bf16 v[148:151], v[232:235], v[36:39], v[148:151]
    ds_read_b64_tr_b16 v[212:213], v101 offset:0
    ds_read_b64_tr_b16 v[214:215], v101 offset:4096
    v_mfma_f32_16x16x32_bf16 v[156:159], v[236:239], v[36:39], v[156:159]
    ds_read_b64_tr_b16 v[216:217], v102 offset:0
    ds_read_b64_tr_b16 v[218:219], v102 offset:4096
    v_mfma_f32_16x16x32_bf16 v[152:155], v[236:239], v[32:35], v[152:155]
    ds_read_b64_tr_b16 v[220:221], v103 offset:0
    ds_read_b64_tr_b16 v[222:223], v103 offset:4096
    buffer_load_dwordx4 v[28:31], v105, s[36:39], s74 offen sc1
    v_mfma_f32_16x16x32_bf16 v[160:163], v[240:243], v[32:35], v[160:163]
    v_mfma_f32_16x16x32_bf16 v[164:167], v[240:243], v[36:39], v[164:167]
    v_mfma_f32_16x16x32_bf16 v[172:175], v[244:247], v[36:39], v[172:175]
    s_add_u32 m0, s101, 81920
    s_add_u32 s73, s19, 0
    buffer_load_dwordx4 v114, s[88:91], s73 offen lds
    v_mfma_f32_16x16x32_bf16 v[168:171], v[244:247], v[32:35], v[168:171]
    v_mfma_f32_16x16x32_bf16 v[176:179], v[248:251], v[32:35], v[176:179]
    v_mfma_f32_16x16x32_bf16 v[180:183], v[248:251], v[36:39], v[180:183]
    v_mfma_f32_16x16x32_bf16 v[188:191], v[252:255], v[36:39], v[188:191]
    v_mfma_f32_16x16x32_bf16 v[184:187], v[252:255], v[32:35], v[184:187]
    s_cmp_eq_u32 s58, 1
    s_cbranch_scc1 P2_w15
    s_waitcnt vmcnt(7)
P2_w15:
    s_waitcnt vmcnt(9) lgkmcnt(0)
    s_cmp_eq_u32 s58, 0
    s_cbranch_scc1 P2b16
    v_mfma_f32_16x16x32_bf16 v[76:79], v[64:67], v[52:55], 0
    v_mfma_f32_16x16x32_bf16 v[68:71], v[56:59], v[52:55], 0
    v_mfma_f32_16x16x32_bf16 v[72:75], v[60:63], v[52:55], 0
    s_nop 5
    v_add_f32 v76, s86, v76
    v_rcp_f32 v76, v76
    s_nop 0
    v_pk_mul_f32 v[68:69], v[68:69], v[76:77] op_sel_hi:[1,0]
    v_pk_mul_f32 v[70:71], v[70:71], v[76:77] op_sel_hi:[1,0]
    v_cvt_pk_bf16_f32 v116, v68, v69
    v_cvt_pk_bf16_f32 v117, v70, v71
    v_pk_mul_f32 v[72:73], v[72:73], v[76:77] op_sel_hi:[1,0]
    v_pk_mul_f32 v[74:75], v[74:75], v[76:77] op_sel_hi:[1,0]
    v_cvt_pk_bf16_f32 v118, v72, v73
    v_cvt_pk_bf16_f32 v119, v74, v75
    buffer_store_dwordx4 v[116:119], v113, s[36:39], s99 offen sc1
    s_add_u32 s99, s99, 147456
P2b16:
    v_mfma_f32_16x16x32_bf16 v[128:131], v[192:195], v[8:11], v[128:131]
    ds_read_b64_tr_b16 v[224:225], v96 offset:8192
    ds_read_b64_tr_b16 v[226:227], v96 offset:12288
    v_mfma_f32_16x16x32_bf16 v[132:135], v[192:195], v[12:15], v[132:135]
    ds_read_b64_tr_b16 v[228:229], v97 offset:8192
    ds_read_b64_tr_b16 v[230:231], v97 offset:12288
    v_mfma_f32_16x16x32_bf16 v[140:143], v[196:199], v[12:15], v[140:143]
    ds_read_b64_tr_b16 v[232:233], v98 offset:8192
    ds_read_b64_tr_b16 v[234:235], v98 offset:12288
    v_mfma_f32_16x16x32_bf16 v[136:139], v[196:199], v[8:11], v[136:139]
    ds_read_b64_tr_b16 v[236:237], v99 offset:8192
    ds_read_b64_tr_b16 v[238:239], v99 offset:12288
    s_add_u32 s74, s96, 13312
    buffer_load_dwordx4 v[32:35], v104, s[36:39], s74 offen sc1
    v_mfma_f32_16x16x32_bf16 v[144:147], v[200:203], v[8:11], v[144:147]
    ds_read_b64_tr_b16 v[240:241], v100 offset:8192
    ds_read_b64_tr_b16 v[242:243], v100 offset:12288
    v_mfma_f32_16x16x32_bf16 v[148:151], v[200:203], v[12:15], v[148:151]
    ds_read_b64_tr_b16 v[244:245], v101 offset:8192
    ds_read_b64_tr_b16 v[246:247], v101 offset:12288
    v_mfma_f32_16x16x32_bf16 v[156:159], v[204:207], v[12:15], v[156:159]
    ds_read_b64_tr_b16 v[248:249], v102 offset:8192
    ds_read_b64_tr_b16 v[250:251], v102 offset:12288
    v_mfma_f32_16x16x32_bf16 v[152:155], v[204:207], v[8:11], v[152:155]
    ds_read_b64_tr_b16 v[252:253], v103 offset:8192
    ds_read_b64_tr_b16 v[254:255], v103 offset:12288
    buffer_load_dwordx4 v[36:39], v105, s[36:39], s74 offen sc1
    v_mfma_f32_16x16x32_bf16 v[160:163], v[208:211], v[8:11], v[160:163]
    v_mfma_f32_16x16x32_bf16 v[164:167], v[208:211], v[12:15], v[164:167]
    v_mfma_f32_16x16x32_bf16 v[172:175], v[212:215], v[12:15], v[172:175]
    s_add_u32 m0, s101, 90112
    s_add_u32 s73, s19, 65536
    buffer_load_dwordx4 v114, s[88:91], s73 offen lds
    v_mfma_f32_16x16x32_bf16 v[168:171], v[212:215], v[8:11], v[168:171]
    v_mfma_f32_16x16x32_bf16 v[176:179], v[216:219], v[8:11], v[176:179]
    v_mfma_f32_16x16x32_bf16 v[180:183], v[216:219], v[12:15], v[180:183]
    v_mfma_f32_16x16x32_bf16 v[188:191], v[220:223], v[12:15], v[188:191]
    v_mfma_f32_16x16x32_bf16 v[184:187], v[220:223], v[8:11], v[184:187]
    s_cmp_eq_u32 s58, 1
    s_cbranch_scc1 P2_w16
    s_waitcnt vmcnt(7)
P2_w16:
    s_waitcnt vmcnt(9) lgkmcnt(0)
    v_mfma_f32_16x16x32_bf16 v[128:131], v[224:227], v[16:19], v[128:131]
    ds_read_b64_tr_b16 v[192:193], v80 offset:0
    ds_read_b64_tr_b16 v[194:195], v80 offset:4096
    v_mfma_f32_16x16x32_bf16 v[132:135], v[224:227], v[20:23], v[132:135]
    ds_read_b64_tr_b16 v[196:197], v81 offset:0
    ds_read_b64_tr_b16 v[198:199], v81 offset:4096
    v_mfma_f32_16x16x32_bf16 v[140:143], v[228:231], v[20:23], v[140:143]
    ds_read_b64_tr_b16 v[200:201], v82 offset:0
    ds_read_b64_tr_b16 v[202:203], v82 offset:4096
    v_mfma_f32_16x16x32_bf16 v[136:139], v[228:231], v[16:19], v[136:139]
    ds_read_b64_tr_b16 v[204:205], v83 offset:0
    ds_read_b64_tr_b16 v[206:207], v83 offset:4096
    s_add_u32 s74, s96, 14336
    buffer_load_dwordx4 v[8:11], v104, s[36:39], s74 offen sc1
    v_mfma_f32_16x16x32_bf16 v[144:147], v[232:235], v[16:19], v[144:147]
    ds_read_b64_tr_b16 v[208:209], v84 offset:0
    ds_read_b64_tr_b16 v[210:211], v84 offset:4096
    v_mfma_f32_16x16x32_bf16 v[148:151], v[232:235], v[20:23], v[148:151]
    ds_read_b64_tr_b16 v[212:213], v85 offset:0
    ds_read_b64_tr_b16 v[214:215], v85 offset:4096
    v_mfma_f32_16x16x32_bf16 v[156:159], v[236:239], v[20:23], v[156:159]
    ds_read_b64_tr_b16 v[216:217], v86 offset:0
    ds_read_b64_tr_b16 v[218:219], v86 offset:4096
    v_mfma_f32_16x16x32_bf16 v[152:155], v[236:239], v[16:19], v[152:155]
    ds_read_b64_tr_b16 v[220:221], v87 offset:0
    ds_read_b64_tr_b16 v[222:223], v87 offset:4096
    buffer_load_dwordx4 v[12:15], v105, s[36:39], s74 offen sc1
    v_mfma_f32_16x16x32_bf16 v[160:163], v[240:243], v[16:19], v[160:163]
    v_mfma_f32_16x16x32_bf16 v[164:167], v[240:243], v[20:23], v[164:167]
    v_mfma_f32_16x16x32_bf16 v[172:175], v[244:247], v[20:23], v[172:175]
    s_add_u32 m0, s101, 98304
    s_add_u32 s73, s19, 131072
    buffer_load_dwordx4 v114, s[88:91], s73 offen lds
    v_mfma_f32_16x16x32_bf16 v[168:171], v[244:247], v[16:19], v[168:171]
    v_mfma_f32_16x16x32_bf16 v[176:179], v[248:251], v[16:19], v[176:179]
    v_mfma_f32_16x16x32_bf16 v[180:183], v[248:251], v[20:23], v[180:183]
    v_mfma_f32_16x16x32_bf16 v[188:191], v[252:255], v[20:23], v[188:191]
    v_mfma_f32_16x16x32_bf16 v[184:187], v[252:255], v[16:19], v[184:187]
    s_cmp_eq_u32 s58, 0
    s_cbranch_scc1 P2_w17
    s_waitcnt vmcnt(6)
P2_w17:
    s_waitcnt vmcnt(7) lgkmcnt(0)
    s_barrier
    s_lshl_b32 s73, s59, 1
    s_or_b32 s73, s73, s58
    s_cmp_eq_u32 s73, 13
    s_cbranch_scc0 P2b18
    buffer_store_dword v110, off, s[36:39], s100 offset:4 sc1
P2b18:
    v_mfma_f32_16x16x32_bf16 v[128:131], v[192:195], v[24:27], v[128:131]
    ds_read_b64_tr_b16 v[224:225], v80 offset:8192
    ds_read_b64_tr_b16 v[226:227], v80 offset:12288
    v_mfma_f32_16x16x32_bf16 v[132:135], v[192:195], v[28:31], v[132:135]
    ds_read_b64_tr_b16 v[228:229], v81 offset:8192
    ds_read_b64_tr_b16 v[230:231], v81 offset:12288
    v_mfma_f32_16x16x32_bf16 v[140:143], v[196:199], v[28:31], v[140:143]
    ds_read_b64_tr_b16 v[232:233], v82 offset:8192
    ds_read_b64_tr_b16 v[234:235], v82 offset:12288
    v_mfma_f32_16x16x32_bf16 v[136:139], v[196:199], v[24:27], v[136:139]
    ds_read_b64_tr_b16 v[236:237], v83 offset:8192
    ds_read_b64_tr_b16 v[238:239], v83 offset:12288
    s_add_u32 s74, s96, 15360
    buffer_load_dwordx4 v[16:19], v104, s[36:39], s74 offen sc1
    v_mfma_f32_16x16x32_bf16 v[144:147], v[200:203], v[24:27], v[144:147]
    ds_read_b64_tr_b16 v[240:241], v84 offset:8192
    ds_read_b64_tr_b16 v[242:243], v84 offset:12288
    v_mfma_f32_16x16x32_bf16 v[148:151], v[200:203], v[28:31], v[148:151]
    ds_read_b64_tr_b16 v[244:245], v85 offset:8192
    ds_read_b64_tr_b16 v[246:247], v85 offset:12288
    v_mfma_f32_16x16x32_bf16 v[156:159], v[204:207], v[28:31], v[156:159]
    ds_read_b64_tr_b16 v[248:249], v86 offset:8192
    ds_read_b64_tr_b16 v[250:251], v86 offset:12288
    v_mfma_f32_16x16x32_bf16 v[152:155], v[204:207], v[24:27], v[152:155]
    ds_read_b64_tr_b16 v[252:253], v87 offset:8192
    ds_read_b64_tr_b16 v[254:255], v87 offset:12288
    buffer_load_dwordx4 v[20:23], v105, s[36:39], s74 offen sc1
    v_mfma_f32_16x16x32_bf16 v[160:163], v[208:211], v[24:27], v[160:163]
    v_mfma_f32_16x16x32_bf16 v[164:167], v[208:211], v[28:31], v[164:167]
    v_mfma_f32_16x16x32_bf16 v[172:175], v[212:215], v[28:31], v[172:175]
    s_add_u32 m0, s101, 106496
    s_add_u32 s73, s19, 196608
    buffer_load_dwordx4 v114, s[88:91], s73 offen lds
    v_mfma_f32_16x16x32_bf16 v[168:171], v[212:215], v[24:27], v[168:171]
    v_mfma_f32_16x16x32_bf16 v[176:179], v[216:219], v[24:27], v[176:179]
    v_mfma_f32_16x16x32_bf16 v[180:183], v[216:219], v[28:31], v[180:183]
    v_mfma_f32_16x16x32_bf16 v[188:191], v[220:223], v[28:31], v[188:191]
    v_mfma_f32_16x16x32_bf16 v[184:187], v[220:223], v[24:27], v[184:187]
    s_waitcnt vmcnt(7) lgkmcnt(0)
    v_mfma_f32_16x16x32_bf16 v[128:131], v[224:227], v[32:35], v[128:131]
    ds_read_b64_tr_b16 v[192:193], v80 offset:16384
    ds_read_b64_tr_b16 v[194:195], v80 offset:20480
    v_mfma_f32_16x16x32_bf16 v[132:135], v[224:227], v[36:39], v[132:135]
    ds_read_b64_tr_b16 v[196:197], v81 offset:16384
    ds_read_b64_tr_b16 v[198:199], v81 offset:20480
    v_mfma_f32_16x16x32_bf16 v[140:143], v[228:231], v[36:39], v[140:143]
    ds_read_b64_tr_b16 v[200:201], v82 offset:16384
    ds_read_b64_tr_b16 v[202:203], v82 offset:20480
    v_mfma_f32_16x16x32_bf16 v[136:139], v[228:231], v[32:35], v[136:139]
    ds_read_b64_tr_b16 v[204:205], v83 offset:16384
    ds_read_b64_tr_b16 v[206:207], v83 offset:20480
    s_add_u32 s74, s96, 26624
    buffer_load_dwordx4 v[24:27], v104, s[36:39], s74 offen sc1
    v_mfma_f32_16x16x32_bf16 v[144:147], v[232:235], v[32:35], v[144:147]
    ds_read_b64_tr_b16 v[208:209], v84 offset:16384
    ds_read_b64_tr_b16 v[210:211], v84 offset:20480
    v_mfma_f32_16x16x32_bf16 v[148:151], v[232:235], v[36:39], v[148:151]
    ds_read_b64_tr_b16 v[212:213], v85 offset:16384
    ds_read_b64_tr_b16 v[214:215], v85 offset:20480
    v_mfma_f32_16x16x32_bf16 v[156:159], v[236:239], v[36:39], v[156:159]
    ds_read_b64_tr_b16 v[216:217], v86 offset:16384
    ds_read_b64_tr_b16 v[218:219], v86 offset:20480
    v_mfma_f32_16x16x32_bf16 v[152:155], v[236:239], v[32:35], v[152:155]
    ds_read_b64_tr_b16 v[220:221], v87 offset:16384
    ds_read_b64_tr_b16 v[222:223], v87 offset:20480
    buffer_load_dwordx4 v[28:31], v105, s[36:39], s74 offen sc1
    v_mfma_f32_16x16x32_bf16 v[160:163], v[240:243], v[32:35], v[160:163]
    v_mfma_f32_16x16x32_bf16 v[164:167], v[240:243], v[36:39], v[164:167]
    v_mfma_f32_16x16x32_bf16 v[172:175], v[244:247], v[36:39], v[172:175]
    s_add_u32 m0, s101, 114688
    s_add_u32 s73, s19, 262144
    buffer_load_dwordx4 v114, s[88:91], s73 offen lds
    v_mfma_f32_16x16x32_bf16 v[168:171], v[244:247], v[32:35], v[168:171]
    v_mfma_f32_16x16x32_bf16 v[176:179], v[248:251], v[32:35], v[176:179]
    v_mfma_f32_16x16x32_bf16 v[180:183], v[248:251], v[36:39], v[180:183]
    v_mfma_f32_16x16x32_bf16 v[188:191], v[252:255], v[36:39], v[188:191]
    v_mfma_f32_16x16x32_bf16 v[184:187], v[252:255], v[32:35], v[184:187]
    s_waitcnt vmcnt(7) lgkmcnt(0)
    v_mfma_f32_16x16x32_bf16 v[128:131], v[192:195], v[8:11], v[128:131]
    ds_read_b64_tr_b16 v[224:225], v80 offset:24576
    ds_read_b64_tr_b16 v[226:227], v80 offset:28672
    v_mfma_f32_16x16x32_bf16 v[132:135], v[192:195], v[12:15], v[132:135]
    ds_read_b64_tr_b16 v[228:229], v81 offset:24576
    ds_read_b64_tr_b16 v[230:231], v81 offset:28672
    v_mfma_f32_16x16x32_bf16 v[140:143], v[196:199], v[12:15], v[140:143]
    ds_read_b64_tr_b16 v[232:233], v82 offset:24576
    ds_read_b64_tr_b16 v[234:235], v82 offset:28672
    v_mfma_f32_16x16x32_bf16 v[136:139], v[196:199], v[8:11], v[136:139]
    ds_read_b64_tr_b16 v[236:237], v83 offset:24576
    ds_read_b64_tr_b16 v[238:239], v83 offset:28672
    s_add_u32 s74, s96, 27648
    buffer_load_dwordx4 v[32:35], v104, s[36:39], s74 offen sc1
    v_mfma_f32_16x16x32_bf16 v[144:147], v[200:203], v[8:11], v[144:147]
    ds_read_b64_tr_b16 v[240:241], v84 offset:24576
    ds_read_b64_tr_b16 v[242:243], v84 offset:28672
    v_mfma_f32_16x16x32_bf16 v[148:151], v[200:203], v[12:15], v[148:151]
    ds_read_b64_tr_b16 v[244:245], v85 offset:24576
    ds_read_b64_tr_b16 v[246:247], v85 offset:28672
    v_mfma_f32_16x16x32_bf16 v[156:159], v[204:207], v[12:15], v[156:159]
    ds_read_b64_tr_b16 v[248:249], v86 offset:24576
    ds_read_b64_tr_b16 v[250:251], v86 offset:28672
    v_mfma_f32_16x16x32_bf16 v[152:155], v[204:207], v[8:11], v[152:155]
    ds_read_b64_tr_b16 v[252:253], v87 offset:24576
    ds_read_b64_tr_b16 v[254:255], v87 offset:28672
    buffer_load_dwordx4 v[36:39], v105, s[36:39], s74 offen sc1
    v_mfma_f32_16x16x32_bf16 v[160:163], v[208:211], v[8:11], v[160:163]
    v_mfma_f32_16x16x32_bf16 v[164:167], v[208:211], v[12:15], v[164:167]
    v_mfma_f32_16x16x32_bf16 v[172:175], v[212:215], v[12:15], v[172:175]
    s_add_u32 m0, s101, 122880
    s_add_u32 s73, s19, 327680
    buffer_load_dwordx4 v114, s[88:91], s73 offen lds
    v_mfma_f32_16x16x32_bf16 v[168:171], v[212:215], v[8:11], v[168:171]
    v_mfma_f32_16x16x32_bf16 v[176:179], v[216:219], v[8:11], v[176:179]
    v_mfma_f32_16x16x32_bf16 v[180:183], v[216:219], v[12:15], v[180:183]
    v_mfma_f32_16x16x32_bf16 v[188:191], v[220:223], v[12:15], v[188:191]
    v_mfma_f32_16x16x32_bf16 v[184:187], v[220:223], v[8:11], v[184:187]
    s_waitcnt vmcnt(7) lgkmcnt(0)
    s_cmp_lg_u32 s59, 7
    s_cbranch_scc1 P2_nl21
    buffer_load_dword v111, v112, s[36:39], 0 offen sc1
P2_nl21:
    v_mfma_f32_16x16x32_bf16 v[128:131], v[224:227], v[16:19], v[128:131]
    ds_read_b64_tr_b16 v[192:193], v80 offset:32768
    ds_read_b64_tr_b16 v[194:195], v80 offset:36864
    v_mfma_f32_16x16x32_bf16 v[132:135], v[224:227], v[20:23], v[132:135]
    ds_read_b64_tr_b16 v[196:197], v81 offset:32768
    ds_read_b64_tr_b16 v[198:199], v81 offset:36864
    v_mfma_f32_16x16x32_bf16 v[140:143], v[228:231], v[20:23], v[140:143]
    ds_read_b64_tr_b16 v[200:201], v82 offset:32768
    ds_read_b64_tr_b16 v[202:203], v82 offset:36864
    v_mfma_f32_16x16x32_bf16 v[136:139], v[228:231], v[16:19], v[136:139]
    ds_read_b64_tr_b16 v[204:205], v83 offset:32768
    ds_read_b64_tr_b16 v[206:207], v83 offset:36864
    s_add_u32 s74, s96, 2048
    buffer_load_dwordx4 v[8:11], v104, s[36:39], s74 offen sc1
    v_mfma_f32_16x16x32_bf16 v[144:147], v[232:235], v[16:19], v[144:147]
    ds_read_b64_tr_b16 v[208:209], v84 offset:32768
    ds_read_b64_tr_b16 v[210:211], v84 offset:36864
    v_mfma_f32_16x16x32_bf16 v[148:151], v[232:235], v[20:23], v[148:151]
    ds_read_b64_tr_b16 v[212:213], v85 offset:32768
    ds_read_b64_tr_b16 v[214:215], v85 offset:36864
    v_mfma_f32_16x16x32_bf16 v[156:159], v[236:239], v[20:23], v[156:159]
    ds_read_b64_tr_b16 v[216:217], v86 offset:32768
    ds_read_b64_tr_b16 v[218:219], v86 offset:36864
    v_mfma_f32_16x16x32_bf16 v[152:155], v[236:239], v[16:19], v[152:155]
    ds_read_b64_tr_b16 v[220:221], v87 offset:32768
    ds_read_b64_tr_b16 v[222:223], v87 offset:36864
    buffer_load_dwordx4 v[12:15], v105, s[36:39], s74 offen sc1
    v_mfma_f32_16x16x32_bf16 v[160:163], v[240:243], v[16:19], v[160:163]
    v_mfma_f32_16x16x32_bf16 v[164:167], v[240:243], v[20:23], v[164:167]
    v_mfma_f32_16x16x32_bf16 v[172:175], v[244:247], v[20:23], v[172:175]
    s_add_u32 m0, s101, 131072
    s_add_u32 s73, s19, 393216
    buffer_load_dwordx4 v114, s[88:91], s73 offen lds
    v_mfma_f32_16x16x32_bf16 v[168:171], v[244:247], v[16:19], v[168:171]
    v_mfma_f32_16x16x32_bf16 v[176:179], v[248:251], v[16:19], v[176:179]
    v_mfma_f32_16x16x32_bf16 v[180:183], v[248:251], v[20:23], v[180:183]
    v_mfma_f32_16x16x32_bf16 v[188:191], v[252:255], v[20:23], v[188:191]
    v_mfma_f32_16x16x32_bf16 v[184:187], v[252:255], v[16:19], v[184:187]
    s_waitcnt vmcnt(7) lgkmcnt(0)
    v_mfma_f32_16x16x32_bf16 v[128:131], v[192:195], v[24:27], v[128:131]
    ds_read_b64_tr_b16 v[224:225], v80 offset:40960
    ds_read_b64_tr_b16 v[226:227], v80 offset:45056
    v_mfma_f32_16x16x32_bf16 v[132:135], v[192:195], v[28:31], v[132:135]
    ds_read_b64_tr_b16 v[228:229], v81 offset:40960
    ds_read_b64_tr_b16 v[230:231], v81 offset:45056
    v_mfma_f32_16x16x32_bf16 v[140:143], v[196:199], v[28:31], v[140:143]
    ds_read_b64_tr_b16 v[232:233], v82 offset:40960
    ds_read_b64_tr_b16 v[234:235], v82 offset:45056
    v_mfma_f32_16x16x32_bf16 v[136:139], v[196:199], v[24:27], v[136:139]
    ds_read_b64_tr_b16 v[236:237], v83 offset:40960
    ds_read_b64_tr_b16 v[238:239], v83 offset:45056
    s_add_u32 s74, s96, 11264
    buffer_load_dwordx4 v[16:19], v104, s[36:39], s74 offen sc1
    v_mfma_f32_16x16x32_bf16 v[144:147], v[200:203], v[24:27], v[144:147]
    ds_read_b64_tr_b16 v[240:241], v84 offset:40960
    ds_read_b64_tr_b16 v[242:243], v84 offset:45056
    v_mfma_f32_16x16x32_bf16 v[148:151], v[200:203], v[28:31], v[148:151]
    ds_read_b64_tr_b16 v[244:245], v85 offset:40960
    ds_read_b64_tr_b16 v[246:247], v85 offset:45056
    v_mfma_f32_16x16x32_bf16 v[156:159], v[204:207], v[28:31], v[156:159]
    ds_read_b64_tr_b16 v[248:249], v86 offset:40960
    ds_read_b64_tr_b16 v[250:251], v86 offset:45056
    v_mfma_f32_16x16x32_bf16 v[152:155], v[204:207], v[24:27], v[152:155]
    ds_read_b64_tr_b16 v[252:253], v87 offset:40960
    ds_read_b64_tr_b16 v[254:255], v87 offset:45056
    buffer_load_dwordx4 v[20:23], v105, s[36:39], s74 offen sc1
    v_mfma_f32_16x16x32_bf16 v[160:163], v[208:211], v[24:27], v[160:163]
    v_mfma_f32_16x16x32_bf16 v[164:167], v[208:211], v[28:31], v[164:167]
    v_mfma_f32_16x16x32_bf16 v[172:175], v[212:215], v[28:31], v[172:175]
    s_add_u32 m0, s101, 139264
    s_add_u32 s73, s19, 458752
    buffer_load_dwordx4 v114, s[88:91], s73 offen lds
    v_mfma_f32_16x16x32_bf16 v[168:171], v[212:215], v[24:27], v[168:171]
    v_mfma_f32_16x16x32_bf16 v[176:179], v[216:219], v[24:27], v[176:179]
    v_mfma_f32_16x16x32_bf16 v[180:183], v[216:219], v[28:31], v[180:183]
    v_mfma_f32_16x16x32_bf16 v[188:191], v[220:223], v[28:31], v[188:191]
    v_mfma_f32_16x16x32_bf16 v[184:187], v[220:223], v[24:27], v[184:187]
    s_waitcnt vmcnt(7) lgkmcnt(0)
    v_mfma_f32_16x16x32_bf16 v[128:131], v[224:227], v[32:35], v[128:131]
    ds_read_b64_tr_b16 v[192:193], v80 offset:49152
    ds_read_b64_tr_b16 v[194:195], v80 offset:53248
    v_mfma_f32_16x16x32_bf16 v[132:135], v[224:227], v[36:39], v[132:135]
    ds_read_b64_tr_b16 v[196:197], v81 offset:49152
    ds_read_b64_tr_b16 v[198:199], v81 offset:53248
    v_mfma_f32_16x16x32_bf16 v[140:143], v[228:231], v[36:39], v[140:143]
    ds_read_b64_tr_b16 v[200:201], v82 offset:49152
    ds_read_b64_tr_b16 v[202:203], v82 offset:53248
    v_mfma_f32_16x16x32_bf16 v[136:139], v[228:231], v[32:35], v[136:139]
    ds_read_b64_tr_b16 v[204:205], v83 offset:49152
    ds_read_b64_tr_b16 v[206:207], v83 offset:53248
    s_add_u32 s74, s96, 16384
    buffer_load_dwordx4 v[24:27], v104, s[36:39], s74 offen sc1
    v_mfma_f32_16x16x32_bf16 v[144:147], v[232:235], v[32:35], v[144:147]
    ds_read_b64_tr_b16 v[208:209], v84 offset:49152
    ds_read_b64_tr_b16 v[210:211], v84 offset:53248
    v_mfma_f32_16x16x32_bf16 v[148:151], v[232:235], v[36:39], v[148:151]
    ds_read_b64_tr_b16 v[212:213], v85 offset:49152
    ds_read_b64_tr_b16 v[214:215], v85 offset:53248
    v_mfma_f32_16x16x32_bf16 v[156:159], v[236:239], v[36:39], v[156:159]
    ds_read_b64_tr_b16 v[216:217], v86 offset:49152
    ds_read_b64_tr_b16 v[218:219], v86 offset:53248
    v_mfma_f32_16x16x32_bf16 v[152:155], v[236:239], v[32:35], v[152:155]
    ds_read_b64_tr_b16 v[220:221], v87 offset:49152
    ds_read_b64_tr_b16 v[222:223], v87 offset:53248
    buffer_load_dwordx4 v[28:31], v105, s[36:39], s74 offen sc1
    v_mfma_f32_16x16x32_bf16 v[160:163], v[240:243], v[32:35], v[160:163]
    v_mfma_f32_16x16x32_bf16 v[164:167], v[240:243], v[36:39], v[164:167]
    v_mfma_f32_16x16x32_bf16 v[172:175], v[244:247], v[36:39], v[172:175]
    v_mfma_f32_16x16x32_bf16 v[168:171], v[244:247], v[32:35], v[168:171]
    v_mfma_f32_16x16x32_bf16 v[176:179], v[248:251], v[32:35], v[176:179]
    v_mfma_f32_16x16x32_bf16 v[180:183], v[248:251], v[36:39], v[180:183]
    v_mfma_f32_16x16x32_bf16 v[188:191], v[252:255], v[36:39], v[188:191]
    v_mfma_f32_16x16x32_bf16 v[184:187], v[252:255], v[32:35], v[184:187]
    s_cmp_lg_u32 s59, 7
    s_cbranch_scc1 P2_nc23
    s_waitcnt vmcnt(8)
    s_mov_b32 s79, 0
P2c3_c:
    v_cmp_ne_u32 vcc, s83, v111
    s_nop 4
    s_cbranch_vccz P2c3_ok
    s_sleep 4
    buffer_load_dword v111, v112, s[36:39], 0 offen sc1
    s_add_u32 s79, s79, 1
    s_waitcnt vmcnt(0)
    s_cmp_lt_u32 s79, 100000
    s_cbranch_scc1 P2c3_c
P2c3_ok:
P2_nc23:
    s_waitcnt vmcnt(6) lgkmcnt(0)
    s_barrier
    buffer_load_dword v106, v106, s[36:39], 0 offen sc1
    buffer_load_dword v107, v107, s[36:39], 0 offen sc1
    s_bitcmp0_b32 s95, 0
    s_cbranch_scc0 K2_sp1_24
    v_swap_b32 v10, v12
    v_swap_b32 v11, v13
    s_branch K2_spd_24
K2_sp1_24:
    v_swap_b32 v8, v14
    v_swap_b32 v9, v15
K2_spd_24:
    s_nop 1
    v_mfma_f32_16x16x32_bf16 v[128:131], v[192:195], v[8:11], v[128:131]
    ds_read_b64_tr_b16 v[224:225], v80 offset:57344
    ds_read_b64_tr_b16 v[226:227], v80 offset:61440
    v_mfma_f32_16x16x32_bf16 v[132:135], v[192:195], v[12:15], v[132:135]
    ds_read_b64_tr_b16 v[228:229], v81 offset:57344
    ds_read_b64_tr_b16 v[230:231], v81 offset:61440
    v_mfma_f32_16x16x32_bf16 v[140:143], v[196:199], v[12:15], v[140:143]
    ds_read_b64_tr_b16 v[232:233], v82 offset:57344
    ds_read_b64_tr_b16 v[234:235], v82 offset:61440
    v_mfma_f32_16x16x32_bf16 v[136:139], v[196:199], v[8:11], v[136:139]
    ds_read_b64_tr_b16 v[236:237], v83 offset:57344
    ds_read_b64_tr_b16 v[238:239], v83 offset:61440
    s_add_u32 s74, s96, 25600
    buffer_load_dwordx4 v[32:35], v104, s[36:39], s74 offen sc1
    v_mfma_f32_16x16x32_bf16 v[144:147], v[200:203], v[8:11], v[144:147]
    ds_read_b64_tr_b16 v[240:241], v84 offset:57344
    ds_read_b64_tr_b16 v[242:243], v84 offset:61440
    v_mfma_f32_16x16x32_bf16 v[148:151], v[200:203], v[12:15], v[148:151]
    ds_read_b64_tr_b16 v[244:245], v85 offset:57344
    ds_read_b64_tr_b16 v[246:247], v85 offset:61440
    v_mfma_f32_16x16x32_bf16 v[156:159], v[204:207], v[12:15], v[156:159]
    ds_read_b64_tr_b16 v[248:249], v86 offset:57344
    ds_read_b64_tr_b16 v[250:251], v86 offset:61440
    v_mfma_f32_16x16x32_bf16 v[152:155], v[204:207], v[8:11], v[152:155]
    ds_read_b64_tr_b16 v[252:253], v87 offset:57344
    ds_read_b64_tr_b16 v[254:255], v87 offset:61440
    buffer_load_dwordx4 v[36:39], v105, s[36:39], s74 offen sc1
    v_mfma_f32_16x16x32_bf16 v[160:163], v[208:211], v[8:11], v[160:163]
    v_mfma_f32_16x16x32_bf16 v[164:167], v[208:211], v[12:15], v[164:167]
    v_mfma_f32_16x16x32_bf16 v[172:175], v[212:215], v[12:15], v[172:175]
    v_mfma_f32_16x16x32_bf16 v[168:171], v[212:215], v[8:11], v[168:171]
    v_mfma_f32_16x16x32_bf16 v[176:179], v[216:219], v[8:11], v[176:179]
    v_mfma_f32_16x16x32_bf16 v[180:183], v[216:219], v[12:15], v[180:183]
    v_mfma_f32_16x16x32_bf16 v[188:191], v[220:223], v[12:15], v[188:191]
    v_mfma_f32_16x16x32_bf16 v[184:187], v[220:223], v[8:11], v[184:187]
    s_waitcnt vmcnt(7) lgkmcnt(0)
    s_bitcmp0_b32 s95, 0
    s_cbranch_scc0 K2_sp1_25
    v_swap_b32 v18, v20
    v_swap_b32 v19, v21
    s_branch K2_spd_25
K2_sp1_25:
    v_swap_b32 v16, v22
    v_swap_b32 v17, v23
K2_spd_25:
    s_nop 1
    v_mfma_f32_16x16x32_bf16 v[128:131], v[224:227], v[16:19], v[128:131]
    ds_read_b64_tr_b16 v[192:193], v88 offset:0
    ds_read_b64_tr_b16 v[194:195], v88 offset:4096
    v_mfma_f32_16x16x32_bf16 v[132:135], v[224:227], v[20:23], v[132:135]
    ds_read_b64_tr_b16 v[196:197], v89 offset:0
    ds_read_b64_tr_b16 v[198:199], v89 offset:4096
    v_mfma_f32_16x16x32_bf16 v[140:143], v[228:231], v[20:23], v[140:143]
    ds_read_b64_tr_b16 v[200:201], v90 offset:0
    ds_read_b64_tr_b16 v[202:203], v90 offset:4096
    v_mfma_f32_16x16x32_bf16 v[136:139], v[228:231], v[16:19], v[136:139]
    ds_read_b64_tr_b16 v[204:205], v91 offset:0
    ds_read_b64_tr_b16 v[206:207], v91 offset:4096
    s_add_u32 s74, s18, 0
    buffer_load_dwordx4 v[8:11], v104, s[36:39], s74 offen sc1
    v_mfma_f32_16x16x32_bf16 v[144:147], v[232:235], v[16:19], v[144:147]
    ds_read_b64_tr_b16 v[208:209], v92 offset:0
    ds_read_b64_tr_b16 v[210:211], v92 offset:4096
    v_mfma_f32_16x16x32_bf16 v[148:151], v[232:235], v[20:23], v[148:151]
    ds_read_b64_tr_b16 v[212:213], v93 offset:0
    ds_read_b64_tr_b16 v[214:215], v93 offset:4096
    v_mfma_f32_16x16x32_bf16 v[156:159], v[236:239], v[20:23], v[156:159]
    ds_read_b64_tr_b16 v[216:217], v94 offset:0
    ds_read_b64_tr_b16 v[218:219], v94 offset:4096
    v_mfma_f32_16x16x32_bf16 v[152:155], v[236:239], v[16:19], v[152:155]
    ds_read_b64_tr_b16 v[220:221], v95 offset:0
    ds_read_b64_tr_b16 v[222:223], v95 offset:4096
    buffer_load_dwordx4 v[12:15], v105, s[36:39], s74 offen sc1
    v_mfma_f32_16x16x32_bf16 v[160:163], v[240:243], v[16:19], v[160:163]
    v_mfma_f32_16x16x32_bf16 v[164:167], v[240:243], v[20:23], v[164:167]
    v_mfma_f32_16x16x32_bf16 v[172:175], v[244:247], v[20:23], v[172:175]
    v_mfma_f32_16x16x32_bf16 v[168:171], v[244:247], v[16:19], v[168:171]
    v_mfma_f32_16x16x32_bf16 v[176:179], v[248:251], v[16:19], v[176:179]
    v_mfma_f32_16x16x32_bf16 v[180:183], v[248:251], v[20:23], v[180:183]
    v_mfma_f32_16x16x32_bf16 v[188:191], v[252:255], v[20:23], v[188:191]
    v_mfma_f32_16x16x32_bf16 v[184:187], v[252:255], v[16:19], v[184:187]
    s_waitcnt vmcnt(6) lgkmcnt(0)
    s_bitcmp0_b32 s95, 0
    s_cbranch_scc0 K2_sp1_26
    v_swap_b32 v26, v28
    v_swap_b32 v27, v29
    s_branch K2_spd_26
K2_sp1_26:
    v_swap_b32 v24, v30
    v_swap_b32 v25, v31
K2_spd_26:
    s_nop 1
    v_mfma_f32_16x16x32_bf16 v[128:131], v[192:195], v[24:27], v[128:131]
    ds_read_b64_tr_b16 v[224:225], v88 offset:8192
    ds_read_b64_tr_b16 v[226:227], v88 offset:12288
    v_mfma_f32_16x16x32_bf16 v[132:135], v[192:195], v[28:31], v[132:135]
    ds_read_b64_tr_b16 v[228:229], v89 offset:8192
    ds_read_b64_tr_b16 v[230:231], v89 offset:12288
    v_mfma_f32_16x16x32_bf16 v[140:143], v[196:199], v[28:31], v[140:143]
    ds_read_b64_tr_b16 v[232:233], v90 offset:8192
    ds_read_b64_tr_b16 v[234:235], v90 offset:12288
    v_mfma_f32_16x16x32_bf16 v[136:139], v[196:199], v[24:27], v[136:139]
    ds_read_b64_tr_b16 v[236:237], v91 offset:8192
    ds_read_b64_tr_b16 v[238:239], v91 offset:12288
    s_add_u32 s74, s18, 1024
    buffer_load_dwordx4 v[16:19], v104, s[36:39], s74 offen sc1
    v_mfma_f32_16x16x32_bf16 v[144:147], v[200:203], v[24:27], v[144:147]
    ds_read_b64_tr_b16 v[240:241], v92 offset:8192
    ds_read_b64_tr_b16 v[242:243], v92 offset:12288
    v_mfma_f32_16x16x32_bf16 v[148:151], v[200:203], v[28:31], v[148:151]
    ds_read_b64_tr_b16 v[244:245], v93 offset:8192
    ds_read_b64_tr_b16 v[246:247], v93 offset:12288
    v_mfma_f32_16x16x32_bf16 v[156:159], v[204:207], v[28:31], v[156:159]
    ds_read_b64_tr_b16 v[248:249], v94 offset:8192
    ds_read_b64_tr_b16 v[250:251], v94 offset:12288
    v_mfma_f32_16x16x32_bf16 v[152:155], v[204:207], v[24:27], v[152:155]
    ds_read_b64_tr_b16 v[252:253], v95 offset:8192
    ds_read_b64_tr_b16 v[254:255], v95 offset:12288
    buffer_load_dwordx4 v[20:23], v105, s[36:39], s74 offen sc1
    v_mfma_f32_16x16x32_bf16 v[160:163], v[208:211], v[24:27], v[160:163]
    v_mfma_f32_16x16x32_bf16 v[164:167], v[208:211], v[28:31], v[164:167]
    v_mfma_f32_16x16x32_bf16 v[172:175], v[212:215], v[28:31], v[172:175]
    v_mfma_f32_16x16x32_bf16 v[168:171], v[212:215], v[24:27], v[168:171]
    v_mfma_f32_16x16x32_bf16 v[176:179], v[216:219], v[24:27], v[176:179]
    v_mfma_f32_16x16x32_bf16 v[180:183], v[216:219], v[28:31], v[180:183]
    v_mfma_f32_16x16x32_bf16 v[188:191], v[220:223], v[28:31], v[188:191]
    v_mfma_f32_16x16x32_bf16 v[184:187], v[220:223], v[24:27], v[184:187]
    s_waitcnt vmcnt(4) lgkmcnt(0)
    s_bitcmp0_b32 s95, 0
    s_cbranch_scc0 K2_sp1_27
    v_swap_b32 v34, v36
    v_swap_b32 v35, v37
    s_branch K2_spd_27
K2_sp1_27:
    v_swap_b32 v32, v38
    v_swap_b32 v33, v39
K2_spd_27:
    s_nop 1
    v_mfma_f32_16x16x32_bf16 v[128:131], v[224:227], v[32:35], v[128:131]
    ds_read_b64_tr_b16 v[192:193], v88 offset:16384
    ds_read_b64_tr_b16 v[194:195], v88 offset:20480
    v_mfma_f32_16x16x32_bf16 v[132:135], v[224:227], v[36:39], v[132:135]
    ds_read_b64_tr_b16 v[196:197], v89 offset:16384
    ds_read_b64_tr_b16 v[198:199], v89 offset:20480
    v_mfma_f32_16x16x32_bf16 v[140:143], v[228:231], v[36:39], v[140:143]
    ds_read_b64_tr_b16 v[200:201], v90 offset:16384
    ds_read_b64_tr_b16 v[202:203], v90 offset:20480
    v_mfma_f32_16x16x32_bf16 v[136:139], v[228:231], v[32:35], v[136:139]
    ds_read_b64_tr_b16 v[204:205], v91 offset:16384
    ds_read_b64_tr_b16 v[206:207], v91 offset:20480
    s_add_u32 s74, s18, 2048
    buffer_load_dwordx4 v[24:27], v104, s[36:39], s74 offen sc1
    v_mfma_f32_16x16x32_bf16 v[144:147], v[232:235], v[32:35], v[144:147]
    ds_read_b64_tr_b16 v[208:209], v92 offset:16384
    ds_read_b64_tr_b16 v[210:211], v92 offset:20480
    v_mfma_f32_16x16x32_bf16 v[148:151], v[232:235], v[36:39], v[148:151]
    ds_read_b64_tr_b16 v[212:213], v93 offset:16384
    ds_read_b64_tr_b16 v[214:215], v93 offset:20480
    v_mfma_f32_16x16x32_bf16 v[156:159], v[236:239], v[36:39], v[156:159]
    ds_read_b64_tr_b16 v[216:217], v94 offset:16384
    ds_read_b64_tr_b16 v[218:219], v94 offset:20480
    v_mfma_f32_16x16x32_bf16 v[152:155], v[236:239], v[32:35], v[152:155]
    ds_read_b64_tr_b16 v[220:221], v95 offset:16384
    ds_read_b64_tr_b16 v[222:223], v95 offset:20480
    buffer_load_dwordx4 v[28:31], v105, s[36:39], s74 offen sc1
    v_mfma_f32_16x16x32_bf16 v[160:163], v[240:243], v[32:35], v[160:163]
    v_mfma_f32_16x16x32_bf16 v[164:167], v[240:243], v[36:39], v[164:167]
    v_mfma_f32_16x16x32_bf16 v[172:175], v[244:247], v[36:39], v[172:175]
    v_mfma_f32_16x16x32_bf16 v[168:171], v[244:247], v[32:35], v[168:171]
    v_mfma_f32_16x16x32_bf16 v[176:179], v[248:251], v[32:35], v[176:179]
    v_mfma_f32_16x16x32_bf16 v[180:183], v[248:251], v[36:39], v[180:183]
    v_mfma_f32_16x16x32_bf16 v[188:191], v[252:255], v[36:39], v[188:191]
    v_mfma_f32_16x16x32_bf16 v[184:187], v[252:255], v[32:35], v[184:187]
    s_waitcnt vmcnt(4) lgkmcnt(0)
    s_waitcnt vmcnt(8)
    v_rcp_f32 v106, v106
    v_rcp_f32 v107, v107
    v_mul_f32 v128, v106, v128
    v_mul_f32 v129, v106, v129
    v_mul_f32 v130, v106, v130
    v_mul_f32 v131, v106, v131
    v_mul_f32 v132, v107, v132
    v_mul_f32 v133, v107, v133
    v_mul_f32 v134, v107, v134
    v_mul_f32 v135, v107, v135
    v_mul_f32 v136, v106, v136
    v_mul_f32 v137, v106, v137
    v_mul_f32 v138, v106, v138
    v_mul_f32 v139, v106, v139
    v_mfma_f32_16x16x32_bf16 v[128:131], v[192:195], v[8:11], v[128:131]
    ds_read_b64_tr_b16 v[224:225], v88 offset:24576
    ds_read_b64_tr_b16 v[226:227], v88 offset:28672
    v_mul_f32 v140, v107, v140
    v_mul_f32 v141, v107, v141
    v_mul_f32 v142, v107, v142
    v_mul_f32 v143, v107, v143
    v_mfma_f32_16x16x32_bf16 v[132:135], v[192:195], v[12:15], v[132:135]
    ds_read_b64_tr_b16 v[228:229], v89 offset:24576
    ds_read_b64_tr_b16 v[230:231], v89 offset:28672
    v_mul_f32 v144, v106, v144
    v_mul_f32 v145, v106, v145
    v_mul_f32 v146, v106, v146
    v_mul_f32 v147, v106, v147
    v_mfma_f32_16x16x32_bf16 v[136:139], v[196:199], v[8:11], v[136:139]
    ds_read_b64_tr_b16 v[232:233], v90 offset:24576
    ds_read_b64_tr_b16 v[234:235], v90 offset:28672
    v_mul_f32 v148, v107, v148
    v_mul_f32 v149, v107, v149
    v_mul_f32 v150, v107, v150
    v_mul_f32 v151, v107, v151
    v_mfma_f32_16x16x32_bf16 v[140:143], v[196:199], v[12:15], v[140:143]
    ds_read_b64_tr_b16 v[236:237], v91 offset:24576
    ds_read_b64_tr_b16 v[238:239], v91 offset:28672
    s_add_u32 s74, s18, 3072
    buffer_load_dwordx4 v[32:35], v104, s[36:39], s74 offen sc1
    v_mul_f32 v152, v106, v152
    v_mul_f32 v153, v106, v153
    v_mul_f32 v154, v106, v154
    v_mul_f32 v155, v106, v155
    v_mfma_f32_16x16x32_bf16 v[144:147], v[200:203], v[8:11], v[144:147]
    ds_read_b64_tr_b16 v[240:241], v92 offset:24576
    ds_read_b64_tr_b16 v[242:243], v92 offset:28672
    v_mul_f32 v156, v107, v156
    v_mul_f32 v157, v107, v157
    v_mul_f32 v158, v107, v158
    v_mul_f32 v159, v107, v159
    v_mfma_f32_16x16x32_bf16 v[148:151], v[200:203], v[12:15], v[148:151]
    ds_read_b64_tr_b16 v[244:245], v93 offset:24576
    ds_read_b64_tr_b16 v[246:247], v93 offset:28672
    v_mul_f32 v160, v106, v160
    v_mul_f32 v161, v106, v161
    v_mul_f32 v162, v106, v162
    v_mul_f32 v163, v106, v163
    v_mfma_f32_16x16x32_bf16 v[152:155], v[204:207], v[8:11], v[152:155]
    ds_read_b64_tr_b16 v[248:249], v94 offset:24576
    ds_read_b64_tr_b16 v[250:251], v94 offset:28672
    v_mul_f32 v164, v107, v164
    v_mul_f32 v165, v107, v165
    v_mul_f32 v166, v107, v166
    v_mul_f32 v167, v107, v167
    v_mfma_f32_16x16x32_bf16 v[156:159], v[204:207], v[12:15], v[156:159]
    ds_read_b64_tr_b16 v[252:253], v95 offset:24576
    ds_read_b64_tr_b16 v[254:255], v95 offset:28672
    buffer_load_dwordx4 v[36:39], v105, s[36:39], s74 offen sc1
    v_mul_f32 v168, v106, v168
    v_mul_f32 v169, v106, v169
    v_mul_f32 v170, v106, v170
    v_mul_f32 v171, v106, v171
    v_mfma_f32_16x16x32_bf16 v[160:163], v[208:211], v[8:11], v[160:163]
    v_mul_f32 v172, v107, v172
    v_mul_f32 v173, v107, v173
    v_mul_f32 v174, v107, v174
    v_mul_f32 v175, v107, v175
    v_mfma_f32_16x16x32_bf16 v[164:167], v[208:211], v[12:15], v[164:167]
    v_mul_f32 v176, v106, v176
    v_mul_f32 v177, v106, v177
    v_mul_f32 v178, v106, v178
    v_mul_f32 v179, v106, v179
    v_mfma_f32_16x16x32_bf16 v[168:171], v[212:215], v[8:11], v[168:171]
    v_mul_f32 v180, v107, v180
    v_mul_f32 v181, v107, v181
    v_mul_f32 v182, v107, v182
    v_mul_f32 v183, v107, v183
    v_mfma_f32_16x16x32_bf16 v[172:175], v[212:215], v[12:15], v[172:175]
    v_mul_f32 v184, v106, v184
    v_mul_f32 v185, v106, v185
    v_mul_f32 v186, v106, v186
    v_mul_f32 v187, v106, v187
    v_mfma_f32_16x16x32_bf16 v[176:179], v[216:219], v[8:11], v[176:179]
    v_mul_f32 v188, v107, v188
    v_mul_f32 v189, v107, v189
    v_mul_f32 v190, v107, v190
    v_mul_f32 v191, v107, v191
    v_mfma_f32_16x16x32_bf16 v[180:183], v[216:219], v[12:15], v[180:183]
    v_mfma_f32_16x16x32_bf16 v[184:187], v[220:223], v[8:11], v[184:187]
    v_mfma_f32_16x16x32_bf16 v[188:191], v[220:223], v[12:15], v[188:191]
    s_waitcnt vmcnt(4) lgkmcnt(0)
    v_mfma_f32_16x16x32_bf16 v[128:131], v[224:227], v[16:19], v[128:131]
    ds_read_b64_tr_b16 v[192:193], v88 offset:32768
    ds_read_b64_tr_b16 v[194:195], v88 offset:36864
    v_mfma_f32_16x16x32_bf16 v[132:135], v[224:227], v[20:23], v[132:135]
    ds_read_b64_tr_b16 v[196:197], v89 offset:32768
    ds_read_b64_tr_b16 v[198:199], v89 offset:36864
    v_mfma_f32_16x16x32_bf16 v[140:143], v[228:231], v[20:23], v[140:143]
    ds_read_b64_tr_b16 v[200:201], v90 offset:32768
    ds_read_b64_tr_b16 v[202:203], v90 offset:36864
    v_mfma_f32_16x16x32_bf16 v[136:139], v[228:231], v[16:19], v[136:139]
    ds_read_b64_tr_b16 v[204:205], v91 offset:32768
    ds_read_b64_tr_b16 v[206:207], v91 offset:36864
    s_add_u32 s74, s18, 4096
    buffer_load_dwordx4 v[8:11], v104, s[36:39], s74 offen sc1
    v_mfma_f32_16x16x32_bf16 v[144:147], v[232:235], v[16:19], v[144:147]
    ds_read_b64_tr_b16 v[208:209], v92 offset:32768
    ds_read_b64_tr_b16 v[210:211], v92 offset:36864
    v_mfma_f32_16x16x32_bf16 v[148:151], v[232:235], v[20:23], v[148:151]
    ds_read_b64_tr_b16 v[212:213], v93 offset:32768
    ds_read_b64_tr_b16 v[214:215], v93 offset:36864
    v_mfma_f32_16x16x32_bf16 v[156:159], v[236:239], v[20:23], v[156:159]
    ds_read_b64_tr_b16 v[216:217], v94 offset:32768
    ds_read_b64_tr_b16 v[218:219], v94 offset:36864
    v_mfma_f32_16x16x32_bf16 v[152:155], v[236:239], v[16:19], v[152:155]
    ds_read_b64_tr_b16 v[220:221], v95 offset:32768
    ds_read_b64_tr_b16 v[222:223], v95 offset:36864
    buffer_load_dwordx4 v[12:15], v105, s[36:39], s74 offen sc1
    v_mfma_f32_16x16x32_bf16 v[160:163], v[240:243], v[16:19], v[160:163]
    v_mfma_f32_16x16x32_bf16 v[164:167], v[240:243], v[20:23], v[164:167]
    v_mfma_f32_16x16x32_bf16 v[172:175], v[244:247], v[20:23], v[172:175]
    v_mfma_f32_16x16x32_bf16 v[168:171], v[244:247], v[16:19], v[168:171]
    v_mfma_f32_16x16x32_bf16 v[176:179], v[248:251], v[16:19], v[176:179]
    v_mfma_f32_16x16x32_bf16 v[180:183], v[248:251], v[20:23], v[180:183]
    v_mfma_f32_16x16x32_bf16 v[188:191], v[252:255], v[20:23], v[188:191]
    v_mfma_f32_16x16x32_bf16 v[184:187], v[252:255], v[16:19], v[184:187]
    s_waitcnt vmcnt(4) lgkmcnt(0)
    s_barrier
    v_mfma_f32_16x16x32_bf16 v[128:131], v[192:195], v[24:27], v[128:131]
    ds_read_b64_tr_b16 v[224:225], v88 offset:40960
    ds_read_b64_tr_b16 v[226:227], v88 offset:45056
    v_mfma_f32_16x16x32_bf16 v[132:135], v[192:195], v[28:31], v[132:135]
    ds_read_b64_tr_b16 v[228:229], v89 offset:40960
    ds_read_b64_tr_b16 v[230:231], v89 offset:45056
    v_mfma_f32_16x16x32_bf16 v[140:143], v[196:199], v[28:31], v[140:143]
    ds_read_b64_tr_b16 v[232:233], v90 offset:40960
    ds_read_b64_tr_b16 v[234:235], v90 offset:45056
    v_mfma_f32_16x16x32_bf16 v[136:139], v[196:199], v[24:27], v[136:139]
    ds_read_b64_tr_b16 v[236:237], v91 offset:40960
    ds_read_b64_tr_b16 v[238:239], v91 offset:45056
    s_add_u32 s74, s18, 5120
    buffer_load_dwordx4 v[16:19], v104, s[36:39], s74 offen sc1
    v_mfma_f32_16x16x32_bf16 v[144:147], v[200:203], v[24:27], v[144:147]
    ds_read_b64_tr_b16 v[240:241], v92 offset:40960
    ds_read_b64_tr_b16 v[242:243], v92 offset:45056
    v_mfma_f32_16x16x32_bf16 v[148:151], v[200:203], v[28:31], v[148:151]
    ds_read_b64_tr_b16 v[244:245], v93 offset:40960
    ds_read_b64_tr_b16 v[246:247], v93 offset:45056
    v_mfma_f32_16x16x32_bf16 v[156:159], v[204:207], v[28:31], v[156:159]
    ds_read_b64_tr_b16 v[248:249], v94 offset:40960
    ds_read_b64_tr_b16 v[250:251], v94 offset:45056
    v_mfma_f32_16x16x32_bf16 v[152:155], v[204:207], v[24:27], v[152:155]
    ds_read_b64_tr_b16 v[252:253], v95 offset:40960
    ds_read_b64_tr_b16 v[254:255], v95 offset:45056
    buffer_load_dwordx4 v[20:23], v105, s[36:39], s74 offen sc1
    v_mfma_f32_16x16x32_bf16 v[160:163], v[208:211], v[24:27], v[160:163]
    v_mfma_f32_16x16x32_bf16 v[164:167], v[208:211], v[28:31], v[164:167]
    v_mfma_f32_16x16x32_bf16 v[172:175], v[212:215], v[28:31], v[172:175]
    s_add_u32 s74, s18, 6144
    buffer_load_dwordx4 v[40:43], v104, s[36:39], s74 offen sc1
    v_mfma_f32_16x16x32_bf16 v[168:171], v[212:215], v[24:27], v[168:171]
    v_mfma_f32_16x16x32_bf16 v[176:179], v[216:219], v[24:27], v[176:179]
    v_mfma_f32_16x16x32_bf16 v[180:183], v[216:219], v[28:31], v[180:183]
    buffer_load_dwordx4 v[44:47], v105, s[36:39], s74 offen sc1
    v_mfma_f32_16x16x32_bf16 v[188:191], v[220:223], v[28:31], v[188:191]
    v_mfma_f32_16x16x32_bf16 v[184:187], v[220:223], v[24:27], v[184:187]
    s_waitcnt vmcnt(6) lgkmcnt(0)
    v_mfma_f32_16x16x32_bf16 v[128:131], v[224:227], v[32:35], v[128:131]
    ds_read_b64_tr_b16 v[192:193], v88 offset:49152
    ds_read_b64_tr_b16 v[194:195], v88 offset:53248
    v_mfma_f32_16x16x32_bf16 v[132:135], v[224:227], v[36:39], v[132:135]
    ds_read_b64_tr_b16 v[196:197], v89 offset:49152
    ds_read_b64_tr_b16 v[198:199], v89 offset:53248
    v_mfma_f32_16x16x32_bf16 v[140:143], v[228:231], v[36:39], v[140:143]
    ds_read_b64_tr_b16 v[200:201], v90 offset:49152
    ds_read_b64_tr_b16 v[202:203], v90 offset:53248
    v_mfma_f32_16x16x32_bf16 v[136:139], v[228:231], v[32:35], v[136:139]
    ds_read_b64_tr_b16 v[204:205], v91 offset:49152
    ds_read_b64_tr_b16 v[206:207], v91 offset:53248
    s_add_u32 s74, s18, 7168
    buffer_load_dwordx4 v[48:51], v104, s[36:39], s74 offen sc1
    v_mfma_f32_16x16x32_bf16 v[144:147], v[232:235], v[32:35], v[144:147]
    ds_read_b64_tr_b16 v[208:209], v92 offset:49152
    ds_read_b64_tr_b16 v[210:211], v92 offset:53248
    v_mfma_f32_16x16x32_bf16 v[148:151], v[232:235], v[36:39], v[148:151]
    ds_read_b64_tr_b16 v[212:213], v93 offset:49152
    ds_read_b64_tr_b16 v[214:215], v93 offset:53248
    v_mfma_f32_16x16x32_bf16 v[156:159], v[236:239], v[36:39], v[156:159]
    ds_read_b64_tr_b16 v[216:217], v94 offset:49152
    ds_read_b64_tr_b16 v[218:219], v94 offset:53248
    v_mfma_f32_16x16x32_bf16 v[152:155], v[236:239], v[32:35], v[152:155]
    ds_read_b64_tr_b16 v[220:221], v95 offset:49152
    ds_read_b64_tr_b16 v[222:223], v95 offset:53248
    buffer_load_dwordx4 v[52:55], v105, s[36:39], s74 offen sc1
    v_mfma_f32_16x16x32_bf16 v[160:163], v[240:243], v[32:35], v[160:163]
    v_mfma_f32_16x16x32_bf16 v[164:167], v[240:243], v[36:39], v[164:167]
    v_mfma_f32_16x16x32_bf16 v[172:175], v[244:247], v[36:39], v[172:175]
    v_mfma_f32_16x16x32_bf16 v[168:171], v[244:247], v[32:35], v[168:171]
    v_mfma_f32_16x16x32_bf16 v[176:179], v[248:251], v[32:35], v[176:179]
    v_mfma_f32_16x16x32_bf16 v[180:183], v[248:251], v[36:39], v[180:183]
    v_mfma_f32_16x16x32_bf16 v[188:191], v[252:255], v[36:39], v[188:191]
    v_mfma_f32_16x16x32_bf16 v[184:187], v[252:255], v[32:35], v[184:187]
    s_waitcnt vmcnt(6) lgkmcnt(0)
    v_mfma_f32_16x16x32_bf16 v[128:131], v[192:195], v[8:11], v[128:131]
    ds_read_b64_tr_b16 v[224:225], v92 offset:57344
    ds_read_b64_tr_b16 v[226:227], v92 offset:61440
    v_mfma_f32_16x16x32_bf16 v[132:135], v[192:195], v[12:15], v[132:135]
    ds_read_b64_tr_b16 v[228:229], v93 offset:57344
    ds_read_b64_tr_b16 v[230:231], v93 offset:61440
    v_mfma_f32_16x16x32_bf16 v[140:143], v[196:199], v[12:15], v[140:143]
    ds_read_b64_tr_b16 v[232:233], v94 offset:57344
    ds_read_b64_tr_b16 v[234:235], v94 offset:61440
    v_mfma_f32_16x16x32_bf16 v[136:139], v[196:199], v[8:11], v[136:139]
    ds_read_b64_tr_b16 v[236:237], v95 offset:57344
    ds_read_b64_tr_b16 v[238:239], v95 offset:61440
    v_mfma_f32_16x16x32_bf16 v[144:147], v[200:203], v[8:11], v[144:147]
    ds_read_b64_tr_b16 v[240:241], v100 offset:0
    ds_read_b64_tr_b16 v[242:243], v100 offset:4096
    v_mfma_f32_16x16x32_bf16 v[148:151], v[200:203], v[12:15], v[148:151]
    ds_read_b64_tr_b16 v[244:245], v101 offset:0
    ds_read_b64_tr_b16 v[246:247], v101 offset:4096
    v_mfma_f32_16x16x32_bf16 v[156:159], v[204:207], v[12:15], v[156:159]
    ds_read_b64_tr_b16 v[248:249], v102 offset:0
    ds_read_b64_tr_b16 v[250:251], v102 offset:4096
    v_mfma_f32_16x16x32_bf16 v[152:155], v[204:207], v[8:11], v[152:155]
    ds_read_b64_tr_b16 v[252:253], v103 offset:0
    ds_read_b64_tr_b16 v[254:255], v103 offset:4096
    v_mfma_f32_16x16x32_bf16 v[160:163], v[208:211], v[8:11], v[160:163]
    v_mfma_f32_16x16x32_bf16 v[164:167], v[208:211], v[12:15], v[164:167]
    v_mfma_f32_16x16x32_bf16 v[172:175], v[212:215], v[12:15], v[172:175]
    v_mfma_f32_16x16x32_bf16 v[168:171], v[212:215], v[8:11], v[168:171]
    v_mfma_f32_16x16x32_bf16 v[176:179], v[216:219], v[8:11], v[176:179]
    v_mfma_f32_16x16x32_bf16 v[180:183], v[216:219], v[12:15], v[180:183]
    v_mfma_f32_16x16x32_bf16 v[188:191], v[220:223], v[12:15], v[188:191]
    v_mfma_f32_16x16x32_bf16 v[184:187], v[220:223], v[8:11], v[184:187]
    s_waitcnt vmcnt(2) lgkmcnt(0)
    s_lshl_b32 s75, s59, 11
    v_mfma_f32_16x16x32_bf16 v[160:163], v[224:227], v[16:19], v[160:163]
    ds_read_b64_tr_b16 v[192:193], v100 offset:8192
    ds_read_b64_tr_b16 v[194:195], v100 offset:12288
    v_mfma_f32_16x16x32_bf16 v[164:167], v[224:227], v[20:23], v[164:167]
    ds_read_b64_tr_b16 v[196:197], v101 offset:8192
    ds_read_b64_tr_b16 v[198:199], v101 offset:12288
    v_mfma_f32_16x16x32_bf16 v[168:171], v[228:231], v[16:19], v[168:171]
    ds_read_b64_tr_b16 v[200:201], v102 offset:8192
    ds_read_b64_tr_b16 v[202:203], v102 offset:12288
    v_mfma_f32_16x16x32_bf16 v[172:175], v[228:231], v[20:23], v[172:175]
    ds_read_b64_tr_b16 v[204:205], v103 offset:8192
    ds_read_b64_tr_b16 v[206:207], v103 offset:12288
    v_mfma_f32_16x16x32_bf16 v[176:179], v[232:235], v[16:19], v[176:179]
    ds_read_b64_tr_b16 v[208:209], v88 offset:57344
    ds_read_b64_tr_b16 v[210:211], v88 offset:61440
    v_mfma_f32_16x16x32_bf16 v[180:183], v[232:235], v[20:23], v[180:183]
    ds_read_b64_tr_b16 v[212:213], v89 offset:57344
    ds_read_b64_tr_b16 v[214:215], v89 offset:61440
    v_mfma_f32_16x16x32_bf16 v[184:187], v[236:239], v[16:19], v[184:187]
    ds_read_b64_tr_b16 v[216:217], v90 offset:57344
    ds_read_b64_tr_b16 v[218:219], v90 offset:61440
    v_mfma_f32_16x16x32_bf16 v[188:191], v[236:239], v[20:23], v[188:191]
    ds_read_b64_tr_b16 v[220:221], v91 offset:57344
    ds_read_b64_tr_b16 v[222:223], v91 offset:61440
    v_mfma_f32_16x16x32_bf16 v[160:163], v[240:243], v[40:43], v[160:163]
    v_mfma_f32_16x16x32_bf16 v[164:167], v[240:243], v[44:47], v[164:167]
    v_mfma_f32_16x16x32_bf16 v[168:171], v[244:247], v[40:43], v[168:171]
    v_mfma_f32_16x16x32_bf16 v[172:175], v[244:247], v[44:47], v[172:175]
    v_mfma_f32_16x16x32_bf16 v[176:179], v[248:251], v[40:43], v[176:179]
    v_mfma_f32_16x16x32_bf16 v[180:183], v[248:251], v[44:47], v[180:183]
    v_mfma_f32_16x16x32_bf16 v[184:187], v[252:255], v[40:43], v[184:187]
    v_mfma_f32_16x16x32_bf16 v[188:191], v[252:255], v[44:47], v[188:191]
    s_waitcnt vmcnt(0) lgkmcnt(0)
    v_mfma_f32_16x16x32_bf16 v[160:163], v[192:195], v[48:51], v[160:163]
    ds_read_b64_tr_b16 v[224:225], v96 offset:0
    ds_read_b64_tr_b16 v[226:227], v96 offset:4096
    v_mfma_f32_16x16x32_bf16 v[164:167], v[192:195], v[52:55], v[164:167]
    ds_read_b64_tr_b16 v[228:229], v97 offset:0
    ds_read_b64_tr_b16 v[230:231], v97 offset:4096
    v_mfma_f32_16x16x32_bf16 v[168:171], v[196:199], v[48:51], v[168:171]
    ds_read_b64_tr_b16 v[232:233], v98 offset:0
    ds_read_b64_tr_b16 v[234:235], v98 offset:4096
    v_mfma_f32_16x16x32_bf16 v[172:175], v[196:199], v[52:55], v[172:175]
    ds_read_b64_tr_b16 v[236:237], v99 offset:0
    ds_read_b64_tr_b16 v[238:239], v99 offset:4096
    v_mfma_f32_16x16x32_bf16 v[176:179], v[200:203], v[48:51], v[176:179]
    ds_read_b64_tr_b16 v[240:241], v96 offset:8192
    ds_read_b64_tr_b16 v[242:243], v96 offset:12288
    v_mfma_f32_16x16x32_bf16 v[180:183], v[200:203], v[52:55], v[180:183]
    ds_read_b64_tr_b16 v[244:245], v97 offset:8192
    ds_read_b64_tr_b16 v[246:247], v97 offset:12288
    v_mfma_f32_16x16x32_bf16 v[184:187], v[204:207], v[48:51], v[184:187]
    ds_read_b64_tr_b16 v[248:249], v98 offset:8192
    ds_read_b64_tr_b16 v[250:251], v98 offset:12288
    v_mfma_f32_16x16x32_bf16 v[188:191], v[204:207], v[52:55], v[188:191]
    ds_read_b64_tr_b16 v[252:253], v99 offset:8192
    ds_read_b64_tr_b16 v[254:255], v99 offset:12288
    v_mfma_f32_16x16x32_bf16 v[132:135], v[208:211], v[20:23], v[132:135]
    s_xor_b32 s76, s93, 16
    v_mfma_f32_16x16x32_bf16 v[140:143], v[212:215], v[20:23], v[140:143]
    s_mul_i32 s76, s76, 49152
    v_mfma_f32_16x16x32_bf16 v[148:151], v[216:219], v[20:23], v[148:151]
    s_add_u32 s76, s76, s75
    v_mfma_f32_16x16x32_bf16 v[156:159], v[220:223], v[20:23], v[156:159]
    s_add_u32 s76, s76, 25182208
    s_waitcnt lgkmcnt(0)
    v_mfma_f32_16x16x32_bf16 v[132:135], v[224:227], v[44:47], v[132:135]
    v_cvt_pk_bf16_f32 v64, v160, v161
    v_cvt_pk_bf16_f32 v65, v162, v163
    v_cvt_pk_bf16_f32 v66, v168, v169
    v_mfma_f32_16x16x32_bf16 v[140:143], v[228:231], v[44:47], v[140:143]
    v_cvt_pk_bf16_f32 v67, v170, v171
    buffer_store_dwordx4 v[64:67], v113, s[36:39], s76 offen offset:0 sc1
    v_cvt_pk_bf16_f32 v68, v176, v177
    v_mfma_f32_16x16x32_bf16 v[148:151], v[232:235], v[44:47], v[148:151]
    v_cvt_pk_bf16_f32 v69, v178, v179
    v_cvt_pk_bf16_f32 v70, v184, v185
    v_cvt_pk_bf16_f32 v71, v186, v187
    v_mfma_f32_16x16x32_bf16 v[156:159], v[236:239], v[44:47], v[156:159]
    buffer_store_dwordx4 v[68:71], v113, s[36:39], s76 offen offset:1024 sc1
    s_xor_b32 s76, s93, 24
    s_mul_i32 s76, s76, 49152
    v_mfma_f32_16x16x32_bf16 v[132:135], v[240:243], v[52:55], v[132:135]
    s_add_u32 s76, s76, s75
    s_add_u32 s76, s76, 25198592
    v_cvt_pk_bf16_f32 v72, v164, v165
    v_mfma_f32_16x16x32_bf16 v[140:143], v[244:247], v[52:55], v[140:143]
    v_cvt_pk_bf16_f32 v73, v166, v167
    v_cvt_pk_bf16_f32 v74, v172, v173
    v_cvt_pk_bf16_f32 v75, v174, v175
    v_mfma_f32_16x16x32_bf16 v[148:151], v[248:251], v[52:55], v[148:151]
    buffer_store_dwordx4 v[72:75], v113, s[36:39], s76 offen offset:0 sc1
    v_cvt_pk_bf16_f32 v76, v180, v181
    v_cvt_pk_bf16_f32 v77, v182, v183
    v_mfma_f32_16x16x32_bf16 v[156:159], v[252:255], v[52:55], v[156:159]
    v_cvt_pk_bf16_f32 v78, v188, v189
    v_cvt_pk_bf16_f32 v79, v190, v191
    buffer_store_dwordx4 v[76:79], v113, s[36:39], s76 offen offset:1024 sc1
    v_mfma_f32_16x16x32_bf16 v[128:131], v[208:211], v[16:19], v[128:131]
    v_mfma_f32_16x16x32_bf16 v[136:139], v[212:215], v[16:19], v[136:139]
    v_mfma_f32_16x16x32_bf16 v[144:147], v[216:219], v[16:19], v[144:147]
    s_xor_b32 s76, s93, 8
    s_mul_i32 s76, s76, 49152
    s_add_u32 s76, s76, s75
    s_add_u32 s76, s76, 25165824
    v_mfma_f32_16x16x32_bf16 v[152:155], v[220:223], v[16:19], v[152:155]
    v_cvt_pk_bf16_f32 v56, v132, v133
    v_cvt_pk_bf16_f32 v57, v134, v135
    v_cvt_pk_bf16_f32 v58, v140, v141
    v_cvt_pk_bf16_f32 v59, v142, v143
    v_mfma_f32_16x16x32_bf16 v[128:131], v[224:227], v[40:43], v[128:131]
    buffer_store_dwordx4 v[56:59], v113, s[36:39], s76 offen offset:0 sc1
    v_cvt_pk_bf16_f32 v60, v148, v149
    v_cvt_pk_bf16_f32 v61, v150, v151
    v_cvt_pk_bf16_f32 v62, v156, v157
    v_mfma_f32_16x16x32_bf16 v[136:139], v[228:231], v[40:43], v[136:139]
    v_cvt_pk_bf16_f32 v63, v158, v159
    buffer_store_dwordx4 v[60:63], v113, s[36:39], s76 offen offset:1024 sc1
    v_add_f32 v106, 1.0, v106
    v_rcp_f32 v106, v106
    v_mfma_f32_16x16x32_bf16 v[144:147], v[232:235], v[40:43], v[144:147]
    s_lshl_b32 s73, s93, 3
    s_add_u32 s73, s73, s59
    s_lshl_b32 s73, s73, 7
    v_and_b32 v5, 3, v1
    v_mfma_f32_16x16x32_bf16 v[152:155], v[236:239], v[40:43], v[152:155]
    v_max_u32 v5, 1, v5
    v_lshlrev_b32 v5, 13, v5
    v_xor_b32 v5, s73, v5
    v_add_u32 v120, 38797312, v5
    v_mfma_f32_16x16x32_bf16 v[128:131], v[240:243], v[48:51], v[128:131]
    s_add_u32 s73, s73, 38797312
    s_mul_i32 s74, s93, 49152
    s_add_u32 s74, s74, s75
    s_add_u32 s74, s74, 25165824
    v_mfma_f32_16x16x32_bf16 v[136:139], v[244:247], v[48:51], v[136:139]
    v_and_b32 v5, 15, v1
    v_and_b32 v6, 7, v1
    v_lshrrev_b32 v7, 1, v2
    v_xor_b32 v6, v6, v7
    v_mfma_f32_16x16x32_bf16 v[144:147], v[248:251], v[48:51], v[144:147]
    v_lshlrev_b32 v5, 7, v5
    v_and_b32 v7, 1, v2
    v_lshl_add_u32 v5, v7, 3, v5
    s_add_u32 s79, s75, 147456
    v_mfma_f32_16x16x32_bf16 v[152:155], v[252:255], v[48:51], v[152:155]
    v_add_u32 v5, s79, v5
    v_xor_b32 v7, 0, v6
    v_lshl_add_u32 v80, v7, 4, v5
    v_xor_b32 v7, 2, v6
    v_lshl_add_u32 v81, v7, 4, v5
    v_xor_b32 v7, 4, v6
    v_lshl_add_u32 v82, v7, 4, v5
    v_xor_b32 v7, 6, v6
    v_lshl_add_u32 v83, v7, 4, v5
    v_lshrrev_b32 v6, 3, v1
    v_and_b32 v7, 7, v1
    v_xor_b32 v124, v6, v7
    v_lshlrev_b32 v124, 4, v124
    v_lshl_add_u32 v124, v6, 7, v124
    v_add_u32 v124, s79, v124
    v_lshlrev_b32 v7, 4, v7
    v_lshl_add_u32 v7, v6, 11, v7
    v_mov_b32 v121, 0
    s_waitcnt vmcnt(0)
    buffer_store_dword v110, off, s[36:39], s73 sc1
    s_mov_b32 s79, 0
K2x_c:
    v_cmp_ne_u32 vcc, s83, v121
    s_nop 4
    s_cbranch_vccz K2x_ok
    buffer_load_dword v121, v120, s[36:39], 0 offen sc1
    s_add_u32 s79, s79, 1
    s_waitcnt vmcnt(0)
    s_cmp_lt_u32 s79, 100000
    s_cbranch_scc1 K2x_c
K2x_ok:
    buffer_load_dwordx4 v[40:43], v113, s[36:39], s74 offen offset:0 sc1
    buffer_load_dwordx4 v[44:47], v113, s[36:39], s74 offen offset:1024 sc1
    s_add_u32 s74, s74, 16384
    buffer_load_dwordx4 v[48:51], v113, s[36:39], s74 offen offset:0 sc1
    buffer_load_dwordx4 v[52:55], v113, s[36:39], s74 offen offset:1024 sc1
    s_add_u32 s74, s74, 16384
    buffer_load_dwordx4 v[56:59], v113, s[36:39], s74 offen offset:0 sc1
    buffer_load_dwordx4 v[60:63], v113, s[36:39], s74 offen offset:1024 sc1
    s_lshl_b32 s73, s87, 11
    s_lshl_b32 s75, s94, 8
    s_add_u32 s73, s73, s75
    s_lshr_b32 s75, s95, 1
    s_lshl_b32 s75, s75, 7
    s_add_u32 s73, s73, s75
    s_add_u32 s75, s73, 16384
    s_waitcnt vmcnt(4)
    v_lshlrev_b32 v64, 16, v40
    v_and_b32 v65, 0xffff0000, v40
    v_lshlrev_b32 v66, 16, v41
    v_and_b32 v67, 0xffff0000, v41
    v_pk_add_f32 v[128:129], v[128:129], v[64:65]
    v_pk_add_f32 v[130:131], v[130:131], v[66:67]
    v_lshlrev_b32 v68, 16, v42
    v_and_b32 v69, 0xffff0000, v42
    v_lshlrev_b32 v70, 16, v43
    v_and_b32 v71, 0xffff0000, v43
    v_pk_add_f32 v[136:137], v[136:137], v[68:69]
    v_pk_add_f32 v[138:139], v[138:139], v[70:71]
    v_lshlrev_b32 v64, 16, v44
    v_and_b32 v65, 0xffff0000, v44
    v_lshlrev_b32 v66, 16, v45
    v_and_b32 v67, 0xffff0000, v45
    v_pk_add_f32 v[144:145], v[144:145], v[64:65]
    v_pk_add_f32 v[146:147], v[146:147], v[66:67]
    v_lshlrev_b32 v68, 16, v46
    v_and_b32 v69, 0xffff0000, v46
    v_lshlrev_b32 v70, 16, v47
    v_and_b32 v71, 0xffff0000, v47
    v_pk_add_f32 v[152:153], v[152:153], v[68:69]
    v_pk_add_f32 v[154:155], v[154:155], v[70:71]
    s_waitcnt vmcnt(2)
    v_lshlrev_b32 v64, 16, v48
    v_and_b32 v65, 0xffff0000, v48
    v_lshlrev_b32 v66, 16, v49
    v_and_b32 v67, 0xffff0000, v49
    v_pk_add_f32 v[128:129], v[128:129], v[64:65]
    v_pk_add_f32 v[130:131], v[130:131], v[66:67]
    v_lshlrev_b32 v68, 16, v50
    v_and_b32 v69, 0xffff0000, v50
    v_lshlrev_b32 v70, 16, v51
    v_and_b32 v71, 0xffff0000, v51
    v_pk_add_f32 v[136:137], v[136:137], v[68:69]
    v_pk_add_f32 v[138:139], v[138:139], v[70:71]
    v_lshlrev_b32 v64, 16, v52
    v_and_b32 v65, 0xffff0000, v52
    v_lshlrev_b32 v66, 16, v53
    v_and_b32 v67, 0xffff0000, v53
    v_pk_add_f32 v[144:145], v[144:145], v[64:65]
    v_pk_add_f32 v[146:147], v[146:147], v[66:67]
    v_lshlrev_b32 v68, 16, v54
    v_and_b32 v69, 0xffff0000, v54
    v_lshlrev_b32 v70, 16, v55
    v_and_b32 v71, 0xffff0000, v55
    v_pk_add_f32 v[152:153], v[152:153], v[68:69]
    v_pk_add_f32 v[154:155], v[154:155], v[70:71]
    s_waitcnt vmcnt(0)
    v_lshlrev_b32 v64, 16, v56
    v_and_b32 v65, 0xffff0000, v56
    v_lshlrev_b32 v66, 16, v57
    v_and_b32 v67, 0xffff0000, v57
    v_pk_add_f32 v[128:129], v[128:129], v[64:65]
    v_pk_add_f32 v[130:131], v[130:131], v[66:67]
    v_lshlrev_b32 v68, 16, v58
    v_and_b32 v69, 0xffff0000, v58
    v_lshlrev_b32 v70, 16, v59
    v_and_b32 v71, 0xffff0000, v59
    v_pk_add_f32 v[136:137], v[136:137], v[68:69]
    v_pk_add_f32 v[138:139], v[138:139], v[70:71]
    v_lshlrev_b32 v64, 16, v60
    v_and_b32 v65, 0xffff0000, v60
    v_lshlrev_b32 v66, 16, v61
    v_and_b32 v67, 0xffff0000, v61
    v_pk_add_f32 v[144:145], v[144:145], v[64:65]
    v_pk_add_f32 v[146:147], v[146:147], v[66:67]
    v_lshlrev_b32 v68, 16, v62
    v_and_b32 v69, 0xffff0000, v62
    v_lshlrev_b32 v70, 16, v63
    v_and_b32 v71, 0xffff0000, v63
    v_pk_add_f32 v[152:153], v[152:153], v[68:69]
    v_pk_add_f32 v[154:155], v[154:155], v[70:71]
    v_pk_mul_f32 v[128:129], v[128:129], v[106:107] op_sel_hi:[1,0]
    v_pk_mul_f32 v[130:131], v[130:131], v[106:107] op_sel_hi:[1,0]
    v_cvt_pk_bf16_f32 v8, v128, v129
    v_cvt_pk_bf16_f32 v9, v130, v131
    ds_write_b64 v80, v[8:9]
    v_pk_mul_f32 v[136:137], v[136:137], v[106:107] op_sel_hi:[1,0]
    v_pk_mul_f32 v[138:139], v[138:139], v[106:107] op_sel_hi:[1,0]
    v_cvt_pk_bf16_f32 v10, v136, v137
    v_cvt_pk_bf16_f32 v11, v138, v139
    ds_write_b64 v81, v[10:11]
    v_pk_mul_f32 v[144:145], v[144:145], v[106:107] op_sel_hi:[1,0]
    v_pk_mul_f32 v[146:147], v[146:147], v[106:107] op_sel_hi:[1,0]
    v_cvt_pk_bf16_f32 v12, v144, v145
    v_cvt_pk_bf16_f32 v13, v146, v147
    ds_write_b64 v82, v[12:13]
    v_pk_mul_f32 v[152:153], v[152:153], v[106:107] op_sel_hi:[1,0]
    v_pk_mul_f32 v[154:155], v[154:155], v[106:107] op_sel_hi:[1,0]
    v_cvt_pk_bf16_f32 v14, v152, v153
    v_cvt_pk_bf16_f32 v15, v154, v155
    ds_write_b64 v83, v[14:15]
    s_waitcnt lgkmcnt(0)
    ds_read_b128 v[16:19], v124
    ds_read_b128 v[20:23], v124 offset:1024
    s_waitcnt lgkmcnt(1)
    buffer_store_dwordx4 v[16:19], v7, s[48:51], s73 offen nt
    s_waitcnt lgkmcnt(0)
    buffer_store_dwordx4 v[20:23], v7, s[48:51], s75 offen nt
K_end:
    s_endpgm
K_code_end:
.section .rodata,"a"
.p2align 6
.amdhsa_kernel gated_mix__linear_attn_block__dense_activation_mish__prompt_kernel
  .amdhsa_next_free_vgpr 256
  .amdhsa_next_free_sgpr 102
  .amdhsa_accum_offset 256
  .amdhsa_group_segment_fixed_size 0
  .amdhsa_kernarg_size 88
  .amdhsa_user_sgpr_count 2
  .amdhsa_user_sgpr_kernarg_segment_ptr 1
  .amdhsa_system_sgpr_workgroup_id_x 1
.end_amdhsa_kernel
```
